```python
import torch

def _softmax(x, axis=-1):
    return torch.softmax(x, dim=axis)
def _gelu(x):
    return torch.nn.functional.gelu(x, approximate="tanh")
def _silu(x):
    return torch.nn.functional.silu(x)
def _sigmoid(x):
    return torch.sigmoid(x)
def _layernorm(x, axis=-1, eps=1e-5):
    m = x.mean(dim=axis, keepdim=True)
    v = x.var(dim=axis, keepdim=True, unbiased=False)
    return (x - m) / torch.sqrt(v + eps)
def _scatter_add(tgt, idx, src, axis=0):
    return tgt.clone().index_add_(axis, idx, src)
def _segment_sum(src, seg, n):
    out = torch.zeros((n,) + src.shape[1:], dtype=src.dtype)
    return out.index_add_(0, seg, src)
def _pad(x, pw):
    flat = tuple(v for pair in reversed(pw) for v in pair)
    return torch.nn.functional.pad(x, flat)

kernel_name = 'recurrent_scan__sliding_block_cached__moe_arch_mod__prompt'

def setup_inputs():

    _w = (lambda a: (lambda t: t.to(torch.bfloat16) if t.is_floating_point() else t)(torch.as_tensor(a)))
    def _A_setup():
        B, Sq, D = 1, 2048, 512
        Hq, Hkv, Sk, Dh = 32, 8, 2048, 128
        assert Hq % Hkv == 0, (Hq, Hkv)
        return {
            "x": _w((lambda *s: torch.randn(*s, dtype=torch.bfloat16) * 0.1)(B, Sq, D)),
            "k_cache": _w((lambda *s: torch.randn(*s, dtype=torch.bfloat16) * 0.8)(B, Hkv, Sk, Dh)),
            "v_cache": _w((lambda *s: torch.randn(*s, dtype=torch.bfloat16) * 3.2)(B, Hkv, Sk, Dh)),
            "wq": _w((lambda *s: torch.randn(*s, dtype=torch.bfloat16) * 0.8)(D, Hq * Dh) * (D ** -0.5)),
            "wo": _w((lambda *s: torch.randn(*s, dtype=torch.bfloat16) * 3.2)(Hq * Dh, D) * ((Hq * Dh) ** -0.5)),
        }
    _A_in = _A_setup()

    def _B_setup():
        B, S, D, F, C = 1, 2048, 512, 1792, 8
        return {
            "x": _w((lambda *s: torch.randn(*s, dtype=torch.bfloat16) * 0.1)(B, S, D)),
            "w_r": _w((lambda *s: torch.randn(*s, dtype=torch.bfloat16) * 3.2)(D)),
            "w_gate": _w((lambda *s: torch.randn(*s, dtype=torch.bfloat16) * 1.6)(D, F)),
            "w_up": _w((lambda *s: torch.randn(*s, dtype=torch.bfloat16) * 1.6)(D, F)),
            "w_down": _w((lambda *s: torch.randn(*s, dtype=torch.bfloat16) * 1.6)(F, D)),
        }
    _B_in = _B_setup()

    return {
        "A_x": _A_in["x"],
        "A_k_cache": _A_in["k_cache"],
        "A_v_cache": _A_in["v_cache"],
        "A_wq": _A_in["wq"],
        "A_wo": _A_in["wo"],
        "B_x": _B_in["x"],
        "B_w_r": _B_in["w_r"],
        "B_w_gate": _B_in["w_gate"],
        "B_w_up": _B_in["w_up"],
        "B_w_down": _B_in["w_down"],
    }

def reference(A_x, A_k_cache, A_v_cache, A_wq, A_wo, B_x, B_w_r, B_w_gate, B_w_up, B_w_down):
    def _A_ref(x, k_cache, v_cache, wq, wo):
        B, Sq, D = x.shape
        Hq, Dh = 32, 128
        Hkv, Sk = k_cache.shape[1], k_cache.shape[2]
        W = min(4096, max(256, Sk // 4))
        rep = Hq // Hkv
        q = (lambda x, *d: x.permute(*d))((x @ wq).reshape(B, Sq, Hq, Dh), 0, 2, 1, 3)
        k = (lambda x, n, axis: torch.repeat_interleave(x, n, dim=axis))(k_cache[:, :, Sk - W:, :], rep, axis=1)
        v = (lambda x, n, axis: torch.repeat_interleave(x, n, dim=axis))(v_cache[:, :, Sk - W:, :], rep, axis=1)
        scores = torch.einsum("bhqd,bhkd->bhqk", q, k) * (Dh ** -0.5)
        p = _softmax(scores, axis=-1)
        o = torch.einsum("bhqk,bhkd->bhqd", p, v)
        return (lambda x, *d: x.permute(*d))(o, 0, 2, 1, 3).reshape(B, Sq, Hq * Dh) @ wo

    def _B_ref(x, w_r, w_gate, w_up, w_down):
        B, S, D = x.shape
        C = 8
        r = x @ w_r
        idx = torch.argsort(-r, axis=-1)[:, :C]
        idx_e = (lambda x, n, axis: torch.repeat_interleave(x, n, dim=axis))(idx.reshape(B, C, 1), D, axis=2)
        x_sel = (lambda x, i, axis: torch.take_along_dim(x, i, dim=axis))(x, idx_e, axis=1)
        g = _silu(x_sel @ w_gate)
        u = x_sel @ w_up
        y = (g * u) @ w_down
        r_sel = _sigmoid((lambda x, i, axis: torch.take_along_dim(x, i, dim=axis))(r, idx, axis=1))
        y = y * r_sel.reshape(B, C, 1)
        b_off = (torch.arange(B) * S).reshape(B, 1)
        flat_idx = (idx + b_off).reshape(B * C)
        zero = (x * 0.0).reshape(B * S, D)
        upd = _scatter_add(zero, flat_idx, y.reshape(B * C, D), axis=0)
        return x + upd.reshape(B, S, D)

    x = A_x
    xn = _layernorm(x, axis=-1)
    s = _A_ref(xn, A_k_cache, A_v_cache, A_wq, A_wo)
    g = _silu(_B_ref(xn, B_w_r, B_w_gate, B_w_up, B_w_down))
    return x + s * g
```

```asm
; @launch grid=(256,1,1) block=(256,1,1) lds=163840
.amdgcn_target "amdgcn-amd-amdhsa--gfx950"
.text
.globl recurrent_scan__sliding_block_cached__moe_arch_mod__prompt_kernel
.p2align 8
.type recurrent_scan__sliding_block_cached__moe_arch_mod__prompt_kernel,@function
recurrent_scan__sliding_block_cached__moe_arch_mod__prompt_kernel:
    s_cmp_ge_u32 s2, 256
    s_cbranch_scc1 L_recurrent_scan__sliding_block_cached__moe_arch_mod__prompt_kernel_done
L_kbase:
    s_getpc_b64 s[42:43]
    s_lshr_b32 s44, s2, 3
    s_and_b32 s44, s44, 15
    s_lshl_b32 s44, s44, 12
    v_lshlrev_b32 v200, 4, v0
    v_add_u32 v200, s44, v200
    v_min_u32 v200, (L_kend - L_kbase - 32) & 0xfffffff0, v200
    global_load_dwordx4 v[200:203], v200, s[42:43]
    s_load_dwordx2 s[4:5], s[0:1], 0
    s_load_dwordx2 s[12:13], s[0:1], 8
    s_load_dwordx2 s[16:17], s[0:1], 16
    s_load_dwordx2 s[8:9], s[0:1], 24
    s_load_dwordx2 s[20:21], s[0:1], 32
    s_load_dwordx2 s[28:29], s[0:1], 48
    s_load_dwordx2 s[24:25], s[0:1], 96
    s_load_dwordx2 s[72:73], s[0:1], 88
    s_load_dwordx4 s[92:95], s[0:1], 56
    s_load_dwordx2 s[96:97], s[0:1], 72
    v_lshrrev_b32 v58, 6, v0
    v_and_b32 v0, 63, v0
    v_readfirstlane_b32 s34, v58
    s_and_b32 s42, s2, 3
    s_lshl_b32 s42, s42, 1
    s_bfe_u32 s43, s2, 65539
    s_or_b32 s32, s42, s43
    s_bfe_u32 s42, s2, 65538
    s_lshl_b32 s42, s42, 4
    s_lshr_b32 s43, s2, 4
    s_or_b32 s33, s42, s43
    s_and_b32 s35, s33, 7
    s_lshl_b32 s35, s35, 1
    s_and_b32 s51, s33, 7
    v_and_b32 v60, 15, v0
    v_lshrrev_b32 v61, 4, v0
    s_lshl_b32 s42, s33, 6
    s_lshl_b32 s43, s34, 4
    s_add_u32 s42, s42, s43
    v_lshrrev_b32 v58, 3, v0
    v_add_u32 v58, s42, v58
    v_and_b32 v59, 7, v0
    v_xor_b32 v59, v59, v61
    v_lshlrev_b32 v59, 4, v59
    v_lshl_add_u32 v56, v58, 10, v59
    v_xor_b32 v57, 64, v56
    v_add_u32 v57, 8192, v57
    s_mul_i32 s40, s34, 24576
    s_add_u32 s40, s40, 65536
    s_lshl_b32 s45, s34, 10
    s_lshl_b32 s101, s35, 6
    s_waitcnt lgkmcnt(0)
    s_mov_b32 s6, 2097152
    s_mov_b32 s7, 0x20000
    s_mov_b32 s14, 4194304
    s_mov_b32 s15, 0x20000
    s_mov_b32 s18, 4194304
    s_mov_b32 s19, 0x20000
    s_mov_b32 s10, 4194304
    s_mov_b32 s11, 0x20000
    s_mov_b32 s22, 4194304
    s_mov_b32 s23, 0x20000
    s_mov_b32 s30, 1024
    s_mov_b32 s31, 0x20000
    s_mov_b32 s26, 268435456
    s_mov_b32 s27, 0x20000
    s_add_u32 m0, s45, 0
    s_nop 0
    buffer_load_dwordx4 v56, s[4:7], s101 offen lds
    s_add_u32 m0, s45, 4096
    s_nop 0
    buffer_load_dwordx4 v57, s[4:7], s101 offen lds
    s_add_u32 s101, s101, 128
    s_and_b32 s101, s101, 1023
    s_add_u32 m0, s45, 8192
    s_nop 0
    buffer_load_dwordx4 v56, s[4:7], s101 offen lds
    s_add_u32 m0, s45, 12288
    s_nop 0
    buffer_load_dwordx4 v57, s[4:7], s101 offen lds
    s_add_u32 s101, s101, 128
    s_and_b32 s101, s101, 1023
    s_add_u32 m0, s45, 16384
    s_nop 0
    buffer_load_dwordx4 v56, s[4:7], s101 offen lds
    s_add_u32 m0, s45, 20480
    s_nop 0
    buffer_load_dwordx4 v57, s[4:7], s101 offen lds
    s_add_u32 s101, s101, 128
    s_and_b32 s101, s101, 1023
    s_add_u32 m0, s45, 24576
    s_nop 0
    buffer_load_dwordx4 v56, s[4:7], s101 offen lds
    s_add_u32 m0, s45, 28672
    s_nop 0
    buffer_load_dwordx4 v57, s[4:7], s101 offen lds
    s_add_u32 s101, s101, 128
    s_and_b32 s101, s101, 1023
    s_add_u32 m0, s45, 32768
    s_nop 0
    buffer_load_dwordx4 v56, s[4:7], s101 offen lds
    s_add_u32 m0, s45, 36864
    s_nop 0
    buffer_load_dwordx4 v57, s[4:7], s101 offen lds
    s_add_u32 s101, s101, 128
    s_and_b32 s101, s101, 1023
    s_add_u32 m0, s45, 40960
    s_nop 0
    buffer_load_dwordx4 v56, s[4:7], s101 offen lds
    s_add_u32 m0, s45, 45056
    s_nop 0
    buffer_load_dwordx4 v57, s[4:7], s101 offen lds
    s_add_u32 s101, s101, 128
    s_and_b32 s101, s101, 1023
    s_lshl_b32 s42, s32, 2
    s_add_u32 s42, s42, s34
    s_lshl_b32 s42, s42, 8
    v_lshlrev_b32 v62, 1, v61
    v_xor_b32 v62, v62, v60
    v_lshlrev_b32 v63, 13, v61
    v_add_u32 v63, s42, v63
    v_lshl_add_u32 v1, v62, 4, v63
    v_add_u32 v2, 31744, v1
    v_xor_b32 v62, 8, v62
    v_lshl_add_u32 v3, v62, 4, v63
    v_add_u32 v3, 63488, v3
    v_add_u32 v4, 31744, v3
    s_lshl_b32 s36, s35, 18
    v_bfe_u32 v128, v0, 2, 2
    v_and_b32 v129, 3, v0
    v_lshrrev_b32 v130, 4, v0
    v_and_b32 v131, 1, v130
    v_lshl_or_b32 v131, v131, 2, v128
    v_lshlrev_b32 v131, 1, v131
    v_lshrrev_b32 v132, 1, v129
    v_xor_b32 v131, v131, v132
    v_lshlrev_b32 v131, 4, v131
    v_and_b32 v132, 1, v129
    v_lshl_or_b32 v131, v132, 3, v131
    v_lshl_add_u32 v132, v130, 3, v128
    v_lshl_add_u32 v131, v132, 8, v131
    v_add_u32 v14, s40, v131
    v_xor_b32 v15, 32, v14
    v_xor_b32 v16, 64, v14
    v_xor_b32 v17, 96, v14
    v_xor_b32 v18, 128, v14
    v_xor_b32 v19, 160, v14
    v_xor_b32 v20, 192, v14
    v_xor_b32 v21, 224, v14
    v_and_b32 v131, 1, v130
    v_lshl_or_b32 v132, v131, 2, v128
    v_lshrrev_b32 v131, 1, v132
    v_lshrrev_b32 v133, 1, v130
    v_lshl_or_b32 v132, v133, 4, v132
    v_lshlrev_b32 v131, 1, v131
    v_lshrrev_b32 v133, 1, v129
    v_xor_b32 v131, v131, v133
    v_lshlrev_b32 v131, 4, v131
    v_and_b32 v133, 1, v129
    v_lshl_or_b32 v131, v133, 3, v131
    v_lshl_add_u32 v131, v132, 7, v131
    v_add_u32 v22, s40, v131
    v_xor_b32 v23, 32, v22
    v_xor_b32 v24, 64, v22
    v_xor_b32 v25, 96, v22
    v_lshlrev_b32 v30, 4, v0
    v_lshrrev_b32 v131, 3, v0
    v_lshrrev_b32 v132, 1, v131
    v_and_b32 v132, 3, v132
    v_lshlrev_b32 v132, 1, v132
    v_and_b32 v133, 7, v0
    v_xor_b32 v132, v132, v133
    v_lshlrev_b32 v132, 4, v132
    v_lshl_add_u32 v132, v131, 10, v132
    s_lshl_b32 s42, s34, 7
    v_add_u32 v5, s42, v132
    v_add_u32 v6, 7168, v5
    v_add_u32 v7, 14336, v5
    v_add_u32 v8, 21504, v5
    v_and_b32 v131, 15, v0
    s_lshl_b32 s37, s35, 15
    v_xor_b32 v132, v130, v131
    v_lshlrev_b32 v133, 8, v130
    v_lshl_add_u32 v9, v132, 4, v133
    v_xor_b32 v10, 64, v9
    v_xor_b32 v11, 128, v9
    v_xor_b32 v12, 192, v9
    v_lshlrev_b32 v132, 2, v130
    v_xor_b32 v132, v132, v131
    v_lshl_add_u32 v13, v132, 4, v133
    v_lshrrev_b32 v132, 5, v0
    v_xor_b32 v132, v132, v131
    v_lshlrev_b32 v132, 4, v132
    v_lshl_add_u32 v132, v131, 8, v132
    v_and_b32 v133, 1, v130
    v_mul_u32_u24 v133, 24576, v133
    v_add_u32 v132, v132, v133
    v_add_u32 v32, 73728, v132
    v_xor_b32 v33, 32, v32
    v_xor_b32 v34, 64, v32
    v_xor_b32 v35, 96, v32
    v_xor_b32 v36, 128, v32
    v_xor_b32 v37, 160, v32
    v_xor_b32 v38, 192, v32
    v_xor_b32 v39, 224, v32
    v_and_b32 v132, 1, v130
    v_lshlrev_b32 v132, 1, v132
    v_lshrrev_b32 v133, 1, v129
    v_or_b32 v132, v132, v133
    v_lshlrev_b32 v133, 2, v128
    v_xor_b32 v132, v132, v133
    v_lshlrev_b32 v132, 4, v132
    v_and_b32 v133, 1, v129
    v_lshl_or_b32 v132, v133, 3, v132
    v_lshrrev_b32 v133, 5, v0
    v_lshl_add_u32 v133, v133, 2, v128
    v_lshl_add_u32 v132, v133, 8, v132
    v_add_u32 v40, 77824, v132
    v_xor_b32 v41, 64, v40
    v_xor_b32 v42, 128, v40
    v_xor_b32 v43, 192, v40
    s_add_u32 m0, s45, 49152
    s_nop 0
    buffer_load_dwordx4 v56, s[4:7], s101 offen lds
    s_add_u32 m0, s45, 53248
    s_nop 0
    buffer_load_dwordx4 v57, s[4:7], s101 offen lds
    s_add_u32 s101, s101, 128
    s_and_b32 s101, s101, 1023
    s_add_u32 m0, s45, 57344
    s_nop 0
    buffer_load_dwordx4 v56, s[4:7], s101 offen lds
    s_add_u32 m0, s45, 61440
    s_nop 0
    buffer_load_dwordx4 v57, s[4:7], s101 offen lds
    s_add_u32 s101, s101, 128
    s_and_b32 s101, s101, 1023
    s_lshl_b32 s42, s35, 2
    v_add_u32 v58, s42, v0
    v_and_b32 v58, 63, v58
    v_lshlrev_b32 v58, 4, v58
    s_add_u32 m0, s40, 20480
    s_nop 0
    buffer_load_dwordx4 v58, s[28:31], 0 offen lds
    v_lshlrev_b32 v58, 21, v0
    s_lshl_b32 s42, s33, 16
    v_add_u32 v58, s42, v58
    v_cmp_gt_u32 vcc, 9, v0
    v_mov_b32 v59, 0x7ffffff0
    s_nop 0
    v_cndmask_b32 v58, v59, v58, vcc
    buffer_load_dword a96, v58, s[24:27], 0 offen
    v_lshlrev_b32 v56, 4, v131
    v_lshrrev_b32 v132, 5, v0
    v_lshl_add_u32 v56, v132, 8, v56
    v_and_b32 v132, 1, v130
    v_lshl_add_u32 v56, v132, 10, v56
    s_lshl_b32 s42, s32, 5
    s_add_u32 s42, s42, s33
    s_lshl_b32 s42, s42, 3
    s_add_u32 s42, s42, s34
    s_lshl_b32 s42, s42, 13
    v_lshlrev_b32 v57, 4, v0
    v_add_u32 v57, s42, v57
    s_lshl_b32 s71, s32, 19
    s_lshl_b32 s42, s34, 12
    s_add_u32 s71, s71, s42
    s_add_u32 s71, s71, 393216
    s_add_u32 s12, s12, s71
    s_addc_u32 s13, s13, 0
    s_add_u32 s16, s16, s71
    s_addc_u32 s17, s17, 0
    s_sub_u32 s14, 131072, s42
    s_mov_b32 s18, s14
    s_lshl_b32 s42, s32, 19
    s_add_u32 s20, s20, s42
    s_addc_u32 s21, s21, 0
    s_mov_b32 s22, 524288
    s_lshl_b32 s38, s51, 14
    s_mov_b32 s39, s38
    v_cmp_eq_u32 s[64:65], 1, v129
    v_cmp_eq_u32 s[66:67], 2, v129
    v_cmp_eq_u32 s[68:69], 3, v129
    v_cmp_eq_u32 s[98:99], v130, v128
    v_mov_b32 v133, 0x3f803f80
    v_accvgpr_write_b32 a64, v133
    v_accvgpr_write_b32 a65, v133
    v_accvgpr_write_b32 a66, v133
    v_accvgpr_write_b32 a67, v133
    s_mov_b32 s100, 0xffff0000
    s_nop 0
    v_and_b32 v58, 15, v0
    v_lshrrev_b32 v59, 4, v0
    v_bfe_u32 v60, v58, 1, 3
    v_xor_b32 v59, v59, v60
    v_lshlrev_b32 v59, 4, v59
    v_and_b32 v60, 7, v58
    v_lshl_add_u32 v59, v60, 7, v59
    v_lshrrev_b32 v60, 3, v58
    v_lshl_add_u32 v59, v60, 12, v59
    v_add_u32 v62, s45, v59
    v_xor_b32 v63, 64, v62
    v_accvgpr_write_b32 a192, 0
    v_accvgpr_write_b32 a193, 0
    v_accvgpr_write_b32 a194, 0
    v_accvgpr_write_b32 a195, 0
    v_accvgpr_write_b32 a196, 0
    v_accvgpr_write_b32 a197, 0
    v_accvgpr_write_b32 a198, 0
    v_accvgpr_write_b32 a199, 0
    v_accvgpr_write_b32 a200, 0
    v_accvgpr_write_b32 a201, 0
    v_accvgpr_write_b32 a202, 0
    v_accvgpr_write_b32 a203, 0
    v_accvgpr_write_b32 a204, 0
    v_accvgpr_write_b32 a205, 0
    v_accvgpr_write_b32 a206, 0
    v_accvgpr_write_b32 a207, 0
    v_accvgpr_write_b32 a208, 0
    v_accvgpr_write_b32 a209, 0
    v_accvgpr_write_b32 a210, 0
    v_accvgpr_write_b32 a211, 0
    v_accvgpr_write_b32 a212, 0
    v_accvgpr_write_b32 a213, 0
    v_accvgpr_write_b32 a214, 0
    v_accvgpr_write_b32 a215, 0
    v_accvgpr_write_b32 a216, 0
    v_accvgpr_write_b32 a217, 0
    v_accvgpr_write_b32 a218, 0
    v_accvgpr_write_b32 a219, 0
    v_accvgpr_write_b32 a220, 0
    v_accvgpr_write_b32 a221, 0
    v_accvgpr_write_b32 a222, 0
    v_accvgpr_write_b32 a223, 0
    v_accvgpr_write_b32 a224, 0
    v_accvgpr_write_b32 a225, 0
    v_accvgpr_write_b32 a226, 0
    v_accvgpr_write_b32 a227, 0
    v_accvgpr_write_b32 a228, 0
    v_accvgpr_write_b32 a229, 0
    v_accvgpr_write_b32 a230, 0
    v_accvgpr_write_b32 a231, 0
    v_accvgpr_write_b32 a232, 0
    v_accvgpr_write_b32 a233, 0
    v_accvgpr_write_b32 a234, 0
    v_accvgpr_write_b32 a235, 0
    v_accvgpr_write_b32 a236, 0
    v_accvgpr_write_b32 a237, 0
    v_accvgpr_write_b32 a238, 0
    v_accvgpr_write_b32 a239, 0
    v_accvgpr_write_b32 a240, 0
    v_accvgpr_write_b32 a241, 0
    v_accvgpr_write_b32 a242, 0
    v_accvgpr_write_b32 a243, 0
    v_accvgpr_write_b32 a244, 0
    v_accvgpr_write_b32 a245, 0
    v_accvgpr_write_b32 a246, 0
    v_accvgpr_write_b32 a247, 0
    v_accvgpr_write_b32 a248, 0
    v_accvgpr_write_b32 a249, 0
    v_accvgpr_write_b32 a250, 0
    v_accvgpr_write_b32 a251, 0
    v_accvgpr_write_b32 a252, 0
    v_accvgpr_write_b32 a253, 0
    v_accvgpr_write_b32 a254, 0
    v_accvgpr_write_b32 a255, 0
    s_waitcnt vmcnt(16)
    ds_read_b128 v[64:67], v62 offset:0
    ds_read_b128 v[68:71], v63 offset:0
    s_waitcnt vmcnt(14)
    ds_read_b128 v[72:75], v62 offset:8192
    ds_read_b128 v[76:79], v63 offset:8192
    s_waitcnt lgkmcnt(3)
    v_mfma_f32_16x16x32_bf16 a[68:71], a[64:67], v[64:67], 0
    v_mfma_f32_16x16x32_bf16 a[72:75], v[64:67], v[64:67], 0
    v_lshlrev_b32 v128, 16, v64
    v_and_b32 v129, s100, v64
    v_lshlrev_b32 v130, 16, v65
    v_and_b32 v131, s100, v65
    v_lshlrev_b32 v132, 16, v66
    v_and_b32 v133, s100, v66
    v_lshlrev_b32 v134, 16, v67
    v_and_b32 v135, s100, v67
    s_waitcnt lgkmcnt(2)
    v_mfma_f32_16x16x32_bf16 a[68:71], a[64:67], v[68:71], a[68:71]
    v_mfma_f32_16x16x32_bf16 a[72:75], v[68:71], v[68:71], a[72:75]
    v_lshlrev_b32 v136, 16, v68
    v_and_b32 v137, s100, v68
    v_lshlrev_b32 v138, 16, v69
    v_and_b32 v139, s100, v69
    v_lshlrev_b32 v140, 16, v70
    v_and_b32 v141, s100, v70
    v_lshlrev_b32 v142, 16, v71
    v_and_b32 v143, s100, v71
    s_waitcnt vmcnt(12)
    ds_read_b128 v[80:83], v62 offset:16384
    ds_read_b128 v[84:87], v63 offset:16384
    s_add_u32 m0, s40, 0
    s_nop 0
    buffer_load_dwordx4 v1, s[8:11], s36 offen offset:0 lds
    buffer_load_dwordx4 v2, s[8:11], s36 offen offset:1024 lds
    buffer_load_dwordx4 v3, s[8:11], s36 offen offset:2048 lds
    buffer_load_dwordx4 v4, s[8:11], s36 offen offset:3072 lds
    s_add_u32 s36, s36, 131072
    s_and_b32 s36, s36, 4194303
    s_waitcnt lgkmcnt(3)
    v_mfma_f32_16x16x32_bf16 a[68:71], a[64:67], v[72:75], a[68:71]
    v_mfma_f32_16x16x32_bf16 a[72:75], v[72:75], v[72:75], a[72:75]
    v_lshlrev_b32 v144, 16, v72
    v_and_b32 v145, s100, v72
    v_lshlrev_b32 v146, 16, v73
    v_and_b32 v147, s100, v73
    v_lshlrev_b32 v148, 16, v74
    v_and_b32 v149, s100, v74
    v_lshlrev_b32 v150, 16, v75
    v_and_b32 v151, s100, v75
    s_waitcnt lgkmcnt(2)
    v_mfma_f32_16x16x32_bf16 a[68:71], a[64:67], v[76:79], a[68:71]
    v_mfma_f32_16x16x32_bf16 a[72:75], v[76:79], v[76:79], a[72:75]
    v_lshlrev_b32 v152, 16, v76
    v_and_b32 v153, s100, v76
    v_lshlrev_b32 v154, 16, v77
    v_and_b32 v155, s100, v77
    v_lshlrev_b32 v156, 16, v78
    v_and_b32 v157, s100, v78
    v_lshlrev_b32 v158, 16, v79
    v_and_b32 v159, s100, v79
    s_waitcnt vmcnt(14)
    ds_read_b128 v[88:91], v62 offset:24576
    ds_read_b128 v[92:95], v63 offset:24576
    s_add_u32 m0, s40, 4096
    s_nop 0
    buffer_load_dwordx4 v1, s[8:11], s36 offen offset:0 lds
    buffer_load_dwordx4 v2, s[8:11], s36 offen offset:1024 lds
    buffer_load_dwordx4 v3, s[8:11], s36 offen offset:2048 lds
    buffer_load_dwordx4 v4, s[8:11], s36 offen offset:3072 lds
    s_add_u32 s36, s36, 131072
    s_and_b32 s36, s36, 4194303
    s_waitcnt lgkmcnt(3)
    v_mfma_f32_16x16x32_bf16 a[68:71], a[64:67], v[80:83], a[68:71]
    v_mfma_f32_16x16x32_bf16 a[72:75], v[80:83], v[80:83], a[72:75]
    v_lshlrev_b32 v160, 16, v80
    v_and_b32 v161, s100, v80
    v_lshlrev_b32 v162, 16, v81
    v_and_b32 v163, s100, v81
    v_lshlrev_b32 v164, 16, v82
    v_and_b32 v165, s100, v82
    v_lshlrev_b32 v166, 16, v83
    v_and_b32 v167, s100, v83
    s_waitcnt lgkmcnt(2)
    v_mfma_f32_16x16x32_bf16 a[68:71], a[64:67], v[84:87], a[68:71]
    v_mfma_f32_16x16x32_bf16 a[72:75], v[84:87], v[84:87], a[72:75]
    v_lshlrev_b32 v168, 16, v84
    v_and_b32 v169, s100, v84
    v_lshlrev_b32 v170, 16, v85
    v_and_b32 v171, s100, v85
    v_lshlrev_b32 v172, 16, v86
    v_and_b32 v173, s100, v86
    v_lshlrev_b32 v174, 16, v87
    v_and_b32 v175, s100, v87
    s_waitcnt vmcnt(16)
    ds_read_b128 v[96:99], v62 offset:32768
    ds_read_b128 v[100:103], v63 offset:32768
    s_waitcnt lgkmcnt(3)
    v_mfma_f32_16x16x32_bf16 a[68:71], a[64:67], v[88:91], a[68:71]
    v_mfma_f32_16x16x32_bf16 a[72:75], v[88:91], v[88:91], a[72:75]
    v_lshlrev_b32 v176, 16, v88
    v_and_b32 v177, s100, v88
    v_lshlrev_b32 v178, 16, v89
    v_and_b32 v179, s100, v89
    v_lshlrev_b32 v180, 16, v90
    v_and_b32 v181, s100, v90
    v_lshlrev_b32 v182, 16, v91
    v_and_b32 v183, s100, v91
    s_waitcnt lgkmcnt(2)
    v_mfma_f32_16x16x32_bf16 a[68:71], a[64:67], v[92:95], a[68:71]
    v_mfma_f32_16x16x32_bf16 a[72:75], v[92:95], v[92:95], a[72:75]
    v_lshlrev_b32 v184, 16, v92
    v_and_b32 v185, s100, v92
    v_lshlrev_b32 v186, 16, v93
    v_and_b32 v187, s100, v93
    v_lshlrev_b32 v188, 16, v94
    v_and_b32 v189, s100, v94
    v_lshlrev_b32 v190, 16, v95
    v_and_b32 v191, s100, v95
    s_waitcnt vmcnt(14)
    ds_read_b128 v[104:107], v62 offset:40960
    ds_read_b128 v[108:111], v63 offset:40960
    s_waitcnt lgkmcnt(3)
    v_mfma_f32_16x16x32_bf16 a[68:71], a[64:67], v[96:99], a[68:71]
    v_mfma_f32_16x16x32_bf16 a[72:75], v[96:99], v[96:99], a[72:75]
    v_lshlrev_b32 v192, 16, v96
    v_and_b32 v193, s100, v96
    v_lshlrev_b32 v194, 16, v97
    v_and_b32 v195, s100, v97
    v_lshlrev_b32 v196, 16, v98
    v_and_b32 v197, s100, v98
    v_lshlrev_b32 v198, 16, v99
    v_and_b32 v199, s100, v99
    s_waitcnt lgkmcnt(2)
    v_mfma_f32_16x16x32_bf16 a[68:71], a[64:67], v[100:103], a[68:71]
    v_mfma_f32_16x16x32_bf16 a[72:75], v[100:103], v[100:103], a[72:75]
    v_lshlrev_b32 v200, 16, v100
    v_and_b32 v201, s100, v100
    v_lshlrev_b32 v202, 16, v101
    v_and_b32 v203, s100, v101
    v_lshlrev_b32 v204, 16, v102
    v_and_b32 v205, s100, v102
    v_lshlrev_b32 v206, 16, v103
    v_and_b32 v207, s100, v103
    s_waitcnt vmcnt(12)
    ds_read_b128 v[112:115], v62 offset:49152
    ds_read_b128 v[116:119], v63 offset:49152
    s_waitcnt lgkmcnt(3)
    v_mfma_f32_16x16x32_bf16 a[68:71], a[64:67], v[104:107], a[68:71]
    v_mfma_f32_16x16x32_bf16 a[72:75], v[104:107], v[104:107], a[72:75]
    v_lshlrev_b32 v208, 16, v104
    v_and_b32 v209, s100, v104
    v_lshlrev_b32 v210, 16, v105
    v_and_b32 v211, s100, v105
    v_lshlrev_b32 v212, 16, v106
    v_and_b32 v213, s100, v106
    v_lshlrev_b32 v214, 16, v107
    v_and_b32 v215, s100, v107
    s_waitcnt lgkmcnt(2)
    v_mfma_f32_16x16x32_bf16 a[68:71], a[64:67], v[108:111], a[68:71]
    v_mfma_f32_16x16x32_bf16 a[72:75], v[108:111], v[108:111], a[72:75]
    v_lshlrev_b32 v216, 16, v108
    v_and_b32 v217, s100, v108
    v_lshlrev_b32 v218, 16, v109
    v_and_b32 v219, s100, v109
    v_lshlrev_b32 v220, 16, v110
    v_and_b32 v221, s100, v110
    v_lshlrev_b32 v222, 16, v111
    v_and_b32 v223, s100, v111
    s_waitcnt vmcnt(10)
    ds_read_b128 v[120:123], v62 offset:57344
    ds_read_b128 v[124:127], v63 offset:57344
    s_waitcnt lgkmcnt(3)
    v_mfma_f32_16x16x32_bf16 a[68:71], a[64:67], v[112:115], a[68:71]
    v_mfma_f32_16x16x32_bf16 a[72:75], v[112:115], v[112:115], a[72:75]
    v_lshlrev_b32 v224, 16, v112
    v_and_b32 v225, s100, v112
    v_lshlrev_b32 v226, 16, v113
    v_and_b32 v227, s100, v113
    v_lshlrev_b32 v228, 16, v114
    v_and_b32 v229, s100, v114
    v_lshlrev_b32 v230, 16, v115
    v_and_b32 v231, s100, v115
    s_waitcnt lgkmcnt(2)
    v_mfma_f32_16x16x32_bf16 a[68:71], a[64:67], v[116:119], a[68:71]
    v_mfma_f32_16x16x32_bf16 a[72:75], v[116:119], v[116:119], a[72:75]
    v_lshlrev_b32 v232, 16, v116
    v_and_b32 v233, s100, v116
    v_lshlrev_b32 v234, 16, v117
    v_and_b32 v235, s100, v117
    v_lshlrev_b32 v236, 16, v118
    v_and_b32 v237, s100, v118
    v_lshlrev_b32 v238, 16, v119
    v_and_b32 v239, s100, v119
    s_waitcnt vmcnt(9)
    v_lshrrev_b32 v58, 4, v0
    v_lshlrev_b32 v58, 4, v58
    v_add_u32 v58, s40, v58
    ds_read_b128 a[128:131], v58 offset:20480
    ds_read_b128 a[132:135], v58 offset:20544
    ds_read_b128 a[136:139], v58 offset:20608
    ds_read_b128 a[140:143], v58 offset:20672
    ds_read_b128 a[144:147], v58 offset:20736
    ds_read_b128 a[148:151], v58 offset:20800
    ds_read_b128 a[152:155], v58 offset:20864
    ds_read_b128 a[156:159], v58 offset:20928
    ds_read_b128 a[160:163], v58 offset:20992
    ds_read_b128 a[164:167], v58 offset:21056
    ds_read_b128 a[168:171], v58 offset:21120
    ds_read_b128 a[172:175], v58 offset:21184
    ds_read_b128 a[176:179], v58 offset:21248
    ds_read_b128 a[180:183], v58 offset:21312
    ds_read_b128 a[184:187], v58 offset:21376
    ds_read_b128 a[188:191], v58 offset:21440
    s_waitcnt lgkmcnt(15)
    v_mfma_f32_16x16x32_bf16 a[68:71], a[64:67], v[120:123], a[68:71]
    v_mfma_f32_16x16x32_bf16 a[72:75], v[120:123], v[120:123], a[72:75]
    v_lshlrev_b32 v240, 16, v120
    v_and_b32 v241, s100, v120
    v_lshlrev_b32 v242, 16, v121
    v_and_b32 v243, s100, v121
    v_lshlrev_b32 v244, 16, v122
    v_and_b32 v245, s100, v122
    v_lshlrev_b32 v246, 16, v123
    v_and_b32 v247, s100, v123
    v_mfma_f32_16x16x32_bf16 a[68:71], a[64:67], v[124:127], a[68:71]
    v_mfma_f32_16x16x32_bf16 a[72:75], v[124:127], v[124:127], a[72:75]
    v_lshlrev_b32 v248, 16, v124
    v_and_b32 v249, s100, v124
    v_lshlrev_b32 v250, 16, v125
    v_and_b32 v251, s100, v125
    v_lshlrev_b32 v252, 16, v126
    v_and_b32 v253, s100, v126
    v_lshlrev_b32 v254, 16, v127
    v_and_b32 v255, s100, v127
    s_nop 5
    v_accvgpr_read_b32 v58, a68
    v_accvgpr_read_b32 v60, a72
    v_accvgpr_read_b32 v61, a73
    v_accvgpr_read_b32 v62, a74
    v_accvgpr_read_b32 v63, a75
    v_cndmask_b32 v60, v60, v61, s[64:65]
    v_cndmask_b32 v60, v60, v62, s[66:67]
    v_cndmask_b32 v60, v60, v63, s[68:69]
    v_cndmask_b32 v60, 0, v60, s[98:99]
    v_mov_b32 v61, v60
    s_nop 1
    v_permlane32_swap_b32 v60, v61
    s_nop 0
    v_add_f32 v60, v60, v61
    v_mov_b32 v61, v60
    s_nop 1
    v_permlane16_swap_b32 v60, v61
    s_nop 0
    v_add_f32 v59, v60, v61
    v_mul_f32 v58, 0x3b000000, v58
    v_mul_f32 v59, 0x3b000000, v59
    v_fma_f32 v59, -v58, v58, v59
    v_max_f32 v59, 0, v59
    v_cvt_pk_bf16_f32 v60, v58, v59
    v_and_b32 v61, s100, v60
    v_add_f32 v61, 0x3727c5ac, v61
    v_cvt_pk_bf16_f32 v61, v61, v61
    v_and_b32 v61, s100, v61
    v_sqrt_f32 v61, v61
    v_lshlrev_b32 v58, 16, v60
    v_cvt_pk_bf16_f32 v61, v61, v61
    v_and_b32 v62, s100, v61
    v_rcp_f32 v63, v62
    v_and_b32 v60, 0xffff, v60
    v_or_b32 v31, v60, v62
    v_mul_f32 v63, 0x3e0293ee, v63
    v_mul_f32 v62, v58, v63
    v_sub_f32 v62, 0, v62
    v_mov_b32 v60, v63
    v_mov_b32 v61, v63
    v_mov_b32 v63, v62
    s_lshl_b32 s42, s34, 10
    v_add_u32 v58, s42, v30
    v_pk_fma_f32 v[128:129], v[128:129], v[60:61], v[62:63]
    v_pk_fma_f32 v[130:131], v[130:131], v[60:61], v[62:63]
    v_pk_fma_f32 v[132:133], v[132:133], v[60:61], v[62:63]
    v_pk_fma_f32 v[134:135], v[134:135], v[60:61], v[62:63]
    v_cvt_pk_bf16_f32 v64, v128, v129
    v_cvt_pk_bf16_f32 v65, v130, v131
    v_cvt_pk_bf16_f32 v66, v132, v133
    v_cvt_pk_bf16_f32 v67, v134, v135
    ds_write_b128 v58, v[64:67] offset:0
    s_add_u32 m0, s40, 8192
    s_nop 0
    buffer_load_dwordx4 v1, s[8:11], s36 offen offset:0 lds
    v_pk_fma_f32 v[136:137], v[136:137], v[60:61], v[62:63]
    v_pk_fma_f32 v[138:139], v[138:139], v[60:61], v[62:63]
    v_pk_fma_f32 v[140:141], v[140:141], v[60:61], v[62:63]
    v_pk_fma_f32 v[142:143], v[142:143], v[60:61], v[62:63]
    v_cvt_pk_bf16_f32 v68, v136, v137
    v_cvt_pk_bf16_f32 v69, v138, v139
    v_cvt_pk_bf16_f32 v70, v140, v141
    v_cvt_pk_bf16_f32 v71, v142, v143
    ds_write_b128 v58, v[68:71] offset:4096
    buffer_load_dwordx4 v2, s[8:11], s36 offen offset:1024 lds
    v_pk_fma_f32 v[144:145], v[144:145], v[60:61], v[62:63]
    v_pk_fma_f32 v[146:147], v[146:147], v[60:61], v[62:63]
    v_pk_fma_f32 v[148:149], v[148:149], v[60:61], v[62:63]
    v_pk_fma_f32 v[150:151], v[150:151], v[60:61], v[62:63]
    v_cvt_pk_bf16_f32 v72, v144, v145
    v_cvt_pk_bf16_f32 v73, v146, v147
    v_cvt_pk_bf16_f32 v74, v148, v149
    v_cvt_pk_bf16_f32 v75, v150, v151
    ds_write_b128 v58, v[72:75] offset:8192
    buffer_load_dwordx4 v3, s[8:11], s36 offen offset:2048 lds
    v_pk_fma_f32 v[152:153], v[152:153], v[60:61], v[62:63]
    v_pk_fma_f32 v[154:155], v[154:155], v[60:61], v[62:63]
    v_pk_fma_f32 v[156:157], v[156:157], v[60:61], v[62:63]
    v_pk_fma_f32 v[158:159], v[158:159], v[60:61], v[62:63]
    v_cvt_pk_bf16_f32 v76, v152, v153
    v_cvt_pk_bf16_f32 v77, v154, v155
    v_cvt_pk_bf16_f32 v78, v156, v157
    v_cvt_pk_bf16_f32 v79, v158, v159
    ds_write_b128 v58, v[76:79] offset:12288
    buffer_load_dwordx4 v4, s[8:11], s36 offen offset:3072 lds
    s_add_u32 s36, s36, 131072
    s_and_b32 s36, s36, 4194303
    v_pk_fma_f32 v[160:161], v[160:161], v[60:61], v[62:63]
    v_pk_fma_f32 v[162:163], v[162:163], v[60:61], v[62:63]
    v_pk_fma_f32 v[164:165], v[164:165], v[60:61], v[62:63]
    v_pk_fma_f32 v[166:167], v[166:167], v[60:61], v[62:63]
    v_cvt_pk_bf16_f32 v80, v160, v161
    v_cvt_pk_bf16_f32 v81, v162, v163
    v_cvt_pk_bf16_f32 v82, v164, v165
    v_cvt_pk_bf16_f32 v83, v166, v167
    ds_write_b128 v58, v[80:83] offset:16384
    s_add_u32 m0, s40, 12288
    s_nop 0
    buffer_load_dwordx4 v1, s[8:11], s36 offen offset:0 lds
    v_pk_fma_f32 v[168:169], v[168:169], v[60:61], v[62:63]
    v_pk_fma_f32 v[170:171], v[170:171], v[60:61], v[62:63]
    v_pk_fma_f32 v[172:173], v[172:173], v[60:61], v[62:63]
    v_pk_fma_f32 v[174:175], v[174:175], v[60:61], v[62:63]
    v_cvt_pk_bf16_f32 v84, v168, v169
    v_cvt_pk_bf16_f32 v85, v170, v171
    v_cvt_pk_bf16_f32 v86, v172, v173
    v_cvt_pk_bf16_f32 v87, v174, v175
    ds_write_b128 v58, v[84:87] offset:20480
    buffer_load_dwordx4 v2, s[8:11], s36 offen offset:1024 lds
    v_pk_fma_f32 v[176:177], v[176:177], v[60:61], v[62:63]
    v_pk_fma_f32 v[178:179], v[178:179], v[60:61], v[62:63]
    v_pk_fma_f32 v[180:181], v[180:181], v[60:61], v[62:63]
    v_pk_fma_f32 v[182:183], v[182:183], v[60:61], v[62:63]
    v_cvt_pk_bf16_f32 v88, v176, v177
    v_cvt_pk_bf16_f32 v89, v178, v179
    v_cvt_pk_bf16_f32 v90, v180, v181
    v_cvt_pk_bf16_f32 v91, v182, v183
    ds_write_b128 v58, v[88:91] offset:24576
    buffer_load_dwordx4 v3, s[8:11], s36 offen offset:2048 lds
    v_pk_fma_f32 v[184:185], v[184:185], v[60:61], v[62:63]
    v_pk_fma_f32 v[186:187], v[186:187], v[60:61], v[62:63]
    v_pk_fma_f32 v[188:189], v[188:189], v[60:61], v[62:63]
    v_pk_fma_f32 v[190:191], v[190:191], v[60:61], v[62:63]
    v_cvt_pk_bf16_f32 v92, v184, v185
    v_cvt_pk_bf16_f32 v93, v186, v187
    v_cvt_pk_bf16_f32 v94, v188, v189
    v_cvt_pk_bf16_f32 v95, v190, v191
    ds_write_b128 v58, v[92:95] offset:28672
    buffer_load_dwordx4 v4, s[8:11], s36 offen offset:3072 lds
    s_add_u32 s36, s36, 131072
    s_and_b32 s36, s36, 4194303
    v_pk_fma_f32 v[192:193], v[192:193], v[60:61], v[62:63]
    v_pk_fma_f32 v[194:195], v[194:195], v[60:61], v[62:63]
    v_pk_fma_f32 v[196:197], v[196:197], v[60:61], v[62:63]
    v_pk_fma_f32 v[198:199], v[198:199], v[60:61], v[62:63]
    v_cvt_pk_bf16_f32 v96, v192, v193
    v_cvt_pk_bf16_f32 v97, v194, v195
    v_cvt_pk_bf16_f32 v98, v196, v197
    v_cvt_pk_bf16_f32 v99, v198, v199
    ds_write_b128 v58, v[96:99] offset:32768
    s_add_u32 m0, s40, 16384
    s_nop 0
    buffer_load_dwordx4 v1, s[8:11], s36 offen offset:0 lds
    v_pk_fma_f32 v[200:201], v[200:201], v[60:61], v[62:63]
    v_pk_fma_f32 v[202:203], v[202:203], v[60:61], v[62:63]
    v_pk_fma_f32 v[204:205], v[204:205], v[60:61], v[62:63]
    v_pk_fma_f32 v[206:207], v[206:207], v[60:61], v[62:63]
    v_cvt_pk_bf16_f32 v100, v200, v201
    v_cvt_pk_bf16_f32 v101, v202, v203
    v_cvt_pk_bf16_f32 v102, v204, v205
    v_cvt_pk_bf16_f32 v103, v206, v207
    ds_write_b128 v58, v[100:103] offset:36864
    buffer_load_dwordx4 v2, s[8:11], s36 offen offset:1024 lds
    v_pk_fma_f32 v[208:209], v[208:209], v[60:61], v[62:63]
    v_pk_fma_f32 v[210:211], v[210:211], v[60:61], v[62:63]
    v_pk_fma_f32 v[212:213], v[212:213], v[60:61], v[62:63]
    v_pk_fma_f32 v[214:215], v[214:215], v[60:61], v[62:63]
    v_cvt_pk_bf16_f32 v104, v208, v209
    v_cvt_pk_bf16_f32 v105, v210, v211
    v_cvt_pk_bf16_f32 v106, v212, v213
    v_cvt_pk_bf16_f32 v107, v214, v215
    ds_write_b128 v58, v[104:107] offset:40960
    buffer_load_dwordx4 v3, s[8:11], s36 offen offset:2048 lds
    v_pk_fma_f32 v[216:217], v[216:217], v[60:61], v[62:63]
    v_pk_fma_f32 v[218:219], v[218:219], v[60:61], v[62:63]
    v_pk_fma_f32 v[220:221], v[220:221], v[60:61], v[62:63]
    v_pk_fma_f32 v[222:223], v[222:223], v[60:61], v[62:63]
    v_cvt_pk_bf16_f32 v108, v216, v217
    v_cvt_pk_bf16_f32 v109, v218, v219
    v_cvt_pk_bf16_f32 v110, v220, v221
    v_cvt_pk_bf16_f32 v111, v222, v223
    ds_write_b128 v58, v[108:111] offset:45056
    buffer_load_dwordx4 v4, s[8:11], s36 offen offset:3072 lds
    s_add_u32 s36, s36, 131072
    s_and_b32 s36, s36, 4194303
    v_pk_fma_f32 v[224:225], v[224:225], v[60:61], v[62:63]
    v_pk_fma_f32 v[226:227], v[226:227], v[60:61], v[62:63]
    v_pk_fma_f32 v[228:229], v[228:229], v[60:61], v[62:63]
    v_pk_fma_f32 v[230:231], v[230:231], v[60:61], v[62:63]
    v_cvt_pk_bf16_f32 v112, v224, v225
    v_cvt_pk_bf16_f32 v113, v226, v227
    v_cvt_pk_bf16_f32 v114, v228, v229
    v_cvt_pk_bf16_f32 v115, v230, v231
    ds_write_b128 v58, v[112:115] offset:49152
    v_pk_fma_f32 v[232:233], v[232:233], v[60:61], v[62:63]
    v_pk_fma_f32 v[234:235], v[234:235], v[60:61], v[62:63]
    v_pk_fma_f32 v[236:237], v[236:237], v[60:61], v[62:63]
    v_pk_fma_f32 v[238:239], v[238:239], v[60:61], v[62:63]
    v_cvt_pk_bf16_f32 v116, v232, v233
    v_cvt_pk_bf16_f32 v117, v234, v235
    v_cvt_pk_bf16_f32 v118, v236, v237
    v_cvt_pk_bf16_f32 v119, v238, v239
    ds_write_b128 v58, v[116:119] offset:53248
    v_pk_fma_f32 v[240:241], v[240:241], v[60:61], v[62:63]
    v_pk_fma_f32 v[242:243], v[242:243], v[60:61], v[62:63]
    v_pk_fma_f32 v[244:245], v[244:245], v[60:61], v[62:63]
    v_pk_fma_f32 v[246:247], v[246:247], v[60:61], v[62:63]
    v_cvt_pk_bf16_f32 v120, v240, v241
    v_cvt_pk_bf16_f32 v121, v242, v243
    v_cvt_pk_bf16_f32 v122, v244, v245
    v_cvt_pk_bf16_f32 v123, v246, v247
    ds_write_b128 v58, v[120:123] offset:57344
    v_pk_fma_f32 v[248:249], v[248:249], v[60:61], v[62:63]
    v_pk_fma_f32 v[250:251], v[250:251], v[60:61], v[62:63]
    v_pk_fma_f32 v[252:253], v[252:253], v[60:61], v[62:63]
    v_pk_fma_f32 v[254:255], v[254:255], v[60:61], v[62:63]
    v_cvt_pk_bf16_f32 v124, v248, v249
    v_cvt_pk_bf16_f32 v125, v250, v251
    v_cvt_pk_bf16_f32 v126, v252, v253
    v_cvt_pk_bf16_f32 v127, v254, v255
    ds_write_b128 v58, v[124:127] offset:61440
    s_waitcnt lgkmcnt(15)
    s_waitcnt lgkmcnt(0)
    s_barrier
    s_waitcnt vmcnt(12)
    ds_read_b128 a[96:99], v30 offset:0
    ds_read_b128 a[100:103], v30 offset:1024
    ds_read_b128 a[104:107], v30 offset:2048
    ds_read_b128 a[108:111], v30 offset:3072
    ds_read_b64_tr_b16 a[0:1], v14 offset:0
    ds_read_b64_tr_b16 a[2:3], v14 offset:1024
    ds_read_b64_tr_b16 a[4:5], v15 offset:0
    ds_read_b64_tr_b16 a[6:7], v15 offset:1024
    ds_read_b64_tr_b16 a[8:9], v16 offset:0
    ds_read_b64_tr_b16 a[10:11], v16 offset:1024
    ds_read_b64_tr_b16 a[12:13], v17 offset:0
    ds_read_b64_tr_b16 a[14:15], v17 offset:1024
    ds_read_b64_tr_b16 a[16:17], v18 offset:0
    ds_read_b64_tr_b16 a[18:19], v18 offset:1024
    ds_read_b64_tr_b16 a[20:21], v19 offset:0
    ds_read_b64_tr_b16 a[22:23], v19 offset:1024
    ds_read_b64_tr_b16 a[24:25], v20 offset:0
    ds_read_b64_tr_b16 a[26:27], v20 offset:1024
    ds_read_b64_tr_b16 a[28:29], v21 offset:0
    ds_read_b64_tr_b16 a[30:31], v21 offset:1024
    s_add_u32 m0, s40, 20480
    s_nop 0
    buffer_load_dwordx4 v1, s[8:11], s36 offen offset:0 lds
    buffer_load_dwordx4 v2, s[8:11], s36 offen offset:1024 lds
    buffer_load_dwordx4 v3, s[8:11], s36 offen offset:2048 lds
    buffer_load_dwordx4 v4, s[8:11], s36 offen offset:3072 lds
    s_add_u32 s36, s36, 131072
    s_and_b32 s36, s36, 4194303
    v_mfma_f32_16x16x32_bf16 a[76:79], a[128:131], v[64:67], 0
    v_mfma_f32_16x16x32_bf16 a[76:79], a[132:135], v[68:71], a[76:79]
    v_mfma_f32_16x16x32_bf16 a[76:79], a[136:139], v[72:75], a[76:79]
    v_mfma_f32_16x16x32_bf16 a[76:79], a[140:143], v[76:79], a[76:79]
    v_mfma_f32_16x16x32_bf16 a[76:79], a[144:147], v[80:83], a[76:79]
    v_mfma_f32_16x16x32_bf16 a[76:79], a[148:151], v[84:87], a[76:79]
    v_mfma_f32_16x16x32_bf16 a[76:79], a[152:155], v[88:91], a[76:79]
    v_mfma_f32_16x16x32_bf16 a[76:79], a[156:159], v[92:95], a[76:79]
    v_mfma_f32_16x16x32_bf16 a[76:79], a[160:163], v[96:99], a[76:79]
    v_mfma_f32_16x16x32_bf16 a[76:79], a[164:167], v[100:103], a[76:79]
    v_mfma_f32_16x16x32_bf16 a[76:79], a[168:171], v[104:107], a[76:79]
    v_mfma_f32_16x16x32_bf16 a[76:79], a[172:175], v[108:111], a[76:79]
    v_mfma_f32_16x16x32_bf16 a[76:79], a[176:179], v[112:115], a[76:79]
    v_mfma_f32_16x16x32_bf16 a[76:79], a[180:183], v[116:119], a[76:79]
    v_mfma_f32_16x16x32_bf16 a[76:79], a[184:187], v[120:123], a[76:79]
    v_mfma_f32_16x16x32_bf16 a[76:79], a[188:191], v[124:127], a[76:79]
    s_nop 7
    v_accvgpr_read_b32 v58, a76
    v_mul_f32 v58, 0x40faf233, v58
    v_cvt_pk_bf16_f32 v58, v58, v58
    v_and_b32 v59, s100, v58
    v_ashrrev_i32 v58, 31, v59
    v_or_b32 v58, 0x80000000, v58
    v_xor_b32 v59, v59, v58
    s_lshl_b32 s42, s33, 6
    s_lshl_b32 s43, s34, 4
    s_add_u32 s42, s42, s43
    s_sub_u32 s42, 2047, s42
    v_and_b32 v58, 15, v0
    v_sub_u32 v58, s42, v58
    v_and_or_b32 v59, v59, s100, v58
    s_waitcnt lgkmcnt(0)
    s_add_u32 m0, s40, 0
    s_nop 0
    buffer_load_dwordx4 v1, s[8:11], s36 offen offset:0 lds
    buffer_load_dwordx4 v2, s[8:11], s36 offen offset:1024 lds
    buffer_load_dwordx4 v3, s[8:11], s36 offen offset:2048 lds
    buffer_load_dwordx4 v4, s[8:11], s36 offen offset:3072 lds
    s_add_u32 s36, s36, 131072
    s_and_b32 s36, s36, 4194303
    s_waitcnt vmcnt(12)
    v_mfma_f32_16x16x32_bf16 v[128:131], a[0:3], a[96:99], 0
    ds_read_b64_tr_b16 a[32:33], v14 offset:8192
    s_add_u32 m0, s40, 4096
    v_mfma_f32_16x16x32_bf16 v[132:135], a[0:3], a[100:103], 0
    ds_read_b64_tr_b16 a[34:35], v14 offset:9216
    v_mfma_f32_16x16x32_bf16 v[136:139], a[0:3], a[104:107], 0
    ds_read_b64_tr_b16 a[36:37], v15 offset:8192
    buffer_load_dwordx4 v1, s[8:11], s36 offen offset:0 lds
    v_mfma_f32_16x16x32_bf16 v[140:143], a[0:3], a[108:111], 0
    ds_read_b64_tr_b16 a[38:39], v15 offset:9216
    v_mfma_f32_16x16x32_bf16 v[144:147], a[4:7], a[96:99], 0
    ds_read_b64_tr_b16 a[40:41], v16 offset:8192
    v_mfma_f32_16x16x32_bf16 v[148:151], a[4:7], a[100:103], 0
    ds_read_b64_tr_b16 a[42:43], v16 offset:9216
    v_mfma_f32_16x16x32_bf16 v[152:155], a[4:7], a[104:107], 0
    ds_read_b64_tr_b16 a[44:45], v17 offset:8192
    buffer_load_dwordx4 v2, s[8:11], s36 offen offset:1024 lds
    v_mfma_f32_16x16x32_bf16 v[156:159], a[4:7], a[108:111], 0
    ds_read_b64_tr_b16 a[46:47], v17 offset:9216
    v_mfma_f32_16x16x32_bf16 v[160:163], a[8:11], a[96:99], 0
    ds_read_b64_tr_b16 a[48:49], v18 offset:8192
    v_mfma_f32_16x16x32_bf16 v[164:167], a[8:11], a[100:103], 0
    ds_read_b64_tr_b16 a[50:51], v18 offset:9216
    v_mfma_f32_16x16x32_bf16 v[168:171], a[8:11], a[104:107], 0
    ds_read_b64_tr_b16 a[52:53], v19 offset:8192
    buffer_load_dwordx4 v3, s[8:11], s36 offen offset:2048 lds
    v_mfma_f32_16x16x32_bf16 v[172:175], a[8:11], a[108:111], 0
    ds_read_b64_tr_b16 a[54:55], v19 offset:9216
    v_mfma_f32_16x16x32_bf16 v[176:179], a[12:15], a[96:99], 0
    ds_read_b64_tr_b16 a[56:57], v20 offset:8192
    v_mfma_f32_16x16x32_bf16 v[180:183], a[12:15], a[100:103], 0
    ds_read_b64_tr_b16 a[58:59], v20 offset:9216
    v_mfma_f32_16x16x32_bf16 v[184:187], a[12:15], a[104:107], 0
    ds_read_b64_tr_b16 a[60:61], v21 offset:8192
    buffer_load_dwordx4 v4, s[8:11], s36 offen offset:3072 lds
    v_mfma_f32_16x16x32_bf16 v[188:191], a[12:15], a[108:111], 0
    ds_read_b64_tr_b16 a[62:63], v21 offset:9216
    v_mfma_f32_16x16x32_bf16 v[192:195], a[16:19], a[96:99], 0
    ds_read_b128 a[112:115], v30 offset:4096
    v_mfma_f32_16x16x32_bf16 v[196:199], a[16:19], a[100:103], 0
    ds_read_b128 a[116:119], v30 offset:5120
    v_mfma_f32_16x16x32_bf16 v[200:203], a[16:19], a[104:107], 0
    ds_read_b128 a[120:123], v30 offset:6144
    v_mfma_f32_16x16x32_bf16 v[204:207], a[16:19], a[108:111], 0
    ds_read_b128 a[124:127], v30 offset:7168
    v_mfma_f32_16x16x32_bf16 v[208:211], a[20:23], a[96:99], 0
    s_add_u32 s36, s36, 131072
    s_and_b32 s36, s36, 4194303
    v_mfma_f32_16x16x32_bf16 v[212:215], a[20:23], a[100:103], 0
    s_waitcnt lgkmcnt(4)
    s_add_u32 m0, s40, 8192
    v_mfma_f32_16x16x32_bf16 v[216:219], a[20:23], a[104:107], 0
    buffer_load_dwordx4 v1, s[8:11], s36 offen offset:0 lds
    v_mfma_f32_16x16x32_bf16 v[220:223], a[20:23], a[108:111], 0
    v_mfma_f32_16x16x32_bf16 v[224:227], a[24:27], a[96:99], 0
    v_mfma_f32_16x16x32_bf16 v[228:231], a[24:27], a[100:103], 0
    buffer_load_dwordx4 v2, s[8:11], s36 offen offset:1024 lds
    v_mfma_f32_16x16x32_bf16 v[232:235], a[24:27], a[104:107], 0
    v_mfma_f32_16x16x32_bf16 v[236:239], a[24:27], a[108:111], 0
    v_mfma_f32_16x16x32_bf16 v[240:243], a[28:31], a[96:99], 0
    buffer_load_dwordx4 v3, s[8:11], s36 offen offset:2048 lds
    v_mfma_f32_16x16x32_bf16 v[244:247], a[28:31], a[100:103], 0
    v_mfma_f32_16x16x32_bf16 v[248:251], a[28:31], a[104:107], 0
    v_mfma_f32_16x16x32_bf16 v[252:255], a[28:31], a[108:111], 0
    buffer_load_dwordx4 v4, s[8:11], s36 offen offset:3072 lds
    s_add_u32 s36, s36, 131072
    s_and_b32 s36, s36, 4194303
    s_mov_b32 s41, 3
    v_add_u32 v30, 4096, v30
L_g1_loop:
    s_waitcnt vmcnt(12)
    s_waitcnt lgkmcnt(0)
    v_mfma_f32_16x16x32_bf16 v[128:131], a[32:35], a[112:115], v[128:131]
    ds_read_b64_tr_b16 a[64:65], v14 offset:16384
    s_add_u32 m0, s40, 12288
    v_mfma_f32_16x16x32_bf16 v[132:135], a[32:35], a[116:119], v[132:135]
    ds_read_b64_tr_b16 a[66:67], v14 offset:17408
    v_mfma_f32_16x16x32_bf16 v[136:139], a[32:35], a[120:123], v[136:139]
    ds_read_b64_tr_b16 a[68:69], v15 offset:16384
    buffer_load_dwordx4 v1, s[8:11], s36 offen offset:0 lds
    v_mfma_f32_16x16x32_bf16 v[140:143], a[32:35], a[124:127], v[140:143]
    ds_read_b64_tr_b16 a[70:71], v15 offset:17408
    v_mfma_f32_16x16x32_bf16 v[144:147], a[36:39], a[112:115], v[144:147]
    ds_read_b64_tr_b16 a[72:73], v16 offset:16384
    v_mfma_f32_16x16x32_bf16 v[148:151], a[36:39], a[116:119], v[148:151]
    ds_read_b64_tr_b16 a[74:75], v16 offset:17408
    v_mfma_f32_16x16x32_bf16 v[152:155], a[36:39], a[120:123], v[152:155]
    ds_read_b64_tr_b16 a[76:77], v17 offset:16384
    buffer_load_dwordx4 v2, s[8:11], s36 offen offset:1024 lds
    v_mfma_f32_16x16x32_bf16 v[156:159], a[36:39], a[124:127], v[156:159]
    ds_read_b64_tr_b16 a[78:79], v17 offset:17408
    v_mfma_f32_16x16x32_bf16 v[160:163], a[40:43], a[112:115], v[160:163]
    ds_read_b64_tr_b16 a[80:81], v18 offset:16384
    v_mfma_f32_16x16x32_bf16 v[164:167], a[40:43], a[116:119], v[164:167]
    ds_read_b64_tr_b16 a[82:83], v18 offset:17408
    v_mfma_f32_16x16x32_bf16 v[168:171], a[40:43], a[120:123], v[168:171]
    ds_read_b64_tr_b16 a[84:85], v19 offset:16384
    buffer_load_dwordx4 v3, s[8:11], s36 offen offset:2048 lds
    v_mfma_f32_16x16x32_bf16 v[172:175], a[40:43], a[124:127], v[172:175]
    ds_read_b64_tr_b16 a[86:87], v19 offset:17408
    v_mfma_f32_16x16x32_bf16 v[176:179], a[44:47], a[112:115], v[176:179]
    ds_read_b64_tr_b16 a[88:89], v20 offset:16384
    v_mfma_f32_16x16x32_bf16 v[180:183], a[44:47], a[116:119], v[180:183]
    ds_read_b64_tr_b16 a[90:91], v20 offset:17408
    v_mfma_f32_16x16x32_bf16 v[184:187], a[44:47], a[120:123], v[184:187]
    ds_read_b64_tr_b16 a[92:93], v21 offset:16384
    buffer_load_dwordx4 v4, s[8:11], s36 offen offset:3072 lds
    v_mfma_f32_16x16x32_bf16 v[188:191], a[44:47], a[124:127], v[188:191]
    ds_read_b64_tr_b16 a[94:95], v21 offset:17408
    v_mfma_f32_16x16x32_bf16 v[192:195], a[48:51], a[112:115], v[192:195]
    ds_read_b128 v[64:67], v30 offset:4096
    v_mfma_f32_16x16x32_bf16 v[196:199], a[48:51], a[116:119], v[196:199]
    ds_read_b128 v[68:71], v30 offset:5120
    v_mfma_f32_16x16x32_bf16 v[200:203], a[48:51], a[120:123], v[200:203]
    ds_read_b128 v[72:75], v30 offset:6144
    v_mfma_f32_16x16x32_bf16 v[204:207], a[48:51], a[124:127], v[204:207]
    ds_read_b128 v[76:79], v30 offset:7168
    v_mfma_f32_16x16x32_bf16 v[208:211], a[52:55], a[112:115], v[208:211]
    s_add_u32 s36, s36, 131072
    s_and_b32 s36, s36, 4194303
    v_mfma_f32_16x16x32_bf16 v[212:215], a[52:55], a[116:119], v[212:215]
    s_waitcnt lgkmcnt(4)
    s_add_u32 m0, s40, 16384
    v_mfma_f32_16x16x32_bf16 v[216:219], a[52:55], a[120:123], v[216:219]
    buffer_load_dwordx4 v1, s[8:11], s36 offen offset:0 lds
    v_mfma_f32_16x16x32_bf16 v[220:223], a[52:55], a[124:127], v[220:223]
    v_mfma_f32_16x16x32_bf16 v[224:227], a[56:59], a[112:115], v[224:227]
    v_mfma_f32_16x16x32_bf16 v[228:231], a[56:59], a[116:119], v[228:231]
    buffer_load_dwordx4 v2, s[8:11], s36 offen offset:1024 lds
    v_mfma_f32_16x16x32_bf16 v[232:235], a[56:59], a[120:123], v[232:235]
    v_mfma_f32_16x16x32_bf16 v[236:239], a[56:59], a[124:127], v[236:239]
    v_mfma_f32_16x16x32_bf16 v[240:243], a[60:63], a[112:115], v[240:243]
    buffer_load_dwordx4 v3, s[8:11], s36 offen offset:2048 lds
    v_mfma_f32_16x16x32_bf16 v[244:247], a[60:63], a[116:119], v[244:247]
    v_mfma_f32_16x16x32_bf16 v[248:251], a[60:63], a[120:123], v[248:251]
    v_mfma_f32_16x16x32_bf16 v[252:255], a[60:63], a[124:127], v[252:255]
    buffer_load_dwordx4 v4, s[8:11], s36 offen offset:3072 lds
    s_add_u32 s36, s36, 131072
    s_and_b32 s36, s36, 4194303
    s_waitcnt vmcnt(12)
    s_waitcnt lgkmcnt(0)
    v_mfma_f32_16x16x32_bf16 v[128:131], a[64:67], v[64:67], v[128:131]
    ds_read_b64_tr_b16 a[0:1], v14 offset:0
    s_add_u32 m0, s40, 20480
    v_mfma_f32_16x16x32_bf16 v[132:135], a[64:67], v[68:71], v[132:135]
    ds_read_b64_tr_b16 a[2:3], v14 offset:1024
    v_mfma_f32_16x16x32_bf16 v[136:139], a[64:67], v[72:75], v[136:139]
    ds_read_b64_tr_b16 a[4:5], v15 offset:0
    buffer_load_dwordx4 v1, s[8:11], s36 offen offset:0 lds
    v_mfma_f32_16x16x32_bf16 v[140:143], a[64:67], v[76:79], v[140:143]
    ds_read_b64_tr_b16 a[6:7], v15 offset:1024
    v_mfma_f32_16x16x32_bf16 v[144:147], a[68:71], v[64:67], v[144:147]
    ds_read_b64_tr_b16 a[8:9], v16 offset:0
    v_mfma_f32_16x16x32_bf16 v[148:151], a[68:71], v[68:71], v[148:151]
    ds_read_b64_tr_b16 a[10:11], v16 offset:1024
    v_mfma_f32_16x16x32_bf16 v[152:155], a[68:71], v[72:75], v[152:155]
    ds_read_b64_tr_b16 a[12:13], v17 offset:0
    buffer_load_dwordx4 v2, s[8:11], s36 offen offset:1024 lds
    v_mfma_f32_16x16x32_bf16 v[156:159], a[68:71], v[76:79], v[156:159]
    ds_read_b64_tr_b16 a[14:15], v17 offset:1024
    v_mfma_f32_16x16x32_bf16 v[160:163], a[72:75], v[64:67], v[160:163]
    ds_read_b64_tr_b16 a[16:17], v18 offset:0
    v_mfma_f32_16x16x32_bf16 v[164:167], a[72:75], v[68:71], v[164:167]
    ds_read_b64_tr_b16 a[18:19], v18 offset:1024
    v_mfma_f32_16x16x32_bf16 v[168:171], a[72:75], v[72:75], v[168:171]
    ds_read_b64_tr_b16 a[20:21], v19 offset:0
    buffer_load_dwordx4 v3, s[8:11], s36 offen offset:2048 lds
    v_mfma_f32_16x16x32_bf16 v[172:175], a[72:75], v[76:79], v[172:175]
    ds_read_b64_tr_b16 a[22:23], v19 offset:1024
    v_mfma_f32_16x16x32_bf16 v[176:179], a[76:79], v[64:67], v[176:179]
    ds_read_b64_tr_b16 a[24:25], v20 offset:0
    v_mfma_f32_16x16x32_bf16 v[180:183], a[76:79], v[68:71], v[180:183]
    ds_read_b64_tr_b16 a[26:27], v20 offset:1024
    v_mfma_f32_16x16x32_bf16 v[184:187], a[76:79], v[72:75], v[184:187]
    ds_read_b64_tr_b16 a[28:29], v21 offset:0
    buffer_load_dwordx4 v4, s[8:11], s36 offen offset:3072 lds
    v_mfma_f32_16x16x32_bf16 v[188:191], a[76:79], v[76:79], v[188:191]
    ds_read_b64_tr_b16 a[30:31], v21 offset:1024
    v_mfma_f32_16x16x32_bf16 v[192:195], a[80:83], v[64:67], v[192:195]
    ds_read_b128 a[96:99], v30 offset:8192
    v_mfma_f32_16x16x32_bf16 v[196:199], a[80:83], v[68:71], v[196:199]
    ds_read_b128 a[100:103], v30 offset:9216
    v_mfma_f32_16x16x32_bf16 v[200:203], a[80:83], v[72:75], v[200:203]
    ds_read_b128 a[104:107], v30 offset:10240
    v_mfma_f32_16x16x32_bf16 v[204:207], a[80:83], v[76:79], v[204:207]
    ds_read_b128 a[108:111], v30 offset:11264
    v_mfma_f32_16x16x32_bf16 v[208:211], a[84:87], v[64:67], v[208:211]
    s_add_u32 s36, s36, 131072
    s_and_b32 s36, s36, 4194303
    v_mfma_f32_16x16x32_bf16 v[212:215], a[84:87], v[68:71], v[212:215]
    s_waitcnt lgkmcnt(4)
    s_add_u32 m0, s40, 0
    v_mfma_f32_16x16x32_bf16 v[216:219], a[84:87], v[72:75], v[216:219]
    buffer_load_dwordx4 v1, s[8:11], s36 offen offset:0 lds
    v_mfma_f32_16x16x32_bf16 v[220:223], a[84:87], v[76:79], v[220:223]
    v_mfma_f32_16x16x32_bf16 v[224:227], a[88:91], v[64:67], v[224:227]
    v_mfma_f32_16x16x32_bf16 v[228:231], a[88:91], v[68:71], v[228:231]
    buffer_load_dwordx4 v2, s[8:11], s36 offen offset:1024 lds
    v_mfma_f32_16x16x32_bf16 v[232:235], a[88:91], v[72:75], v[232:235]
    v_mfma_f32_16x16x32_bf16 v[236:239], a[88:91], v[76:79], v[236:239]
    v_mfma_f32_16x16x32_bf16 v[240:243], a[92:95], v[64:67], v[240:243]
    buffer_load_dwordx4 v3, s[8:11], s36 offen offset:2048 lds
    v_mfma_f32_16x16x32_bf16 v[244:247], a[92:95], v[68:71], v[244:247]
    v_mfma_f32_16x16x32_bf16 v[248:251], a[92:95], v[72:75], v[248:251]
    v_mfma_f32_16x16x32_bf16 v[252:255], a[92:95], v[76:79], v[252:255]
    buffer_load_dwordx4 v4, s[8:11], s36 offen offset:3072 lds
    s_add_u32 s36, s36, 131072
    s_and_b32 s36, s36, 4194303
    s_waitcnt vmcnt(12)
    s_waitcnt lgkmcnt(0)
    v_mfma_f32_16x16x32_bf16 v[128:131], a[0:3], a[96:99], v[128:131]
    ds_read_b64_tr_b16 a[32:33], v14 offset:8192
    s_add_u32 m0, s40, 4096
    v_mfma_f32_16x16x32_bf16 v[132:135], a[0:3], a[100:103], v[132:135]
    ds_read_b64_tr_b16 a[34:35], v14 offset:9216
    v_mfma_f32_16x16x32_bf16 v[136:139], a[0:3], a[104:107], v[136:139]
    ds_read_b64_tr_b16 a[36:37], v15 offset:8192
    buffer_load_dwordx4 v1, s[8:11], s36 offen offset:0 lds
    v_mfma_f32_16x16x32_bf16 v[140:143], a[0:3], a[108:111], v[140:143]
    ds_read_b64_tr_b16 a[38:39], v15 offset:9216
    v_mfma_f32_16x16x32_bf16 v[144:147], a[4:7], a[96:99], v[144:147]
    ds_read_b64_tr_b16 a[40:41], v16 offset:8192
    v_mfma_f32_16x16x32_bf16 v[148:151], a[4:7], a[100:103], v[148:151]
    ds_read_b64_tr_b16 a[42:43], v16 offset:9216
    v_mfma_f32_16x16x32_bf16 v[152:155], a[4:7], a[104:107], v[152:155]
    ds_read_b64_tr_b16 a[44:45], v17 offset:8192
    buffer_load_dwordx4 v2, s[8:11], s36 offen offset:1024 lds
    v_mfma_f32_16x16x32_bf16 v[156:159], a[4:7], a[108:111], v[156:159]
    ds_read_b64_tr_b16 a[46:47], v17 offset:9216
    v_mfma_f32_16x16x32_bf16 v[160:163], a[8:11], a[96:99], v[160:163]
    ds_read_b64_tr_b16 a[48:49], v18 offset:8192
    v_mfma_f32_16x16x32_bf16 v[164:167], a[8:11], a[100:103], v[164:167]
    ds_read_b64_tr_b16 a[50:51], v18 offset:9216
    v_mfma_f32_16x16x32_bf16 v[168:171], a[8:11], a[104:107], v[168:171]
    ds_read_b64_tr_b16 a[52:53], v19 offset:8192
    buffer_load_dwordx4 v3, s[8:11], s36 offen offset:2048 lds
    v_mfma_f32_16x16x32_bf16 v[172:175], a[8:11], a[108:111], v[172:175]
    ds_read_b64_tr_b16 a[54:55], v19 offset:9216
    v_mfma_f32_16x16x32_bf16 v[176:179], a[12:15], a[96:99], v[176:179]
    ds_read_b64_tr_b16 a[56:57], v20 offset:8192
    v_mfma_f32_16x16x32_bf16 v[180:183], a[12:15], a[100:103], v[180:183]
    ds_read_b64_tr_b16 a[58:59], v20 offset:9216
    v_mfma_f32_16x16x32_bf16 v[184:187], a[12:15], a[104:107], v[184:187]
    ds_read_b64_tr_b16 a[60:61], v21 offset:8192
    buffer_load_dwordx4 v4, s[8:11], s36 offen offset:3072 lds
    v_mfma_f32_16x16x32_bf16 v[188:191], a[12:15], a[108:111], v[188:191]
    ds_read_b64_tr_b16 a[62:63], v21 offset:9216
    v_mfma_f32_16x16x32_bf16 v[192:195], a[16:19], a[96:99], v[192:195]
    ds_read_b128 a[112:115], v30 offset:12288
    v_mfma_f32_16x16x32_bf16 v[196:199], a[16:19], a[100:103], v[196:199]
    ds_read_b128 a[116:119], v30 offset:13312
    v_mfma_f32_16x16x32_bf16 v[200:203], a[16:19], a[104:107], v[200:203]
    ds_read_b128 a[120:123], v30 offset:14336
    v_mfma_f32_16x16x32_bf16 v[204:207], a[16:19], a[108:111], v[204:207]
    ds_read_b128 a[124:127], v30 offset:15360
    v_mfma_f32_16x16x32_bf16 v[208:211], a[20:23], a[96:99], v[208:211]
    s_add_u32 s36, s36, 131072
    s_and_b32 s36, s36, 4194303
    v_mfma_f32_16x16x32_bf16 v[212:215], a[20:23], a[100:103], v[212:215]
    s_waitcnt lgkmcnt(4)
    s_add_u32 m0, s40, 8192
    v_mfma_f32_16x16x32_bf16 v[216:219], a[20:23], a[104:107], v[216:219]
    buffer_load_dwordx4 v1, s[8:11], s36 offen offset:0 lds
    v_mfma_f32_16x16x32_bf16 v[220:223], a[20:23], a[108:111], v[220:223]
    v_mfma_f32_16x16x32_bf16 v[224:227], a[24:27], a[96:99], v[224:227]
    v_add_u32 v30, 12288, v30
    v_mfma_f32_16x16x32_bf16 v[228:231], a[24:27], a[100:103], v[228:231]
    buffer_load_dwordx4 v2, s[8:11], s36 offen offset:1024 lds
    v_mfma_f32_16x16x32_bf16 v[232:235], a[24:27], a[104:107], v[232:235]
    v_mfma_f32_16x16x32_bf16 v[236:239], a[24:27], a[108:111], v[236:239]
    v_mfma_f32_16x16x32_bf16 v[240:243], a[28:31], a[96:99], v[240:243]
    buffer_load_dwordx4 v3, s[8:11], s36 offen offset:2048 lds
    v_mfma_f32_16x16x32_bf16 v[244:247], a[28:31], a[100:103], v[244:247]
    v_mfma_f32_16x16x32_bf16 v[248:251], a[28:31], a[104:107], v[248:251]
    v_mfma_f32_16x16x32_bf16 v[252:255], a[28:31], a[108:111], v[252:255]
    buffer_load_dwordx4 v4, s[8:11], s36 offen offset:3072 lds
    s_add_u32 s36, s36, 131072
    s_and_b32 s36, s36, 4194303
    s_sub_u32 s41, s41, 1
    s_cmp_lg_u32 s41, 0
    s_cbranch_scc1 L_g1_loop
    s_waitcnt vmcnt(12)
    s_waitcnt lgkmcnt(0)
    v_mfma_f32_16x16x32_bf16 v[128:131], a[32:35], a[112:115], v[128:131]
    ds_read_b64_tr_b16 a[64:65], v14 offset:16384
    s_add_u32 m0, s40, 12288
    v_mfma_f32_16x16x32_bf16 v[132:135], a[32:35], a[116:119], v[132:135]
    ds_read_b64_tr_b16 a[66:67], v14 offset:17408
    v_mfma_f32_16x16x32_bf16 v[136:139], a[32:35], a[120:123], v[136:139]
    ds_read_b64_tr_b16 a[68:69], v15 offset:16384
    buffer_load_dwordx4 v1, s[8:11], s36 offen offset:0 lds
    v_mfma_f32_16x16x32_bf16 v[140:143], a[32:35], a[124:127], v[140:143]
    ds_read_b64_tr_b16 a[70:71], v15 offset:17408
    v_mfma_f32_16x16x32_bf16 v[144:147], a[36:39], a[112:115], v[144:147]
    ds_read_b64_tr_b16 a[72:73], v16 offset:16384
    v_mfma_f32_16x16x32_bf16 v[148:151], a[36:39], a[116:119], v[148:151]
    ds_read_b64_tr_b16 a[74:75], v16 offset:17408
    v_mfma_f32_16x16x32_bf16 v[152:155], a[36:39], a[120:123], v[152:155]
    ds_read_b64_tr_b16 a[76:77], v17 offset:16384
    buffer_load_dwordx4 v2, s[8:11], s36 offen offset:1024 lds
    v_mfma_f32_16x16x32_bf16 v[156:159], a[36:39], a[124:127], v[156:159]
    ds_read_b64_tr_b16 a[78:79], v17 offset:17408
    v_mfma_f32_16x16x32_bf16 v[160:163], a[40:43], a[112:115], v[160:163]
    ds_read_b64_tr_b16 a[80:81], v18 offset:16384
    v_mfma_f32_16x16x32_bf16 v[164:167], a[40:43], a[116:119], v[164:167]
    ds_read_b64_tr_b16 a[82:83], v18 offset:17408
    v_mfma_f32_16x16x32_bf16 v[168:171], a[40:43], a[120:123], v[168:171]
    ds_read_b64_tr_b16 a[84:85], v19 offset:16384
    buffer_load_dwordx4 v3, s[8:11], s36 offen offset:2048 lds
    v_mfma_f32_16x16x32_bf16 v[172:175], a[40:43], a[124:127], v[172:175]
    ds_read_b64_tr_b16 a[86:87], v19 offset:17408
    v_mfma_f32_16x16x32_bf16 v[176:179], a[44:47], a[112:115], v[176:179]
    ds_read_b64_tr_b16 a[88:89], v20 offset:16384
    v_mfma_f32_16x16x32_bf16 v[180:183], a[44:47], a[116:119], v[180:183]
    ds_read_b64_tr_b16 a[90:91], v20 offset:17408
    v_mfma_f32_16x16x32_bf16 v[184:187], a[44:47], a[120:123], v[184:187]
    ds_read_b64_tr_b16 a[92:93], v21 offset:16384
    buffer_load_dwordx4 v4, s[8:11], s36 offen offset:3072 lds
    v_mfma_f32_16x16x32_bf16 v[188:191], a[44:47], a[124:127], v[188:191]
    ds_read_b64_tr_b16 a[94:95], v21 offset:17408
    v_mfma_f32_16x16x32_bf16 v[192:195], a[48:51], a[112:115], v[192:195]
    ds_read_b128 v[64:67], v30 offset:4096
    v_mfma_f32_16x16x32_bf16 v[196:199], a[48:51], a[116:119], v[196:199]
    ds_read_b128 v[68:71], v30 offset:5120
    v_mfma_f32_16x16x32_bf16 v[200:203], a[48:51], a[120:123], v[200:203]
    ds_read_b128 v[72:75], v30 offset:6144
    v_mfma_f32_16x16x32_bf16 v[204:207], a[48:51], a[124:127], v[204:207]
    ds_read_b128 v[76:79], v30 offset:7168
    v_mfma_f32_16x16x32_bf16 v[208:211], a[52:55], a[112:115], v[208:211]
    s_add_u32 s36, s36, 131072
    s_and_b32 s36, s36, 4194303
    v_mfma_f32_16x16x32_bf16 v[212:215], a[52:55], a[116:119], v[212:215]
    s_waitcnt lgkmcnt(4)
    s_add_u32 m0, s40, 16384
    v_mfma_f32_16x16x32_bf16 v[216:219], a[52:55], a[120:123], v[216:219]
    buffer_load_dwordx4 v1, s[8:11], s36 offen offset:0 lds
    v_mfma_f32_16x16x32_bf16 v[220:223], a[52:55], a[124:127], v[220:223]
    v_mfma_f32_16x16x32_bf16 v[224:227], a[56:59], a[112:115], v[224:227]
    v_mfma_f32_16x16x32_bf16 v[228:231], a[56:59], a[116:119], v[228:231]
    buffer_load_dwordx4 v2, s[8:11], s36 offen offset:1024 lds
    v_mfma_f32_16x16x32_bf16 v[232:235], a[56:59], a[120:123], v[232:235]
    v_mfma_f32_16x16x32_bf16 v[236:239], a[56:59], a[124:127], v[236:239]
    v_mfma_f32_16x16x32_bf16 v[240:243], a[60:63], a[112:115], v[240:243]
    buffer_load_dwordx4 v3, s[8:11], s36 offen offset:2048 lds
    v_mfma_f32_16x16x32_bf16 v[244:247], a[60:63], a[116:119], v[244:247]
    v_mfma_f32_16x16x32_bf16 v[248:251], a[60:63], a[120:123], v[248:251]
    v_mfma_f32_16x16x32_bf16 v[252:255], a[60:63], a[124:127], v[252:255]
    buffer_load_dwordx4 v4, s[8:11], s36 offen offset:3072 lds
    s_add_u32 s36, s36, 131072
    s_and_b32 s36, s36, 4194303
    s_waitcnt vmcnt(12)
    s_waitcnt lgkmcnt(0)
    v_mfma_f32_16x16x32_bf16 v[128:131], a[64:67], v[64:67], v[128:131]
    ds_read_b64_tr_b16 a[0:1], v14 offset:0
    s_add_u32 m0, s40, 20480
    v_mfma_f32_16x16x32_bf16 v[132:135], a[64:67], v[68:71], v[132:135]
    ds_read_b64_tr_b16 a[2:3], v14 offset:1024
    v_mfma_f32_16x16x32_bf16 v[136:139], a[64:67], v[72:75], v[136:139]
    ds_read_b64_tr_b16 a[4:5], v15 offset:0
    buffer_load_dwordx4 v1, s[8:11], s36 offen offset:0 lds
    v_mfma_f32_16x16x32_bf16 v[140:143], a[64:67], v[76:79], v[140:143]
    ds_read_b64_tr_b16 a[6:7], v15 offset:1024
    v_mfma_f32_16x16x32_bf16 v[144:147], a[68:71], v[64:67], v[144:147]
    ds_read_b64_tr_b16 a[8:9], v16 offset:0
    v_mfma_f32_16x16x32_bf16 v[148:151], a[68:71], v[68:71], v[148:151]
    ds_read_b64_tr_b16 a[10:11], v16 offset:1024
    v_mfma_f32_16x16x32_bf16 v[152:155], a[68:71], v[72:75], v[152:155]
    ds_read_b64_tr_b16 a[12:13], v17 offset:0
    buffer_load_dwordx4 v2, s[8:11], s36 offen offset:1024 lds
    v_mfma_f32_16x16x32_bf16 v[156:159], a[68:71], v[76:79], v[156:159]
    ds_read_b64_tr_b16 a[14:15], v17 offset:1024
    v_mfma_f32_16x16x32_bf16 v[160:163], a[72:75], v[64:67], v[160:163]
    ds_read_b64_tr_b16 a[16:17], v18 offset:0
    v_mfma_f32_16x16x32_bf16 v[164:167], a[72:75], v[68:71], v[164:167]
    ds_read_b64_tr_b16 a[18:19], v18 offset:1024
    v_mfma_f32_16x16x32_bf16 v[168:171], a[72:75], v[72:75], v[168:171]
    ds_read_b64_tr_b16 a[20:21], v19 offset:0
    buffer_load_dwordx4 v3, s[8:11], s36 offen offset:2048 lds
    v_mfma_f32_16x16x32_bf16 v[172:175], a[72:75], v[76:79], v[172:175]
    ds_read_b64_tr_b16 a[22:23], v19 offset:1024
    v_mfma_f32_16x16x32_bf16 v[176:179], a[76:79], v[64:67], v[176:179]
    ds_read_b64_tr_b16 a[24:25], v20 offset:0
    v_mfma_f32_16x16x32_bf16 v[180:183], a[76:79], v[68:71], v[180:183]
    ds_read_b64_tr_b16 a[26:27], v20 offset:1024
    v_mfma_f32_16x16x32_bf16 v[184:187], a[76:79], v[72:75], v[184:187]
    ds_read_b64_tr_b16 a[28:29], v21 offset:0
    buffer_load_dwordx4 v4, s[8:11], s36 offen offset:3072 lds
    v_mfma_f32_16x16x32_bf16 v[188:191], a[76:79], v[76:79], v[188:191]
    ds_read_b64_tr_b16 a[30:31], v21 offset:1024
    v_mfma_f32_16x16x32_bf16 v[192:195], a[80:83], v[64:67], v[192:195]
    ds_read_b128 a[96:99], v30 offset:8192
    v_mfma_f32_16x16x32_bf16 v[196:199], a[80:83], v[68:71], v[196:199]
    ds_read_b128 a[100:103], v30 offset:9216
    v_mfma_f32_16x16x32_bf16 v[200:203], a[80:83], v[72:75], v[200:203]
    ds_read_b128 a[104:107], v30 offset:10240
    v_mfma_f32_16x16x32_bf16 v[204:207], a[80:83], v[76:79], v[204:207]
    ds_read_b128 a[108:111], v30 offset:11264
    v_mfma_f32_16x16x32_bf16 v[208:211], a[84:87], v[64:67], v[208:211]
    s_add_u32 s36, s36, 131072
    s_and_b32 s36, s36, 4194303
    v_mfma_f32_16x16x32_bf16 v[212:215], a[84:87], v[68:71], v[212:215]
    s_waitcnt lgkmcnt(4)
    s_add_u32 m0, s40, 0
    v_mfma_f32_16x16x32_bf16 v[216:219], a[84:87], v[72:75], v[216:219]
    buffer_load_dwordx4 v1, s[8:11], s36 offen offset:0 lds
    v_mfma_f32_16x16x32_bf16 v[220:223], a[84:87], v[76:79], v[220:223]
    v_mfma_f32_16x16x32_bf16 v[224:227], a[88:91], v[64:67], v[224:227]
    v_mfma_f32_16x16x32_bf16 v[228:231], a[88:91], v[68:71], v[228:231]
    buffer_load_dwordx4 v2, s[8:11], s36 offen offset:1024 lds
    v_mfma_f32_16x16x32_bf16 v[232:235], a[88:91], v[72:75], v[232:235]
    v_mfma_f32_16x16x32_bf16 v[236:239], a[88:91], v[76:79], v[236:239]
    v_mfma_f32_16x16x32_bf16 v[240:243], a[92:95], v[64:67], v[240:243]
    buffer_load_dwordx4 v3, s[8:11], s36 offen offset:2048 lds
    v_mfma_f32_16x16x32_bf16 v[244:247], a[92:95], v[68:71], v[244:247]
    v_mfma_f32_16x16x32_bf16 v[248:251], a[92:95], v[72:75], v[248:251]
    v_mfma_f32_16x16x32_bf16 v[252:255], a[92:95], v[76:79], v[252:255]
    buffer_load_dwordx4 v4, s[8:11], s36 offen offset:3072 lds
    s_add_u32 s36, s36, 131072
    s_and_b32 s36, s36, 4194303
    s_waitcnt vmcnt(12)
    s_waitcnt lgkmcnt(0)
    v_mfma_f32_16x16x32_bf16 v[128:131], a[0:3], a[96:99], v[128:131]
    ds_read_b64_tr_b16 a[32:33], v14 offset:8192
    s_add_u32 m0, s40, 4096
    v_mfma_f32_16x16x32_bf16 v[132:135], a[0:3], a[100:103], v[132:135]
    ds_read_b64_tr_b16 a[34:35], v14 offset:9216
    v_mfma_f32_16x16x32_bf16 v[136:139], a[0:3], a[104:107], v[136:139]
    ds_read_b64_tr_b16 a[36:37], v15 offset:8192
    buffer_load_dwordx4 v1, s[8:11], s36 offen offset:0 lds
    v_mfma_f32_16x16x32_bf16 v[140:143], a[0:3], a[108:111], v[140:143]
    ds_read_b64_tr_b16 a[38:39], v15 offset:9216
    v_mfma_f32_16x16x32_bf16 v[144:147], a[4:7], a[96:99], v[144:147]
    ds_read_b64_tr_b16 a[40:41], v16 offset:8192
    v_mfma_f32_16x16x32_bf16 v[148:151], a[4:7], a[100:103], v[148:151]
    ds_read_b64_tr_b16 a[42:43], v16 offset:9216
    v_mfma_f32_16x16x32_bf16 v[152:155], a[4:7], a[104:107], v[152:155]
    ds_read_b64_tr_b16 a[44:45], v17 offset:8192
    buffer_load_dwordx4 v2, s[8:11], s36 offen offset:1024 lds
    v_mfma_f32_16x16x32_bf16 v[156:159], a[4:7], a[108:111], v[156:159]
    ds_read_b64_tr_b16 a[46:47], v17 offset:9216
    v_mfma_f32_16x16x32_bf16 v[160:163], a[8:11], a[96:99], v[160:163]
    ds_read_b64_tr_b16 a[48:49], v18 offset:8192
    v_mfma_f32_16x16x32_bf16 v[164:167], a[8:11], a[100:103], v[164:167]
    ds_read_b64_tr_b16 a[50:51], v18 offset:9216
    v_mfma_f32_16x16x32_bf16 v[168:171], a[8:11], a[104:107], v[168:171]
    ds_read_b64_tr_b16 a[52:53], v19 offset:8192
    buffer_load_dwordx4 v3, s[8:11], s36 offen offset:2048 lds
    v_mfma_f32_16x16x32_bf16 v[172:175], a[8:11], a[108:111], v[172:175]
    ds_read_b64_tr_b16 a[54:55], v19 offset:9216
    v_mfma_f32_16x16x32_bf16 v[176:179], a[12:15], a[96:99], v[176:179]
    ds_read_b64_tr_b16 a[56:57], v20 offset:8192
    v_mfma_f32_16x16x32_bf16 v[180:183], a[12:15], a[100:103], v[180:183]
    ds_read_b64_tr_b16 a[58:59], v20 offset:9216
    v_mfma_f32_16x16x32_bf16 v[184:187], a[12:15], a[104:107], v[184:187]
    ds_read_b64_tr_b16 a[60:61], v21 offset:8192
    buffer_load_dwordx4 v4, s[8:11], s36 offen offset:3072 lds
    v_mfma_f32_16x16x32_bf16 v[188:191], a[12:15], a[108:111], v[188:191]
    ds_read_b64_tr_b16 a[62:63], v21 offset:9216
    v_mfma_f32_16x16x32_bf16 v[192:195], a[16:19], a[96:99], v[192:195]
    ds_read_b128 a[112:115], v30 offset:12288
    v_mfma_f32_16x16x32_bf16 v[196:199], a[16:19], a[100:103], v[196:199]
    ds_read_b128 a[116:119], v30 offset:13312
    v_mfma_f32_16x16x32_bf16 v[200:203], a[16:19], a[104:107], v[200:203]
    ds_read_b128 a[120:123], v30 offset:14336
    v_mfma_f32_16x16x32_bf16 v[204:207], a[16:19], a[108:111], v[204:207]
    ds_read_b128 a[124:127], v30 offset:15360
    v_mfma_f32_16x16x32_bf16 v[208:211], a[20:23], a[96:99], v[208:211]
    s_add_u32 s36, s36, 131072
    s_and_b32 s36, s36, 4194303
    v_mfma_f32_16x16x32_bf16 v[212:215], a[20:23], a[100:103], v[212:215]
    s_waitcnt lgkmcnt(4)
    s_add_u32 m0, s40, 8192
    v_mfma_f32_16x16x32_bf16 v[216:219], a[20:23], a[104:107], v[216:219]
    buffer_load_dwordx4 v9, s[12:15], s38 offen offset:0 lds
    v_mfma_f32_16x16x32_bf16 v[220:223], a[20:23], a[108:111], v[220:223]
    v_mfma_f32_16x16x32_bf16 v[224:227], a[24:27], a[96:99], v[224:227]
    v_mfma_f32_16x16x32_bf16 v[228:231], a[24:27], a[100:103], v[228:231]
    buffer_load_dwordx4 v10, s[12:15], s38 offen offset:1024 lds
    v_mfma_f32_16x16x32_bf16 v[232:235], a[24:27], a[104:107], v[232:235]
    v_mfma_f32_16x16x32_bf16 v[236:239], a[24:27], a[108:111], v[236:239]
    v_mfma_f32_16x16x32_bf16 v[240:243], a[28:31], a[96:99], v[240:243]
    buffer_load_dwordx4 v11, s[12:15], s38 offen offset:2048 lds
    v_mfma_f32_16x16x32_bf16 v[244:247], a[28:31], a[100:103], v[244:247]
    v_mfma_f32_16x16x32_bf16 v[248:251], a[28:31], a[104:107], v[248:251]
    v_mfma_f32_16x16x32_bf16 v[252:255], a[28:31], a[108:111], v[252:255]
    buffer_load_dwordx4 v12, s[12:15], s38 offen offset:3072 lds
    s_add_u32 s38, s38, 16384
    s_and_b32 s38, s38, 131071
    s_waitcnt vmcnt(12)
    s_waitcnt lgkmcnt(0)
    v_mfma_f32_16x16x32_bf16 v[128:131], a[32:35], a[112:115], v[128:131]
    ds_read_b64_tr_b16 a[64:65], v14 offset:16384
    s_add_u32 s52, s24, 16777216
    s_addc_u32 s53, s25, 0
    v_mfma_f32_16x16x32_bf16 v[132:135], a[32:35], a[116:119], v[132:135]
    ds_read_b64_tr_b16 a[66:67], v14 offset:17408
    s_add_u32 m0, s40, 12288
    s_mov_b32 s54, 8192
    v_mfma_f32_16x16x32_bf16 v[136:139], a[32:35], a[120:123], v[136:139]
    ds_read_b64_tr_b16 a[68:69], v15 offset:16384
    buffer_load_dwordx4 v13, s[16:19], s39 offen offset:0 lds
    s_mov_b32 s55, 0x20000
    v_mfma_f32_16x16x32_bf16 v[140:143], a[32:35], a[124:127], v[140:143]
    ds_read_b64_tr_b16 a[70:71], v15 offset:17408
    s_add_u32 s56, s24, 16785408
    s_addc_u32 s57, s25, 0
    v_mfma_f32_16x16x32_bf16 v[144:147], a[36:39], a[112:115], v[144:147]
    ds_read_b64_tr_b16 a[72:73], v16 offset:16384
    s_mov_b32 s58, 8192
    v_mfma_f32_16x16x32_bf16 v[148:151], a[36:39], a[116:119], v[148:151]
    ds_read_b64_tr_b16 a[74:75], v16 offset:17408
    s_mov_b32 s59, 0x20000
    v_mfma_f32_16x16x32_bf16 v[152:155], a[36:39], a[120:123], v[152:155]
    ds_read_b64_tr_b16 a[76:77], v17 offset:16384
    buffer_load_dwordx4 v13, s[16:19], s39 offen offset:1024 lds
    s_lshl_b32 s44, s33, 6
    v_mfma_f32_16x16x32_bf16 v[156:159], a[36:39], a[124:127], v[156:159]
    ds_read_b64_tr_b16 a[78:79], v17 offset:17408
    s_lshl_b32 s43, s34, 4
    v_mfma_f32_16x16x32_bf16 v[160:163], a[40:43], a[112:115], v[160:163]
    ds_read_b64_tr_b16 a[80:81], v18 offset:16384
    s_add_u32 s44, s44, s43
    v_mfma_f32_16x16x32_bf16 v[164:167], a[40:43], a[116:119], v[164:167]
    ds_read_b64_tr_b16 a[82:83], v18 offset:17408
    v_add_u32 v58, s44, v0
    v_mfma_f32_16x16x32_bf16 v[168:171], a[40:43], a[120:123], v[168:171]
    ds_read_b64_tr_b16 a[84:85], v19 offset:16384
    buffer_load_dwordx4 v13, s[16:19], s39 offen offset:2048 lds
    v_lshlrev_b32 v58, 2, v58
    v_mfma_f32_16x16x32_bf16 v[172:175], a[40:43], a[124:127], v[172:175]
    ds_read_b64_tr_b16 a[86:87], v19 offset:17408
    v_cmp_gt_u32 vcc, 16, v0
    v_mfma_f32_16x16x32_bf16 v[176:179], a[44:47], a[112:115], v[176:179]
    ds_read_b64_tr_b16 a[88:89], v20 offset:16384
    s_cmp_eq_u32 s32, 0
    s_cselect_b64 s[64:65], -1, 0
    v_mfma_f32_16x16x32_bf16 v[180:183], a[44:47], a[116:119], v[180:183]
    ds_read_b64_tr_b16 a[90:91], v20 offset:17408
    v_mov_b32 v60, 0x7ffffff0
    v_mfma_f32_16x16x32_bf16 v[184:187], a[44:47], a[120:123], v[184:187]
    ds_read_b64_tr_b16 a[92:93], v21 offset:16384
    buffer_load_dwordx4 v13, s[16:19], s39 offen offset:3072 lds
    s_add_u32 s39, s39, 16384
    s_and_b32 s39, s39, 131071
    s_and_b64 vcc, vcc, s[64:65]
    v_mfma_f32_16x16x32_bf16 v[188:191], a[44:47], a[124:127], v[188:191]
    ds_read_b64_tr_b16 a[94:95], v21 offset:17408
    v_cndmask_b32 v58, v60, v58, vcc
    v_mfma_f32_16x16x32_bf16 v[192:195], a[48:51], a[112:115], v[192:195]
    ds_read_b128 v[64:67], v30 offset:16384
    buffer_store_dword v59, v58, s[52:55], 0 offen sc1
    v_mfma_f32_16x16x32_bf16 v[196:199], a[48:51], a[116:119], v[196:199]
    ds_read_b128 v[68:71], v30 offset:17408
    buffer_store_dword v31, v58, s[56:59], 0 offen sc1
    v_mfma_f32_16x16x32_bf16 v[200:203], a[48:51], a[120:123], v[200:203]
    ds_read_b128 v[72:75], v30 offset:18432
    s_lshl_b32 s44, s33, 3
    v_mfma_f32_16x16x32_bf16 v[204:207], a[48:51], a[124:127], v[204:207]
    ds_read_b128 v[76:79], v30 offset:19456
    s_add_u32 s44, s44, s32
    v_mfma_f32_16x16x32_bf16 v[208:211], a[52:55], a[112:115], v[208:211]
    s_lshl_b32 s44, s44, 2
    v_mfma_f32_16x16x32_bf16 v[212:215], a[52:55], a[116:119], v[212:215]
    s_waitcnt lgkmcnt(4)
    s_add_u32 m0, s40, 16384
    s_add_u32 s44, s44, 16809984
    v_mfma_f32_16x16x32_bf16 v[216:219], a[52:55], a[120:123], v[216:219]
    buffer_load_dwordx4 v9, s[12:15], s38 offen offset:0 lds
    s_cmp_eq_u32 s34, 0
    s_cselect_b32 s44, s44, 0x7fff0000
    v_mfma_f32_16x16x32_bf16 v[220:223], a[52:55], a[124:127], v[220:223]
    v_lshlrev_b32 v58, 10, v0
    v_mfma_f32_16x16x32_bf16 v[224:227], a[56:59], a[112:115], v[224:227]
    v_add_u32 v58, s44, v58
    v_mfma_f32_16x16x32_bf16 v[228:231], a[56:59], a[116:119], v[228:231]
    buffer_load_dwordx4 v10, s[12:15], s38 offen offset:1024 lds
    v_mov_b32 v60, 0x7fff0000
    v_mfma_f32_16x16x32_bf16 v[232:235], a[56:59], a[120:123], v[232:235]
    v_cmp_gt_u32 vcc, 9, v0
    v_mfma_f32_16x16x32_bf16 v[236:239], a[56:59], a[124:127], v[236:239]
    v_mov_b32 v61, 0
    v_mfma_f32_16x16x32_bf16 v[240:243], a[60:63], a[112:115], v[240:243]
    buffer_load_dwordx4 v11, s[12:15], s38 offen offset:2048 lds
    s_nop 0
    v_mfma_f32_16x16x32_bf16 v[244:247], a[60:63], a[116:119], v[244:247]
    v_cndmask_b32 v58, v60, v58, vcc
    v_mfma_f32_16x16x32_bf16 v[248:251], a[60:63], a[120:123], v[248:251]
    buffer_store_dword v61, v58, s[24:27], 0 offen sc1
    v_mfma_f32_16x16x32_bf16 v[252:255], a[60:63], a[124:127], v[252:255]
    buffer_load_dwordx4 v12, s[12:15], s38 offen offset:3072 lds
    s_add_u32 s38, s38, 16384
    s_and_b32 s38, s38, 131071
    s_waitcnt vmcnt(15)
    s_waitcnt lgkmcnt(0)
    v_mfma_f32_16x16x32_bf16 v[128:131], a[64:67], v[64:67], v[128:131]
    ds_read_b64_tr_b16 a[0:1], v14 offset:0
    v_mov_b32 v52, 0
    v_mfma_f32_16x16x32_bf16 v[132:135], a[64:67], v[68:71], v[132:135]
    ds_read_b64_tr_b16 a[2:3], v14 offset:1024
    v_mov_b32 v53, 0
    v_mfma_f32_16x16x32_bf16 v[136:139], a[64:67], v[72:75], v[136:139]
    ds_read_b64_tr_b16 a[4:5], v15 offset:0
    v_mov_b32 v54, 0
    v_mfma_f32_16x16x32_bf16 v[140:143], a[64:67], v[76:79], v[140:143]
    ds_read_b64_tr_b16 a[6:7], v15 offset:1024
    v_mov_b32 v55, 0
    v_mfma_f32_16x16x32_bf16 v[144:147], a[68:71], v[64:67], v[144:147]
    ds_read_b64_tr_b16 a[8:9], v16 offset:0
    v_mov_b32 v44, v9
    v_mfma_f32_16x16x32_bf16 v[148:151], a[68:71], v[68:71], v[148:151]
    ds_read_b64_tr_b16 a[10:11], v16 offset:1024
    v_mov_b32 v48, v13
    v_mfma_f32_16x16x32_bf16 v[152:155], a[68:71], v[72:75], v[152:155]
    ds_read_b64_tr_b16 a[12:13], v17 offset:0
    v_mov_b32 v45, v10
    v_mfma_f32_16x16x32_bf16 v[156:159], a[68:71], v[76:79], v[156:159]
    ds_read_b64_tr_b16 a[14:15], v17 offset:1024
    v_mov_b32 v49, v13
    v_mfma_f32_16x16x32_bf16 v[160:163], a[72:75], v[64:67], v[160:163]
    ds_read_b64_tr_b16 a[16:17], v18 offset:0
    v_mov_b32 v46, v11
    v_mfma_f32_16x16x32_bf16 v[164:167], a[72:75], v[68:71], v[164:167]
    ds_read_b64_tr_b16 a[18:19], v18 offset:1024
    v_mov_b32 v50, v13
    v_mfma_f32_16x16x32_bf16 v[168:171], a[72:75], v[72:75], v[168:171]
    ds_read_b64_tr_b16 a[20:21], v19 offset:0
    v_mov_b32 v47, v12
    v_mfma_f32_16x16x32_bf16 v[172:175], a[72:75], v[76:79], v[172:175]
    ds_read_b64_tr_b16 a[22:23], v19 offset:1024
    v_mov_b32 v51, v13
    v_mfma_f32_16x16x32_bf16 v[176:179], a[76:79], v[64:67], v[176:179]
    ds_read_b64_tr_b16 a[24:25], v20 offset:0
    s_mov_b32 s70, 0
    v_mfma_f32_16x16x32_bf16 v[180:183], a[76:79], v[68:71], v[180:183]
    ds_read_b64_tr_b16 a[26:27], v20 offset:1024
    v_mov_b32 v31, v32
    v_mfma_f32_16x16x32_bf16 v[184:187], a[76:79], v[72:75], v[184:187]
    ds_read_b64_tr_b16 a[28:29], v21 offset:0
    v_mov_b32 v63, v40
    v_mfma_f32_16x16x32_bf16 v[188:191], a[76:79], v[76:79], v[188:191]
    ds_read_b64_tr_b16 a[30:31], v21 offset:1024
    s_min_u32 s98, s2, 223
    v_mfma_f32_16x16x32_bf16 v[192:195], a[80:83], v[64:67], v[192:195]
    ds_read_b128 a[96:99], v30 offset:20480
    s_lshl_b32 s44, s34, 7
    v_mfma_f32_16x16x32_bf16 v[196:199], a[80:83], v[68:71], v[196:199]
    ds_read_b128 a[100:103], v30 offset:21504
    v_add_u32 v3, s44, v0
    v_mfma_f32_16x16x32_bf16 v[200:203], a[80:83], v[72:75], v[200:203]
    ds_read_b128 a[104:107], v30 offset:22528
    v_mul_u32_u24 v3, 3584, v3
    v_mfma_f32_16x16x32_bf16 v[204:207], a[80:83], v[76:79], v[204:207]
    ds_read_b128 a[108:111], v30 offset:23552
    s_lshl_b32 s44, s98, 4
    v_mfma_f32_16x16x32_bf16 v[208:211], a[84:87], v[64:67], v[208:211]
    v_add_u32 v3, s44, v3
    v_mfma_f32_16x16x32_bf16 v[212:215], a[84:87], v[68:71], v[212:215]
    v_lshrrev_b32 v4, 4, v0
    v_mfma_f32_16x16x32_bf16 v[216:219], a[84:87], v[72:75], v[216:219]
    v_lshlrev_b32 v2, 1, v4
    v_mfma_f32_16x16x32_bf16 v[220:223], a[84:87], v[76:79], v[220:223]
    v_lshlrev_b32 v4, 10, v4
    v_mfma_f32_16x16x32_bf16 v[224:227], a[88:91], v[64:67], v[224:227]
    v_xor_b32 v2, v2, v0
    v_mfma_f32_16x16x32_bf16 v[228:231], a[88:91], v[68:71], v[228:231]
    v_and_b32 v2, 15, v2
    v_mfma_f32_16x16x32_bf16 v[232:235], a[88:91], v[72:75], v[232:235]
    v_lshl_add_u32 v4, v2, 4, v4
    v_mfma_f32_16x16x32_bf16 v[236:239], a[88:91], v[76:79], v[236:239]
    s_lshl_b32 s44, s98, 13
    v_mfma_f32_16x16x32_bf16 v[240:243], a[92:95], v[64:67], v[240:243]
    s_lshl_b32 s43, s34, 8
    v_mfma_f32_16x16x32_bf16 v[244:247], a[92:95], v[68:71], v[244:247]
    s_add_u32 s44, s44, s43
    v_mfma_f32_16x16x32_bf16 v[248:251], a[92:95], v[72:75], v[248:251]
    v_add_u32 v4, s44, v4
    v_mfma_f32_16x16x32_bf16 v[252:255], a[92:95], v[76:79], v[252:255]
    s_waitcnt lgkmcnt(0)
    v_mfma_f32_16x16x32_bf16 v[128:131], a[0:3], a[96:99], v[128:131]
    s_add_u32 m0, s40, 20480
    v_mfma_f32_16x16x32_bf16 v[132:135], a[0:3], a[100:103], v[132:135]
    buffer_load_dwordx4 v13, s[16:19], s39 offen offset:0 lds
    v_mfma_f32_16x16x32_bf16 v[136:139], a[0:3], a[104:107], v[136:139]
    buffer_load_dwordx4 v13, s[16:19], s39 offen offset:1024 lds
    v_mfma_f32_16x16x32_bf16 v[140:143], a[0:3], a[108:111], v[140:143]
    buffer_load_dwordx4 v13, s[16:19], s39 offen offset:2048 lds
    v_mfma_f32_16x16x32_bf16 v[144:147], a[4:7], a[96:99], v[144:147]
    buffer_load_dwordx4 v13, s[16:19], s39 offen offset:3072 lds
    s_add_u32 s39, s39, 16384
    s_and_b32 s39, s39, 131071
    v_mfma_f32_16x16x32_bf16 v[148:151], a[4:7], a[100:103], v[148:151]
    s_add_u32 m0, s40, 0
    v_mfma_f32_16x16x32_bf16 v[152:155], a[4:7], a[104:107], v[152:155]
    buffer_load_dwordx4 v9, s[12:15], s38 offen offset:0 lds
    v_mfma_f32_16x16x32_bf16 v[156:159], a[4:7], a[108:111], v[156:159]
    buffer_load_dwordx4 v10, s[12:15], s38 offen offset:1024 lds
    v_mfma_f32_16x16x32_bf16 v[160:163], a[8:11], a[96:99], v[160:163]
    buffer_load_dwordx4 v11, s[12:15], s38 offen offset:2048 lds
    v_cvt_pk_bf16_f32 v64, v128, v129
    v_mfma_f32_16x16x32_bf16 v[164:167], a[8:11], a[100:103], v[164:167]
    buffer_load_dwordx4 v12, s[12:15], s38 offen offset:3072 lds
    s_add_u32 s38, s38, 16384
    s_and_b32 s38, s38, 131071
    v_mfma_f32_16x16x32_bf16 v[168:171], a[8:11], a[104:107], v[168:171]
    buffer_load_dword a41, v13, s[16:19], 0 offen
    v_cvt_pk_bf16_f32 v65, v130, v131
    v_mfma_f32_16x16x32_bf16 v[172:175], a[8:11], a[108:111], v[172:175]
    v_cvt_pk_bf16_f32 v66, v132, v133
    v_cvt_pk_bf16_f32 v67, v134, v135
    v_mfma_f32_16x16x32_bf16 v[176:179], a[12:15], a[96:99], v[176:179]
    v_cvt_pk_bf16_f32 v68, v136, v137
    v_cvt_pk_bf16_f32 v69, v138, v139
    v_mfma_f32_16x16x32_bf16 v[180:183], a[12:15], a[100:103], v[180:183]
    v_cvt_pk_bf16_f32 v70, v140, v141
    v_cvt_pk_bf16_f32 v71, v142, v143
    v_mfma_f32_16x16x32_bf16 v[184:187], a[12:15], a[104:107], v[184:187]
    v_permlane16_swap_b32 v64, v66
    v_permlane16_swap_b32 v65, v67
    v_mfma_f32_16x16x32_bf16 v[188:191], a[12:15], a[108:111], v[188:191]
    v_permlane16_swap_b32 v68, v70
    v_mfma_f32_16x16x32_bf16 v[192:195], a[16:19], a[96:99], v[192:195]
    v_permlane16_swap_b32 v69, v71
    v_cvt_pk_bf16_f32 v72, v144, v145
    v_mfma_f32_16x16x32_bf16 v[196:199], a[16:19], a[100:103], v[196:199]
    v_cvt_pk_bf16_f32 v73, v146, v147
    v_cvt_pk_bf16_f32 v74, v148, v149
    v_mfma_f32_16x16x32_bf16 v[200:203], a[16:19], a[104:107], v[200:203]
    v_cvt_pk_bf16_f32 v75, v150, v151
    v_cvt_pk_bf16_f32 v76, v152, v153
    v_mfma_f32_16x16x32_bf16 v[204:207], a[16:19], a[108:111], v[204:207]
    v_cvt_pk_bf16_f32 v77, v154, v155
    v_cvt_pk_bf16_f32 v78, v156, v157
    v_mfma_f32_16x16x32_bf16 v[208:211], a[20:23], a[96:99], v[208:211]
    v_cvt_pk_bf16_f32 v79, v158, v159
    v_permlane16_swap_b32 v72, v74
    v_mfma_f32_16x16x32_bf16 v[212:215], a[20:23], a[100:103], v[212:215]
    v_permlane16_swap_b32 v73, v75
    v_permlane16_swap_b32 v76, v78
    v_mfma_f32_16x16x32_bf16 v[216:219], a[20:23], a[104:107], v[216:219]
    v_permlane16_swap_b32 v77, v79
    v_cvt_pk_bf16_f32 v80, v160, v161
    v_mfma_f32_16x16x32_bf16 v[220:223], a[20:23], a[108:111], v[220:223]
    v_cvt_pk_bf16_f32 v81, v162, v163
    v_cvt_pk_bf16_f32 v82, v164, v165
    v_mfma_f32_16x16x32_bf16 v[224:227], a[24:27], a[96:99], v[224:227]
    v_cvt_pk_bf16_f32 v83, v166, v167
    v_cvt_pk_bf16_f32 v84, v168, v169
    v_mfma_f32_16x16x32_bf16 v[228:231], a[24:27], a[100:103], v[228:231]
    v_cvt_pk_bf16_f32 v85, v170, v171
    v_cvt_pk_bf16_f32 v86, v172, v173
    v_mfma_f32_16x16x32_bf16 v[232:235], a[24:27], a[104:107], v[232:235]
    v_cvt_pk_bf16_f32 v87, v174, v175
    v_permlane16_swap_b32 v80, v82
    v_mfma_f32_16x16x32_bf16 v[236:239], a[24:27], a[108:111], v[236:239]
    v_permlane16_swap_b32 v81, v83
    v_permlane16_swap_b32 v84, v86
    v_mfma_f32_16x16x32_bf16 v[240:243], a[28:31], a[96:99], v[240:243]
    v_permlane16_swap_b32 v85, v87
    v_cvt_pk_bf16_f32 v88, v176, v177
    v_mfma_f32_16x16x32_bf16 v[244:247], a[28:31], a[100:103], v[244:247]
    v_cvt_pk_bf16_f32 v89, v178, v179
    v_cvt_pk_bf16_f32 v90, v180, v181
    v_mfma_f32_16x16x32_bf16 v[248:251], a[28:31], a[104:107], v[248:251]
    v_cvt_pk_bf16_f32 v91, v182, v183
    v_cvt_pk_bf16_f32 v92, v184, v185
    v_mfma_f32_16x16x32_bf16 v[252:255], a[28:31], a[108:111], v[252:255]
    v_cvt_pk_bf16_f32 v93, v186, v187
    v_cvt_pk_bf16_f32 v94, v188, v189
    s_nop 7
    v_cvt_pk_bf16_f32 v95, v190, v191
    v_permlane16_swap_b32 v88, v90
    v_permlane16_swap_b32 v89, v91
    v_permlane16_swap_b32 v92, v94
    s_nop 0
    v_permlane16_swap_b32 v93, v95
    v_cvt_pk_bf16_f32 v96, v192, v193
    v_cvt_pk_bf16_f32 v97, v194, v195
    v_cvt_pk_bf16_f32 v98, v196, v197
    v_cvt_pk_bf16_f32 v99, v198, v199
    v_cvt_pk_bf16_f32 v100, v200, v201
    v_cvt_pk_bf16_f32 v101, v202, v203
    v_cvt_pk_bf16_f32 v102, v204, v205
    v_cvt_pk_bf16_f32 v103, v206, v207
    v_permlane16_swap_b32 v96, v98
    v_permlane16_swap_b32 v97, v99
    v_permlane16_swap_b32 v100, v102
    s_nop 0
    v_permlane16_swap_b32 v101, v103
    v_cvt_pk_bf16_f32 v104, v208, v209
    v_cvt_pk_bf16_f32 v105, v210, v211
    v_cvt_pk_bf16_f32 v106, v212, v213
    v_cvt_pk_bf16_f32 v107, v214, v215
    v_cvt_pk_bf16_f32 v108, v216, v217
    v_cvt_pk_bf16_f32 v109, v218, v219
    v_cvt_pk_bf16_f32 v110, v220, v221
    v_cvt_pk_bf16_f32 v111, v222, v223
    v_permlane16_swap_b32 v104, v106
    v_permlane16_swap_b32 v105, v107
    v_permlane16_swap_b32 v108, v110
    s_nop 0
    v_permlane16_swap_b32 v109, v111
    v_cvt_pk_bf16_f32 v112, v224, v225
    v_cvt_pk_bf16_f32 v113, v226, v227
    v_cvt_pk_bf16_f32 v114, v228, v229
    v_cvt_pk_bf16_f32 v115, v230, v231
    v_cvt_pk_bf16_f32 v116, v232, v233
    v_cvt_pk_bf16_f32 v117, v234, v235
    v_cvt_pk_bf16_f32 v118, v236, v237
    v_cvt_pk_bf16_f32 v119, v238, v239
    v_permlane16_swap_b32 v112, v114
    v_permlane16_swap_b32 v113, v115
    v_permlane16_swap_b32 v116, v118
    s_nop 0
    v_permlane16_swap_b32 v117, v119
    v_cvt_pk_bf16_f32 v120, v240, v241
    v_cvt_pk_bf16_f32 v121, v242, v243
    v_cvt_pk_bf16_f32 v122, v244, v245
    v_cvt_pk_bf16_f32 v123, v246, v247
    v_cvt_pk_bf16_f32 v124, v248, v249
    v_cvt_pk_bf16_f32 v125, v250, v251
    v_cvt_pk_bf16_f32 v126, v252, v253
    v_cvt_pk_bf16_f32 v127, v254, v255
    v_permlane16_swap_b32 v120, v122
    v_permlane16_swap_b32 v121, v123
    v_permlane16_swap_b32 v124, v126
    s_nop 0
    v_permlane16_swap_b32 v125, v127
    v_mov_b32 v224, 0
    v_mov_b32 v225, 0
    v_mov_b32 v226, 0
    v_mov_b32 v227, 0
    v_mov_b32 v228, 0
    v_mov_b32 v229, 0
    v_mov_b32 v230, 0
    v_mov_b32 v231, 0
    v_mov_b32 v232, 0
    v_mov_b32 v233, 0
    v_mov_b32 v234, 0
    v_mov_b32 v235, 0
    v_mov_b32 v236, 0
    v_mov_b32 v237, 0
    v_mov_b32 v238, 0
    v_mov_b32 v239, 0
    v_mov_b32 v240, 0
    v_mov_b32 v241, 0
    v_mov_b32 v242, 0
    v_mov_b32 v243, 0
    v_mov_b32 v244, 0
    v_mov_b32 v245, 0
    v_mov_b32 v246, 0
    v_mov_b32 v247, 0
    v_mov_b32 v248, 0
    v_mov_b32 v249, 0
    v_mov_b32 v250, 0
    v_mov_b32 v251, 0
    v_mov_b32 v252, 0
    v_mov_b32 v253, 0
    v_mov_b32 v254, 0
    v_mov_b32 v255, 0
L_p2_start:
    s_mov_b32 s52, s12
    s_mov_b32 s53, s13
    s_mov_b32 s54, s14
    s_mov_b32 s56, s16
    s_mov_b32 s57, s17
    s_mov_b32 s58, s18
    s_mov_b32 s46, 16384
    s_mov_b32 s47, 8192
    s_mov_b32 s50, 1
    s_add_u32 s62, s40, 8192
    s_add_u32 s63, s40, 4096
    s_lshl_b32 s60, s34, 13
    s_mov_b32 s66, 229376
    s_mov_b32 s10, 1835008
    v_bfe_u32 v61, v0, 2, 2
    v_lshrrev_b32 v59, 4, v0
    v_lshl_add_u32 v60, v59, 3, v61
    v_lshlrev_b32 v60, 4, v60
    v_and_b32 v62, 1, v0
    v_lshl_add_u32 v60, v62, 3, v60
    v_bfe_u32 v62, v0, 1, 1
    v_lshl_add_u32 v60, v62, 11, v60
    s_lshl_b32 s42, s34, 13
    v_add_u32 v60, s42, v60
    v_and_b32 v59, 1, v59
    v_lshl_add_u32 v59, v59, 2, v61
    v_lshlrev_b32 v59, 8, v59
    v_lshlrev_b32 v61, 5, v61
    v_or_b32 v61, v61, v59
    v_bfe_u32 v59, v0, 1, 1
    v_lshl_add_u32 v61, v59, 4, v61
    v_and_b32 v59, 1, v0
    v_lshl_add_u32 v61, v59, 3, v61
    v_add_u32 v61, s42, v61
    s_and_b32 s42, s33, 15
    s_lshl_b32 s42, s42, 2
    s_add_u32 s42, s42, s34
    s_lshl_b32 s42, s42, 13
    v_lshlrev_b32 v62, 7, v0
    v_add_u32 v62, s42, v62
    s_waitcnt vmcnt(9) lgkmcnt(0)
    s_barrier
    ds_read_b128 a[0:3], v32 offset:0
    ds_read_b128 a[4:7], v33 offset:0
    ds_read_b128 a[8:11], v34 offset:0
    ds_read_b128 a[12:15], v35 offset:0
    s_or_b32 s42, 0, s34
    s_or_b32 s42, s42, s70
    s_cmp_lg_u32 s42, 0
    s_cbranch_scc1 L_nopub
    v_mov_b32 v58, 0
    v_mov_b32 v59, 1
    v_cmp_eq_u32 vcc, 0, v0
    s_nop 0
    s_and_saveexec_b64 s[64:65], vcc
    global_atomic_add v58, v59, s[72:73] sc1
    s_mov_b64 exec, s[64:65]
L_nopub:
    v_xor_b32 v58, 32, v61
    v_xor_b32 v59, 64, v61
    v_xor_b32 v2, 96, v61
    s_waitcnt lgkmcnt(2)
    v_mfma_f32_32x32x16_bf16 v[128:143], a[0:3], v[64:67], v[224:239]
    v_accvgpr_write_b32 a128, 0
    v_accvgpr_write_b32 a129, 0
    v_accvgpr_write_b32 a130, 0
    v_accvgpr_write_b32 a131, 0
    v_mfma_f32_32x32x16_bf16 v[144:159], a[0:3], v[68:71], v[240:255]
    ds_read_b128 a[16:19], v36 offset:0
    v_accvgpr_write_b32 a132, 0
    v_accvgpr_write_b32 a133, 0
    v_accvgpr_write_b32 a134, 0
    v_accvgpr_write_b32 a135, 0
    v_mfma_f32_32x32x16_bf16 v[128:143], a[4:7], v[72:75], v[128:143]
    v_accvgpr_write_b32 a136, 0
    v_accvgpr_write_b32 a137, 0
    v_accvgpr_write_b32 a138, 0
    v_accvgpr_write_b32 a139, 0
    v_mfma_f32_32x32x16_bf16 v[144:159], a[4:7], v[76:79], v[144:159]
    ds_read_b128 a[20:23], v37 offset:0
    v_accvgpr_write_b32 a140, 0
    v_accvgpr_write_b32 a141, 0
    v_accvgpr_write_b32 a142, 0
    v_accvgpr_write_b32 a143, 0
    s_waitcnt lgkmcnt(2)
    v_mfma_f32_32x32x16_bf16 v[128:143], a[8:11], v[80:83], v[128:143]
    v_accvgpr_write_b32 a144, 0
    v_accvgpr_write_b32 a145, 0
    v_accvgpr_write_b32 a146, 0
    v_accvgpr_write_b32 a147, 0
    v_mfma_f32_32x32x16_bf16 v[144:159], a[8:11], v[84:87], v[144:159]
    ds_read_b128 a[24:27], v38 offset:0
    v_accvgpr_write_b32 a148, 0
    v_accvgpr_write_b32 a149, 0
    v_accvgpr_write_b32 a150, 0
    v_accvgpr_write_b32 a151, 0
    v_mfma_f32_32x32x16_bf16 v[128:143], a[12:15], v[88:91], v[128:143]
    v_accvgpr_write_b32 a152, 0
    v_accvgpr_write_b32 a153, 0
    v_accvgpr_write_b32 a154, 0
    v_accvgpr_write_b32 a155, 0
    v_mfma_f32_32x32x16_bf16 v[144:159], a[12:15], v[92:95], v[144:159]
    ds_read_b128 a[28:31], v39 offset:0
    v_accvgpr_write_b32 a156, 0
    v_accvgpr_write_b32 a157, 0
    v_accvgpr_write_b32 a158, 0
    v_accvgpr_write_b32 a159, 0
    s_waitcnt lgkmcnt(2)
    v_mfma_f32_32x32x16_bf16 v[128:143], a[16:19], v[96:99], v[128:143]
    v_accvgpr_write_b32 a160, 0
    v_accvgpr_write_b32 a161, 0
    v_accvgpr_write_b32 a162, 0
    v_accvgpr_write_b32 a163, 0
    v_mfma_f32_32x32x16_bf16 v[144:159], a[16:19], v[100:103], v[144:159]
    ds_read_b128 a[0:3], v32 offset:49152
    v_accvgpr_write_b32 a164, 0
    v_accvgpr_write_b32 a165, 0
    v_accvgpr_write_b32 a166, 0
    v_accvgpr_write_b32 a167, 0
    v_mfma_f32_32x32x16_bf16 v[128:143], a[20:23], v[104:107], v[128:143]
    v_accvgpr_write_b32 a168, 0
    v_accvgpr_write_b32 a169, 0
    v_accvgpr_write_b32 a170, 0
    v_accvgpr_write_b32 a171, 0
    v_mfma_f32_32x32x16_bf16 v[144:159], a[20:23], v[108:111], v[144:159]
    ds_read_b128 a[4:7], v33 offset:49152
    v_accvgpr_write_b32 a172, 0
    v_accvgpr_write_b32 a173, 0
    v_accvgpr_write_b32 a174, 0
    v_accvgpr_write_b32 a175, 0
    s_waitcnt lgkmcnt(2)
    v_mfma_f32_32x32x16_bf16 v[128:143], a[24:27], v[112:115], v[128:143]
    v_accvgpr_write_b32 a176, 0
    v_accvgpr_write_b32 a177, 0
    v_accvgpr_write_b32 a178, 0
    v_accvgpr_write_b32 a179, 0
    v_mfma_f32_32x32x16_bf16 v[144:159], a[24:27], v[116:119], v[144:159]
    ds_read_b128 a[8:11], v34 offset:49152
    v_accvgpr_write_b32 a180, 0
    v_accvgpr_write_b32 a181, 0
    v_accvgpr_write_b32 a182, 0
    v_accvgpr_write_b32 a183, 0
    v_mfma_f32_32x32x16_bf16 v[128:143], a[28:31], v[120:123], v[128:143]
    v_accvgpr_write_b32 a184, 0
    v_accvgpr_write_b32 a185, 0
    v_accvgpr_write_b32 a186, 0
    v_accvgpr_write_b32 a187, 0
    v_mfma_f32_32x32x16_bf16 v[144:159], a[28:31], v[124:127], v[144:159]
    ds_read_b128 a[12:15], v35 offset:49152
    v_accvgpr_write_b32 a188, 0
    v_accvgpr_write_b32 a189, 0
    v_accvgpr_write_b32 a190, 0
    v_accvgpr_write_b32 a191, 0
    s_waitcnt lgkmcnt(2)
    v_mfma_f32_32x32x16_bf16 v[160:175], a[0:3], v[64:67], v[224:239]
    v_add_u32 v32, 8192, v32
    v_mfma_f32_32x32x16_bf16 v[176:191], a[0:3], v[68:71], v[240:255]
    ds_read_b128 a[16:19], v36 offset:49152
    v_add_u32 v33, 8192, v33
    v_mfma_f32_32x32x16_bf16 v[160:175], a[4:7], v[72:75], v[160:175]
    v_add_u32 v34, 8192, v34
    v_mfma_f32_32x32x16_bf16 v[176:191], a[4:7], v[76:79], v[176:191]
    ds_read_b128 a[20:23], v37 offset:49152
    v_add_u32 v35, 8192, v35
    s_waitcnt lgkmcnt(2)
    v_mfma_f32_32x32x16_bf16 v[160:175], a[8:11], v[80:83], v[160:175]
    v_mfma_f32_32x32x16_bf16 v[176:191], a[8:11], v[84:87], v[176:191]
    ds_read_b128 a[24:27], v38 offset:49152
    v_exp_f32 v128, v128
    v_exp_f32 v129, v129
    v_exp_f32 v130, v130
    v_add_f32 v52, v52, v128
    v_cvt_pk_bf16_f32 v192, v128, v129
    v_mfma_f32_32x32x16_bf16 v[160:175], a[12:15], v[88:91], v[160:175]
    v_exp_f32 v131, v131
    v_add_f32 v53, v53, v129
    v_exp_f32 v132, v132
    v_add_f32 v52, v52, v130
    v_cvt_pk_bf16_f32 v193, v130, v131
    v_exp_f32 v133, v133
    v_add_f32 v53, v53, v131
    v_mfma_f32_32x32x16_bf16 v[176:191], a[12:15], v[92:95], v[176:191]
    ds_read_b128 a[28:31], v39 offset:49152
    v_exp_f32 v134, v134
    v_add_f32 v52, v52, v132
    v_cvt_pk_bf16_f32 v194, v132, v133
    v_exp_f32 v135, v135
    v_add_f32 v53, v53, v133
    v_exp_f32 v136, v136
    v_add_f32 v52, v52, v134
    v_cvt_pk_bf16_f32 v195, v134, v135
    s_waitcnt lgkmcnt(2)
    v_mfma_f32_32x32x16_bf16 v[160:175], a[16:19], v[96:99], v[160:175]
    v_exp_f32 v137, v137
    v_add_f32 v53, v53, v135
    v_exp_f32 v138, v138
    v_add_f32 v52, v52, v136
    v_cvt_pk_bf16_f32 v196, v136, v137
    v_exp_f32 v139, v139
    v_add_f32 v53, v53, v137
    v_mfma_f32_32x32x16_bf16 v[176:191], a[16:19], v[100:103], v[176:191]
    ds_read_b128 a[0:3], v32 offset:0
    v_exp_f32 v140, v140
    v_add_f32 v52, v52, v138
    v_cvt_pk_bf16_f32 v197, v138, v139
    v_exp_f32 v141, v141
    v_add_f32 v53, v53, v139
    v_exp_f32 v142, v142
    v_add_f32 v52, v52, v140
    v_cvt_pk_bf16_f32 v198, v140, v141
    v_mfma_f32_32x32x16_bf16 v[160:175], a[20:23], v[104:107], v[160:175]
    v_exp_f32 v143, v143
    v_add_f32 v53, v53, v141
    v_exp_f32 v144, v144
    v_add_f32 v52, v52, v142
    v_cvt_pk_bf16_f32 v199, v142, v143
    v_exp_f32 v145, v145
    v_add_f32 v53, v53, v143
    v_mfma_f32_32x32x16_bf16 v[176:191], a[20:23], v[108:111], v[176:191]
    ds_read_b128 a[4:7], v33 offset:0
    v_exp_f32 v146, v146
    v_add_f32 v54, v54, v144
    v_cvt_pk_bf16_f32 v200, v144, v145
    v_exp_f32 v147, v147
    v_add_f32 v55, v55, v145
    v_exp_f32 v148, v148
    v_add_f32 v54, v54, v146
    v_cvt_pk_bf16_f32 v201, v146, v147
    s_waitcnt lgkmcnt(2)
    v_mfma_f32_32x32x16_bf16 v[160:175], a[24:27], v[112:115], v[160:175]
    v_exp_f32 v149, v149
    v_add_f32 v55, v55, v147
    v_exp_f32 v150, v150
    v_add_f32 v54, v54, v148
    v_cvt_pk_bf16_f32 v202, v148, v149
    v_exp_f32 v151, v151
    v_add_f32 v55, v55, v149
    v_mfma_f32_32x32x16_bf16 v[176:191], a[24:27], v[116:119], v[176:191]
    ds_read_b128 a[8:11], v34 offset:0
    v_exp_f32 v152, v152
    v_add_f32 v54, v54, v150
    v_cvt_pk_bf16_f32 v203, v150, v151
    v_exp_f32 v153, v153
    v_add_f32 v55, v55, v151
    v_exp_f32 v154, v154
    v_add_f32 v54, v54, v152
    v_cvt_pk_bf16_f32 v204, v152, v153
    v_add_u32 v36, 8192, v36
    v_mfma_f32_32x32x16_bf16 v[160:175], a[28:31], v[120:123], v[160:175]
    v_exp_f32 v155, v155
    v_add_f32 v55, v55, v153
    v_exp_f32 v156, v156
    v_add_f32 v54, v54, v154
    v_cvt_pk_bf16_f32 v205, v154, v155
    v_exp_f32 v157, v157
    v_add_f32 v55, v55, v155
    v_add_u32 v37, 8192, v37
    v_mfma_f32_32x32x16_bf16 v[176:191], a[28:31], v[124:127], v[176:191]
    ds_read_b128 a[12:15], v35 offset:0
    v_exp_f32 v158, v158
    v_add_f32 v54, v54, v156
    v_cvt_pk_bf16_f32 v206, v156, v157
    v_exp_f32 v159, v159
    v_add_f32 v55, v55, v157
    v_add_u32 v38, 8192, v38
    v_add_f32 v54, v54, v158
    v_add_f32 v55, v55, v159
    v_cvt_pk_bf16_f32 v207, v158, v159
    v_add_u32 v39, 8192, v39
L_p2_loop:
    s_waitcnt vmcnt(1)
    s_barrier
    s_waitcnt lgkmcnt(2)
    v_mfma_f32_32x32x16_bf16 v[128:143], a[0:3], v[64:67], v[224:239]
    v_exp_f32 v160, v160
    v_exp_f32 v161, v161
    s_mov_b32 m0, s62
    v_add_f32 v52, v52, v160
    v_mfma_f32_32x32x16_bf16 v[144:159], a[0:3], v[68:71], v[240:255]
    ds_read_b128 a[16:19], v36 offset:0
    v_exp_f32 v162, v162
    v_add_f32 v53, v53, v161
    v_cvt_pk_bf16_f32 v208, v160, v161
    v_mfma_f32_32x32x16_bf16 v[128:143], a[4:7], v[72:75], v[128:143]
    v_exp_f32 v163, v163
    buffer_load_dwordx4 v44, s[52:55], s38 offen offset:0 lds
    v_add_f32 v52, v52, v162
    v_exp_f32 v164, v164
    v_mfma_f32_32x32x16_bf16 v[144:159], a[4:7], v[76:79], v[144:159]
    ds_read_b128 a[20:23], v37 offset:0
    v_add_f32 v53, v53, v163
    v_cvt_pk_bf16_f32 v209, v162, v163
    v_exp_f32 v165, v165
    s_waitcnt lgkmcnt(2)
    v_mfma_f32_32x32x16_bf16 v[128:143], a[8:11], v[80:83], v[128:143]
    s_add_u32 s43, s46, 8192
    s_cmp_eq_u32 s43, 24576
    s_cselect_b32 s43, 0, s43
    v_add_f32 v52, v52, v164
    v_exp_f32 v166, v166
    v_mfma_f32_32x32x16_bf16 v[144:159], a[8:11], v[84:87], v[144:159]
    ds_read_b128 a[24:27], v38 offset:0
    v_add_f32 v53, v53, v165
    v_cvt_pk_bf16_f32 v210, v164, v165
    v_exp_f32 v167, v167
    v_mfma_f32_32x32x16_bf16 v[128:143], a[12:15], v[88:91], v[128:143]
    buffer_load_dwordx4 v45, s[52:55], s38 offen offset:1024 lds
    v_add_f32 v52, v52, v166
    v_exp_f32 v168, v168
    v_add_f32 v53, v53, v167
    v_mfma_f32_32x32x16_bf16 v[144:159], a[12:15], v[92:95], v[144:159]
    ds_read_b128 a[28:31], v39 offset:0
    v_cvt_pk_bf16_f32 v211, v166, v167
    v_exp_f32 v169, v169
    s_waitcnt lgkmcnt(2)
    v_mfma_f32_32x32x16_bf16 v[128:143], a[16:19], v[96:99], v[128:143]
    s_sub_u32 s48, s43, s46
    s_sub_u32 s49, s46, s47
    v_add_f32 v52, v52, v168
    v_exp_f32 v170, v170
    v_add_f32 v53, v53, v169
    v_mfma_f32_32x32x16_bf16 v[144:159], a[16:19], v[100:103], v[144:159]
    ds_read_b64_tr_b16 a[0:1], v40 offset:0
    ds_read_b64_tr_b16 a[2:3], v40 offset:2048
    v_cvt_pk_bf16_f32 v212, v168, v169
    v_exp_f32 v171, v171
    v_mfma_f32_32x32x16_bf16 v[128:143], a[20:23], v[104:107], v[128:143]
    buffer_load_dwordx4 v46, s[52:55], s38 offen offset:2048 lds
    v_add_f32 v52, v52, v170
    v_exp_f32 v172, v172
    v_add_f32 v53, v53, v171
    v_mfma_f32_32x32x16_bf16 v[144:159], a[20:23], v[108:111], v[144:159]
    ds_read_b64_tr_b16 a[4:5], v41 offset:0
    ds_read_b64_tr_b16 a[6:7], v41 offset:2048
    v_cvt_pk_bf16_f32 v213, v170, v171
    v_exp_f32 v173, v173
    s_waitcnt lgkmcnt(4)
    v_mfma_f32_32x32x16_bf16 v[128:143], a[24:27], v[112:115], v[128:143]
    s_sub_u32 s49, s49, 49152
    s_mov_b32 s47, s46
    s_mov_b32 s46, s43
    v_add_f32 v52, v52, v172
    v_exp_f32 v174, v174
    v_mfma_f32_32x32x16_bf16 v[144:159], a[24:27], v[116:119], v[144:159]
    ds_read_b64_tr_b16 a[8:9], v42 offset:0
    ds_read_b64_tr_b16 a[10:11], v42 offset:2048
    v_add_f32 v53, v53, v173
    v_cvt_pk_bf16_f32 v214, v172, v173
    v_exp_f32 v175, v175
    v_mfma_f32_32x32x16_bf16 v[128:143], a[28:31], v[120:123], v[128:143]
    buffer_load_dwordx4 v47, s[52:55], s38 offen offset:3072 lds
    v_add_f32 v52, v52, v174
    v_exp_f32 v176, v176
    v_add_f32 v53, v53, v175
    v_mfma_f32_32x32x16_bf16 v[144:159], a[28:31], v[124:127], v[144:159]
    ds_read_b64_tr_b16 a[12:13], v43 offset:0
    ds_read_b64_tr_b16 a[14:15], v43 offset:2048
    s_add_u32 s38, s38, 16384
    s_and_b32 s38, s38, 131071
    v_cvt_pk_bf16_f32 v215, v174, v175
    s_waitcnt lgkmcnt(4)
    v_mfma_f32_32x32x16_bf16 a[128:143], a[0:3], v[192:195], a[128:143]
    v_exp_f32 v177, v177
    s_mov_b32 m0, s63
    v_add_f32 v54, v54, v176
    v_exp_f32 v178, v178
    v_mfma_f32_32x32x16_bf16 a[144:159], a[0:3], v[200:203], a[144:159]
    ds_read_b64_tr_b16 a[16:17], v40 offset:24576
    ds_read_b64_tr_b16 a[18:19], v40 offset:26624
    v_add_f32 v55, v55, v177
    v_cvt_pk_bf16_f32 v216, v176, v177
    v_exp_f32 v179, v179
    v_mfma_f32_32x32x16_bf16 a[160:175], a[4:7], v[192:195], a[160:175]
    buffer_load_dwordx4 v48, s[56:59], s39 offen offset:0 lds
    v_add_f32 v54, v54, v178
    v_exp_f32 v180, v180
    v_add_f32 v55, v55, v179
    v_mfma_f32_32x32x16_bf16 a[176:191], a[4:7], v[200:203], a[176:191]
    ds_read_b64_tr_b16 a[20:21], v41 offset:24576
    ds_read_b64_tr_b16 a[22:23], v41 offset:26624
    v_cvt_pk_bf16_f32 v217, v178, v179
    v_exp_f32 v181, v181
    s_waitcnt lgkmcnt(4)
    v_mfma_f32_32x32x16_bf16 a[192:207], a[8:11], v[192:195], a[192:207]
    s_cmp_ge_u32 s50, 3
    s_cselect_b32 s8, s94, s92
    s_cselect_b32 s9, s95, s93
    v_add_f32 v54, v54, v180
    v_exp_f32 v182, v182
    v_mfma_f32_32x32x16_bf16 a[208:223], a[8:11], v[200:203], a[208:223]
    ds_read_b64_tr_b16 a[24:25], v42 offset:24576
    ds_read_b64_tr_b16 a[26:27], v42 offset:26624
    v_add_f32 v55, v55, v181
    v_cvt_pk_bf16_f32 v218, v180, v181
    v_exp_f32 v183, v183
    v_mfma_f32_32x32x16_bf16 a[224:239], a[12:15], v[192:195], a[224:239]
    buffer_load_dwordx4 v49, s[56:59], s39 offen offset:1024 lds
    s_bitcmp0_b32 s50, 0
    s_cselect_b32 s61, s66, 0
    v_add_f32 v54, v54, v182
    v_exp_f32 v184, v184
    v_mfma_f32_32x32x16_bf16 a[240:255], a[12:15], v[200:203], a[240:255]
    ds_read_b64_tr_b16 a[28:29], v43 offset:24576
    ds_read_b64_tr_b16 a[30:31], v43 offset:26624
    v_add_f32 v55, v55, v183
    v_cvt_pk_bf16_f32 v219, v182, v183
    s_waitcnt lgkmcnt(4)
    v_mfma_f32_32x32x16_bf16 a[128:143], a[16:19], v[196:199], a[128:143]
    v_exp_f32 v185, v185
    v_add_u32 v40, 49152, v40
    s_cmp_ge_u32 s50, 5
    s_cselect_b32 s8, s96, s8
    s_cselect_b32 s9, s97, s9
    v_mfma_f32_32x32x16_bf16 a[144:159], a[16:19], v[204:207], a[144:159]
    ds_read_b128 a[0:3], v32 offset:49152
    v_add_f32 v54, v54, v184
    v_exp_f32 v186, v186
    v_add_f32 v55, v55, v185
    v_cvt_pk_bf16_f32 v220, v184, v185
    v_mfma_f32_32x32x16_bf16 a[160:175], a[20:23], v[196:199], a[160:175]
    v_exp_f32 v187, v187
    buffer_load_dwordx4 v50, s[56:59], s39 offen offset:2048 lds
    v_add_u32 v41, 49152, v41
    v_add_f32 v54, v54, v186
    v_mfma_f32_32x32x16_bf16 a[176:191], a[20:23], v[204:207], a[176:191]
    ds_read_b128 a[4:7], v33 offset:49152
    v_exp_f32 v188, v188
    v_add_f32 v55, v55, v187
    v_cvt_pk_bf16_f32 v221, v186, v187
    s_waitcnt lgkmcnt(2)
    v_mfma_f32_32x32x16_bf16 a[192:207], a[24:27], v[196:199], a[192:207]
    v_exp_f32 v189, v189
    s_cmp_ge_u32 s50, 5
    s_cselect_b32 s61, 0, s61
    s_cselect_b64 s[64:65], -1, 0
    v_add_u32 v42, 49152, v42
    v_mfma_f32_32x32x16_bf16 a[208:223], a[24:27], v[204:207], a[208:223]
    ds_read_b128 a[8:11], v34 offset:49152
    v_add_f32 v54, v54, v188
    v_exp_f32 v190, v190
    s_cmp_ge_u32 s50, 6
    s_cselect_b32 s61, 4096, s61
    v_mfma_f32_32x32x16_bf16 a[224:239], a[28:31], v[196:199], a[224:239]
    v_add_f32 v55, v55, v189
    v_cvt_pk_bf16_f32 v222, v188, v189
    v_exp_f32 v191, v191
    buffer_load_dwordx4 v51, s[56:59], s39 offen offset:3072 lds
    v_add_f32 v54, v54, v190
    v_mfma_f32_32x32x16_bf16 a[240:255], a[28:31], v[204:207], a[240:255]
    ds_read_b128 a[12:15], v35 offset:49152
    v_add_f32 v55, v55, v191
    v_cvt_pk_bf16_f32 v223, v190, v191
    s_add_u32 s39, s39, 16384
    s_and_b32 s39, s39, 131071
    v_add_u32 v43, 49152, v43
    s_waitcnt lgkmcnt(2)
    v_mfma_f32_32x32x16_bf16 v[160:175], a[0:3], v[64:67], v[224:239]
    v_exp_f32 v128, v128
    v_exp_f32 v129, v129
    v_add_u32 v32, s48, v32
    v_add_f32 v52, v52, v128
    v_mfma_f32_32x32x16_bf16 v[176:191], a[0:3], v[68:71], v[240:255]
    ds_read_b128 a[16:19], v36 offset:49152
    v_exp_f32 v130, v130
    v_cndmask_b32 v1, v3, v4, s[64:65]
    v_add_f32 v53, v53, v129
    v_cvt_pk_bf16_f32 v192, v128, v129
    v_mfma_f32_32x32x16_bf16 v[160:175], a[4:7], v[72:75], v[160:175]
    v_exp_f32 v131, v131
    v_add_u32 v33, s48, v33
    s_mov_b32 m0, s60
    v_add_f32 v52, v52, v130
    v_mfma_f32_32x32x16_bf16 v[176:191], a[4:7], v[76:79], v[176:191]
    ds_read_b128 a[20:23], v37 offset:49152
    v_exp_f32 v132, v132
    v_add_f32 v53, v53, v131
    v_cvt_pk_bf16_f32 v193, v130, v131
    s_waitcnt lgkmcnt(2)
    v_mfma_f32_32x32x16_bf16 v[160:175], a[8:11], v[80:83], v[160:175]
    v_exp_f32 v133, v133
    v_add_u32 v34, s48, v34
    s_cmp_eq_u32 s50, 7
    s_cbranch_scc0 L_p2_c
    s_waitcnt vmcnt(8)
    ds_read_b64_tr_b16 a[96:97], v60 offset:0
    ds_read_b64_tr_b16 a[98:99], v60 offset:64
    ds_read_b64_tr_b16 a[100:101], v60 offset:512
    ds_read_b64_tr_b16 a[102:103], v60 offset:576
    ds_read_b64_tr_b16 a[104:105], v60 offset:1024
    ds_read_b64_tr_b16 a[106:107], v60 offset:1088
    ds_read_b64_tr_b16 a[108:109], v60 offset:1536
    ds_read_b64_tr_b16 a[110:111], v60 offset:1600
    ds_read_b64_tr_b16 a[112:113], v61 offset:4096
    ds_read_b64_tr_b16 a[114:115], v58 offset:4096
    ds_read_b64_tr_b16 a[116:117], v59 offset:4096
    ds_read_b64_tr_b16 a[118:119], v2 offset:4096
    ds_read_b64_tr_b16 a[120:121], v61 offset:4224
    ds_read_b64_tr_b16 a[122:123], v58 offset:4224
    ds_read_b64_tr_b16 a[124:125], v59 offset:4224
    ds_read_b64_tr_b16 a[126:127], v2 offset:4224
    buffer_load_dword a40, v62, s[20:23], 0 offen
    s_branch L_p2_noc
L_p2_c:
    buffer_load_dwordx4 v1, s[8:11], s61 offen lds
L_p2_noc:
    v_mfma_f32_32x32x16_bf16 v[176:191], a[8:11], v[84:87], v[176:191]
    ds_read_b128 a[24:27], v38 offset:49152
    v_add_f32 v52, v52, v132
    v_exp_f32 v134, v134
    v_add_f32 v53, v53, v133
    v_cvt_pk_bf16_f32 v194, v132, v133
    v_mfma_f32_32x32x16_bf16 v[160:175], a[12:15], v[88:91], v[160:175]
    v_exp_f32 v135, v135
    v_add_u32 v35, s48, v35
    s_add_u32 s60, s60, 1024
    v_add_f32 v52, v52, v134
    v_mfma_f32_32x32x16_bf16 v[176:191], a[12:15], v[92:95], v[176:191]
    ds_read_b128 a[28:31], v39 offset:49152
    v_exp_f32 v136, v136
    v_add_f32 v53, v53, v135
    v_cvt_pk_bf16_f32 v195, v134, v135
    s_waitcnt lgkmcnt(2)
    v_mfma_f32_32x32x16_bf16 v[160:175], a[16:19], v[96:99], v[160:175]
    v_exp_f32 v137, v137
    v_add_f32 v52, v52, v136
    v_exp_f32 v138, v138
    v_add_f32 v53, v53, v137
    v_mfma_f32_32x32x16_bf16 v[176:191], a[16:19], v[100:103], v[176:191]
    ds_read_b64_tr_b16 a[0:1], v40 offset:0
    ds_read_b64_tr_b16 a[2:3], v40 offset:2048
    v_cvt_pk_bf16_f32 v196, v136, v137
    v_exp_f32 v139, v139
    v_mfma_f32_32x32x16_bf16 v[160:175], a[20:23], v[104:107], v[160:175]
    s_add_u32 s62, s40, s47
    s_add_u32 s43, s46, 8192
    v_add_f32 v52, v52, v138
    v_exp_f32 v140, v140
    v_add_f32 v53, v53, v139
    v_mfma_f32_32x32x16_bf16 v[176:191], a[20:23], v[108:111], v[176:191]
    ds_read_b64_tr_b16 a[4:5], v41 offset:0
    ds_read_b64_tr_b16 a[6:7], v41 offset:2048
    v_cvt_pk_bf16_f32 v197, v138, v139
    v_exp_f32 v141, v141
    s_waitcnt lgkmcnt(4)
    v_mfma_f32_32x32x16_bf16 v[160:175], a[24:27], v[112:115], v[160:175]
    s_cmp_eq_u32 s43, 24576
    s_cselect_b32 s43, 0, s43
    s_add_u32 s63, s40, s43
    v_add_f32 v52, v52, v140
    v_exp_f32 v142, v142
    v_mfma_f32_32x32x16_bf16 v[176:191], a[24:27], v[116:119], v[176:191]
    ds_read_b64_tr_b16 a[8:9], v42 offset:0
    ds_read_b64_tr_b16 a[10:11], v42 offset:2048
    v_add_f32 v53, v53, v141
    v_cvt_pk_bf16_f32 v198, v140, v141
    v_exp_f32 v143, v143
    v_mfma_f32_32x32x16_bf16 v[160:175], a[28:31], v[120:123], v[160:175]
    s_add_u32 s63, s63, 4096
    v_add_f32 v52, v52, v142
    v_exp_f32 v144, v144
    v_add_f32 v53, v53, v143
    v_mfma_f32_32x32x16_bf16 v[176:191], a[28:31], v[124:127], v[176:191]
    ds_read_b64_tr_b16 a[12:13], v43 offset:0
    ds_read_b64_tr_b16 a[14:15], v43 offset:2048
    v_cvt_pk_bf16_f32 v199, v142, v143
    v_exp_f32 v145, v145
    s_waitcnt lgkmcnt(4)
    v_mfma_f32_32x32x16_bf16 a[128:143], a[0:3], v[208:211], a[128:143]
    v_add_u32 v36, s48, v36
    v_add_f32 v54, v54, v144
    v_exp_f32 v146, v146
    v_add_f32 v55, v55, v145
    v_mfma_f32_32x32x16_bf16 a[144:159], a[0:3], v[216:219], a[144:159]
    ds_read_b64_tr_b16 a[16:17], v40 offset:24576
    ds_read_b64_tr_b16 a[18:19], v40 offset:26624
    v_cvt_pk_bf16_f32 v200, v144, v145
    v_exp_f32 v147, v147
    v_mfma_f32_32x32x16_bf16 a[160:175], a[4:7], v[208:211], a[160:175]
    v_add_u32 v37, s48, v37
    v_add_f32 v54, v54, v146
    v_exp_f32 v148, v148
    v_add_f32 v55, v55, v147
    v_mfma_f32_32x32x16_bf16 a[176:191], a[4:7], v[216:219], a[176:191]
    ds_read_b64_tr_b16 a[20:21], v41 offset:24576
    ds_read_b64_tr_b16 a[22:23], v41 offset:26624
    v_cvt_pk_bf16_f32 v201, v146, v147
    v_exp_f32 v149, v149
    s_waitcnt lgkmcnt(4)
    v_mfma_f32_32x32x16_bf16 a[192:207], a[8:11], v[208:211], a[192:207]
    v_add_u32 v38, s48, v38
    v_add_f32 v54, v54, v148
    v_exp_f32 v150, v150
    v_add_f32 v55, v55, v149
    v_mfma_f32_32x32x16_bf16 a[208:223], a[8:11], v[216:219], a[208:223]
    ds_read_b64_tr_b16 a[24:25], v42 offset:24576
    ds_read_b64_tr_b16 a[26:27], v42 offset:26624
    v_cvt_pk_bf16_f32 v202, v148, v149
    v_exp_f32 v151, v151
    v_mfma_f32_32x32x16_bf16 a[224:239], a[12:15], v[208:211], a[224:239]
    v_add_u32 v39, s48, v39
    v_add_f32 v54, v54, v150
    v_exp_f32 v152, v152
    v_add_f32 v55, v55, v151
    v_mfma_f32_32x32x16_bf16 a[240:255], a[12:15], v[216:219], a[240:255]
    ds_read_b64_tr_b16 a[28:29], v43 offset:24576
    ds_read_b64_tr_b16 a[30:31], v43 offset:26624
    v_cvt_pk_bf16_f32 v203, v150, v151
    v_exp_f32 v153, v153
    s_waitcnt lgkmcnt(4)
    v_mfma_f32_32x32x16_bf16 a[128:143], a[16:19], v[212:215], a[128:143]
    v_add_u32 v40, s49, v40
    v_add_f32 v54, v54, v152
    v_exp_f32 v154, v154
    v_add_f32 v55, v55, v153
    v_mfma_f32_32x32x16_bf16 a[144:159], a[16:19], v[220:223], a[144:159]
    ds_read_b128 a[0:3], v32 offset:0
    v_cvt_pk_bf16_f32 v204, v152, v153
    v_exp_f32 v155, v155
    v_mfma_f32_32x32x16_bf16 a[160:175], a[20:23], v[212:215], a[160:175]
    v_add_u32 v41, s49, v41
    v_add_f32 v54, v54, v154
    v_exp_f32 v156, v156
    v_add_f32 v55, v55, v155
    v_mfma_f32_32x32x16_bf16 a[176:191], a[20:23], v[220:223], a[176:191]
    ds_read_b128 a[4:7], v33 offset:0
    v_cvt_pk_bf16_f32 v205, v154, v155
    v_exp_f32 v157, v157
    s_waitcnt lgkmcnt(2)
    v_mfma_f32_32x32x16_bf16 a[192:207], a[24:27], v[212:215], a[192:207]
    v_add_u32 v42, s49, v42
    s_add_u32 s50, s50, 1
    v_add_f32 v54, v54, v156
    v_exp_f32 v158, v158
    v_add_f32 v55, v55, v157
    v_mfma_f32_32x32x16_bf16 a[208:223], a[24:27], v[220:223], a[208:223]
    ds_read_b128 a[8:11], v34 offset:0
    v_cvt_pk_bf16_f32 v206, v156, v157
    v_exp_f32 v159, v159
    v_mfma_f32_32x32x16_bf16 a[224:239], a[28:31], v[212:215], a[224:239]
    v_add_u32 v43, s49, v43
    v_add_f32 v54, v54, v158
    v_add_f32 v55, v55, v159
    v_cvt_pk_bf16_f32 v207, v158, v159
    v_mfma_f32_32x32x16_bf16 a[240:255], a[28:31], v[220:223], a[240:255]
    ds_read_b128 a[12:15], v35 offset:0
    s_cmp_lg_u32 s50, 7
    s_cbranch_scc1 L_p2_noswitch
    s_mov_b32 s52, s20
    s_mov_b32 s53, s21
    s_mov_b32 s54, s22
    s_mov_b32 s56, s20
    s_mov_b32 s57, s21
    s_mov_b32 s58, s22
    s_mov_b32 s62, s40
    s_add_u32 s63, s40, 4096
    s_mov_b32 s38, s37
    s_add_u32 s37, s37, 32768
    s_and_b32 s37, s37, 524287
    s_mov_b32 s39, s37
    s_add_u32 s37, s37, 32768
    s_and_b32 s37, s37, 524287
    v_mov_b32 v44, v5
    v_mov_b32 v48, v5
    v_mov_b32 v45, v6
    v_mov_b32 v49, v6
    v_mov_b32 v46, v7
    v_mov_b32 v50, v7
    v_mov_b32 v47, v8
    v_mov_b32 v51, v8
L_p2_noswitch:
    s_cmp_lg_u32 s50, 8
    s_cbranch_scc1 L_p2_loop
    ds_read_b64_tr_b16 a[0:1], v40 offset:0
    ds_read_b64_tr_b16 a[2:3], v40 offset:2048
    ds_read_b64_tr_b16 a[4:5], v41 offset:0
    ds_read_b64_tr_b16 a[6:7], v41 offset:2048
    ds_read_b64_tr_b16 a[8:9], v42 offset:0
    ds_read_b64_tr_b16 a[10:11], v42 offset:2048
    ds_read_b64_tr_b16 a[12:13], v43 offset:0
    ds_read_b64_tr_b16 a[14:15], v43 offset:2048
    s_waitcnt lgkmcnt(0)
    s_barrier
    v_mov_b32 v62, 0
    global_load_dword v2, v62, s[72:73] sc1
    v_mfma_f32_32x32x16_bf16 a[128:143], a[0:3], v[192:195], a[128:143]
    v_exp_f32 v160, v160
    v_exp_f32 v161, v161
    v_mfma_f32_32x32x16_bf16 a[144:159], a[0:3], v[200:203], a[144:159]
    ds_read_b64_tr_b16 a[16:17], v40 offset:24576
    ds_read_b64_tr_b16 a[18:19], v40 offset:26624
    v_exp_f32 v162, v162
    v_add_f32 v52, v52, v160
    v_cvt_pk_bf16_f32 v208, v160, v161
    v_exp_f32 v163, v163
    v_add_f32 v53, v53, v161
    v_mfma_f32_32x32x16_bf16 a[160:175], a[4:7], v[192:195], a[160:175]
    v_exp_f32 v164, v164
    v_add_f32 v52, v52, v162
    v_cvt_pk_bf16_f32 v209, v162, v163
    v_exp_f32 v165, v165
    v_add_f32 v53, v53, v163
    v_mfma_f32_32x32x16_bf16 a[176:191], a[4:7], v[200:203], a[176:191]
    ds_read_b64_tr_b16 a[20:21], v41 offset:24576
    ds_read_b64_tr_b16 a[22:23], v41 offset:26624
    v_exp_f32 v166, v166
    v_add_f32 v52, v52, v164
    v_cvt_pk_bf16_f32 v210, v164, v165
    v_exp_f32 v167, v167
    v_add_f32 v53, v53, v165
    v_mfma_f32_32x32x16_bf16 a[192:207], a[8:11], v[192:195], a[192:207]
    v_exp_f32 v168, v168
    v_add_f32 v52, v52, v166
    v_cvt_pk_bf16_f32 v211, v166, v167
    v_exp_f32 v169, v169
    v_add_f32 v53, v53, v167
    v_mfma_f32_32x32x16_bf16 a[208:223], a[8:11], v[200:203], a[208:223]
    ds_read_b64_tr_b16 a[24:25], v42 offset:24576
    ds_read_b64_tr_b16 a[26:27], v42 offset:26624
    v_exp_f32 v170, v170
    v_add_f32 v52, v52, v168
    v_cvt_pk_bf16_f32 v212, v168, v169
    v_exp_f32 v171, v171
    v_add_f32 v53, v53, v169
    v_mfma_f32_32x32x16_bf16 a[224:239], a[12:15], v[192:195], a[224:239]
    v_exp_f32 v172, v172
    v_add_f32 v52, v52, v170
    v_cvt_pk_bf16_f32 v213, v170, v171
    v_exp_f32 v173, v173
    v_add_f32 v53, v53, v171
    v_mfma_f32_32x32x16_bf16 a[240:255], a[12:15], v[200:203], a[240:255]
    ds_read_b64_tr_b16 a[28:29], v43 offset:24576
    ds_read_b64_tr_b16 a[30:31], v43 offset:26624
    v_exp_f32 v174, v174
    v_add_f32 v52, v52, v172
    v_cvt_pk_bf16_f32 v214, v172, v173
    v_exp_f32 v175, v175
    v_add_f32 v53, v53, v173
    v_add_u32 v40, 49152, v40
    s_waitcnt lgkmcnt(4)
    v_mfma_f32_32x32x16_bf16 a[128:143], a[16:19], v[196:199], a[128:143]
    v_exp_f32 v176, v176
    v_add_f32 v52, v52, v174
    v_cvt_pk_bf16_f32 v215, v174, v175
    v_exp_f32 v177, v177
    v_add_f32 v53, v53, v175
    v_add_u32 v41, 49152, v41
    v_mfma_f32_32x32x16_bf16 a[144:159], a[16:19], v[204:207], a[144:159]
    ds_read_b64_tr_b16 a[0:1], v40 offset:0
    ds_read_b64_tr_b16 a[2:3], v40 offset:2048
    v_exp_f32 v178, v178
    v_add_f32 v54, v54, v176
    v_cvt_pk_bf16_f32 v216, v176, v177
    v_exp_f32 v179, v179
    v_add_f32 v55, v55, v177
    v_add_u32 v42, 49152, v42
    v_mfma_f32_32x32x16_bf16 a[160:175], a[20:23], v[196:199], a[160:175]
    v_exp_f32 v180, v180
    v_add_f32 v54, v54, v178
    v_cvt_pk_bf16_f32 v217, v178, v179
    v_exp_f32 v181, v181
    v_add_f32 v55, v55, v179
    v_add_u32 v43, 49152, v43
    v_mfma_f32_32x32x16_bf16 a[176:191], a[20:23], v[204:207], a[176:191]
    ds_read_b64_tr_b16 a[4:5], v40 offset:24576
    ds_read_b64_tr_b16 a[6:7], v40 offset:26624
    v_exp_f32 v182, v182
    v_add_f32 v54, v54, v180
    v_cvt_pk_bf16_f32 v218, v180, v181
    v_exp_f32 v183, v183
    v_add_f32 v55, v55, v181
    s_waitcnt lgkmcnt(4)
    v_mfma_f32_32x32x16_bf16 a[192:207], a[24:27], v[196:199], a[192:207]
    v_exp_f32 v184, v184
    v_add_f32 v54, v54, v182
    v_cvt_pk_bf16_f32 v219, v182, v183
    v_exp_f32 v185, v185
    v_add_f32 v55, v55, v183
    v_mfma_f32_32x32x16_bf16 a[208:223], a[24:27], v[204:207], a[208:223]
    ds_read_b64_tr_b16 a[8:9], v41 offset:0
    ds_read_b64_tr_b16 a[10:11], v41 offset:2048
    v_exp_f32 v186, v186
    v_add_f32 v54, v54, v184
    v_cvt_pk_bf16_f32 v220, v184, v185
    v_exp_f32 v187, v187
    v_add_f32 v55, v55, v185
    v_mfma_f32_32x32x16_bf16 a[224:239], a[28:31], v[196:199], a[224:239]
    v_exp_f32 v188, v188
    v_add_f32 v54, v54, v186
    v_cvt_pk_bf16_f32 v221, v186, v187
    v_exp_f32 v189, v189
    v_add_f32 v55, v55, v187
    v_mfma_f32_32x32x16_bf16 a[240:255], a[28:31], v[204:207], a[240:255]
    ds_read_b64_tr_b16 a[12:13], v41 offset:24576
    ds_read_b64_tr_b16 a[14:15], v41 offset:26624
    v_exp_f32 v190, v190
    v_add_f32 v54, v54, v188
    v_cvt_pk_bf16_f32 v222, v188, v189
    v_exp_f32 v191, v191
    v_add_f32 v55, v55, v189
    v_add_f32 v54, v54, v190
    v_add_f32 v55, v55, v191
    v_cvt_pk_bf16_f32 v223, v190, v191
    s_waitcnt lgkmcnt(4)
    v_mfma_f32_32x32x16_bf16 a[128:143], a[0:3], v[208:211], a[128:143]
    s_add_u32 m0, s40, 8192
    v_add_f32 v52, v52, v53
    v_add_f32 v54, v54, v55
    v_mov_b32 v53, v52
    v_mov_b32 v55, v54
    v_mfma_f32_32x32x16_bf16 a[144:159], a[0:3], v[216:219], a[144:159]
    ds_read_b64_tr_b16 a[16:17], v42 offset:0
    ds_read_b64_tr_b16 a[18:19], v42 offset:2048
    buffer_load_dwordx4 v5, s[20:23], s37 offen offset:0 lds
    v_permlane32_swap_b32 v52, v53
    v_mfma_f32_32x32x16_bf16 a[128:143], a[4:7], v[212:215], a[128:143]
    v_permlane32_swap_b32 v54, v55
    v_mfma_f32_32x32x16_bf16 a[144:159], a[4:7], v[220:223], a[144:159]
    ds_read_b64_tr_b16 a[20:21], v42 offset:24576
    ds_read_b64_tr_b16 a[22:23], v42 offset:26624
    buffer_load_dwordx4 v6, s[20:23], s37 offen offset:1024 lds
    v_add_f32 v52, v52, v53
    v_add_f32 v54, v54, v55
    v_rcp_f32 v58, v52
    v_rcp_f32 v60, v54
    s_waitcnt lgkmcnt(4)
    v_mfma_f32_32x32x16_bf16 a[160:175], a[8:11], v[208:211], a[160:175]
    s_mov_b32 s44, 0x2b800000
    s_mov_b32 s45, 0x53800000
    v_cmp_lt_f32 s[64:65], s44, v52
    v_cmp_gt_f32 s[66:67], s45, v52
    v_cmp_lt_f32 s[68:69], s44, v54
    v_cmp_gt_f32 vcc, s45, v54
    v_mfma_f32_32x32x16_bf16 a[176:191], a[8:11], v[216:219], a[176:191]
    ds_read_b64_tr_b16 a[24:25], v43 offset:0
    ds_read_b64_tr_b16 a[26:27], v43 offset:2048
    buffer_load_dwordx4 v7, s[20:23], s37 offen offset:2048 lds
    s_and_b64 s[64:65], s[64:65], s[66:67]
    s_and_b64 vcc, vcc, s[68:69]
    s_and_b64 s[64:65], s[64:65], vcc
    s_lshl_b32 s43, s34, 2
    s_add_u32 s43, s43, 0
    s_sub_u32 s43, s43, s35
    v_mfma_f32_32x32x16_bf16 a[160:175], a[12:15], v[212:215], a[160:175]
    s_and_b32 s43, s43, 15
    s_lshl_b32 s43, s43, 12
    v_add_u32 v61, s43, v56
    v_mfma_f32_32x32x16_bf16 a[176:191], a[12:15], v[220:223], a[176:191]
    ds_read_b64_tr_b16 a[28:29], v43 offset:24576
    ds_read_b64_tr_b16 a[30:31], v43 offset:26624
    buffer_load_dwordx4 v8, s[20:23], s37 offen offset:3072 lds
    s_add_u32 s37, s37, 32768
    s_and_b32 s37, s37, 524287
    v_accvgpr_read_b32 v128, a128
    v_accvgpr_read_b32 v129, a129
    v_accvgpr_read_b32 v130, a130
    s_waitcnt lgkmcnt(4)
    v_mfma_f32_32x32x16_bf16 a[192:207], a[16:19], v[208:211], a[192:207]
    s_add_u32 m0, s40, 12288
    v_accvgpr_read_b32 v131, a131
    v_accvgpr_read_b32 v132, a132
    v_accvgpr_read_b32 v133, a133
    v_accvgpr_read_b32 v134, a134
    v_accvgpr_read_b32 v135, a135
    v_mfma_f32_32x32x16_bf16 a[208:223], a[16:19], v[216:219], a[208:223]
    buffer_load_dwordx4 v5, s[20:23], s37 offen offset:0 lds
    v_accvgpr_read_b32 v136, a136
    v_accvgpr_read_b32 v137, a137
    v_accvgpr_read_b32 v138, a138
    v_accvgpr_read_b32 v139, a139
    v_accvgpr_read_b32 v140, a140
    v_mfma_f32_32x32x16_bf16 a[192:207], a[20:23], v[212:215], a[192:207]
    v_accvgpr_read_b32 v141, a141
    v_accvgpr_read_b32 v142, a142
    v_accvgpr_read_b32 v143, a143
    v_pk_mul_f32 v[128:129], v[128:129], v[58:59] op_sel_hi:[1,0]
    v_pk_mul_f32 v[130:131], v[130:131], v[58:59] op_sel_hi:[1,0]
    v_pk_mul_f32 v[132:133], v[132:133], v[58:59] op_sel_hi:[1,0]
    v_mfma_f32_32x32x16_bf16 a[208:223], a[20:23], v[220:223], a[208:223]
    buffer_load_dwordx4 v6, s[20:23], s37 offen offset:1024 lds
    v_pk_mul_f32 v[134:135], v[134:135], v[58:59] op_sel_hi:[1,0]
    v_pk_mul_f32 v[136:137], v[136:137], v[58:59] op_sel_hi:[1,0]
    v_pk_mul_f32 v[138:139], v[138:139], v[58:59] op_sel_hi:[1,0]
    v_pk_mul_f32 v[140:141], v[140:141], v[58:59] op_sel_hi:[1,0]
    v_pk_mul_f32 v[142:143], v[142:143], v[58:59] op_sel_hi:[1,0]
    s_waitcnt lgkmcnt(0)
    v_mfma_f32_32x32x16_bf16 a[224:239], a[24:27], v[208:211], a[224:239]
    v_cvt_pk_bf16_f32 v128, v128, v129
    v_cvt_pk_bf16_f32 v129, v130, v131
    v_cvt_pk_bf16_f32 v130, v132, v133
    v_cvt_pk_bf16_f32 v131, v134, v135
    v_cvt_pk_bf16_f32 v132, v136, v137
    v_cvt_pk_bf16_f32 v133, v138, v139
    v_mfma_f32_32x32x16_bf16 a[240:255], a[24:27], v[216:219], a[240:255]
    buffer_load_dwordx4 v7, s[20:23], s37 offen offset:2048 lds
    v_cvt_pk_bf16_f32 v134, v140, v141
    v_cvt_pk_bf16_f32 v135, v142, v143
    ds_write_b128 v61, v[128:131] offset:0
    ds_write_b128 v61, v[132:135] offset:512
    v_accvgpr_read_b32 v144, a144
    v_mfma_f32_32x32x16_bf16 a[224:239], a[28:31], v[212:215], a[224:239]
    v_accvgpr_read_b32 v145, a145
    v_accvgpr_read_b32 v146, a146
    v_accvgpr_read_b32 v147, a147
    v_accvgpr_read_b32 v148, a148
    v_accvgpr_read_b32 v149, a149
    v_accvgpr_read_b32 v150, a150
    v_mfma_f32_32x32x16_bf16 a[240:255], a[28:31], v[220:223], a[240:255]
    buffer_load_dwordx4 v8, s[20:23], s37 offen offset:3072 lds
    s_add_u32 s37, s37, 32768
    s_and_b32 s37, s37, 524287
    v_accvgpr_read_b32 v151, a151
    v_accvgpr_read_b32 v152, a152
    v_accvgpr_read_b32 v153, a153
    v_accvgpr_read_b32 v154, a154
    s_nop 9
    v_accvgpr_read_b32 v155, a155
    v_accvgpr_read_b32 v156, a156
    v_accvgpr_read_b32 v157, a157
    v_accvgpr_read_b32 v158, a158
    v_accvgpr_read_b32 v159, a159
    v_pk_mul_f32 v[144:145], v[144:145], v[60:61] op_sel_hi:[1,0]
    v_pk_mul_f32 v[146:147], v[146:147], v[60:61] op_sel_hi:[1,0]
    v_pk_mul_f32 v[148:149], v[148:149], v[60:61] op_sel_hi:[1,0]
    v_pk_mul_f32 v[150:151], v[150:151], v[60:61] op_sel_hi:[1,0]
    v_pk_mul_f32 v[152:153], v[152:153], v[60:61] op_sel_hi:[1,0]
    v_pk_mul_f32 v[154:155], v[154:155], v[60:61] op_sel_hi:[1,0]
    v_pk_mul_f32 v[156:157], v[156:157], v[60:61] op_sel_hi:[1,0]
    v_pk_mul_f32 v[158:159], v[158:159], v[60:61] op_sel_hi:[1,0]
    v_cvt_pk_bf16_f32 v144, v144, v145
    v_cvt_pk_bf16_f32 v145, v146, v147
    v_cvt_pk_bf16_f32 v146, v148, v149
    v_cvt_pk_bf16_f32 v147, v150, v151
    v_cvt_pk_bf16_f32 v148, v152, v153
    v_cvt_pk_bf16_f32 v149, v154, v155
    v_cvt_pk_bf16_f32 v150, v156, v157
    v_cvt_pk_bf16_f32 v151, v158, v159
    ds_write_b128 v61, v[144:147] offset:2048
    ds_write_b128 v61, v[148:151] offset:2560
    s_lshl_b32 s43, s34, 2
    s_add_u32 s43, s43, 1
    s_sub_u32 s43, s43, s35
    s_and_b32 s43, s43, 15
    s_lshl_b32 s43, s43, 12
    v_add_u32 v62, s43, v56
    v_accvgpr_read_b32 v160, a160
    v_accvgpr_read_b32 v161, a161
    v_accvgpr_read_b32 v162, a162
    v_accvgpr_read_b32 v163, a163
    v_accvgpr_read_b32 v164, a164
    v_accvgpr_read_b32 v165, a165
    v_accvgpr_read_b32 v166, a166
    v_accvgpr_read_b32 v167, a167
    v_accvgpr_read_b32 v168, a168
    v_accvgpr_read_b32 v169, a169
    v_accvgpr_read_b32 v170, a170
    v_accvgpr_read_b32 v171, a171
    v_accvgpr_read_b32 v172, a172
    v_accvgpr_read_b32 v173, a173
    v_accvgpr_read_b32 v174, a174
    v_accvgpr_read_b32 v175, a175
    v_pk_mul_f32 v[160:161], v[160:161], v[58:59] op_sel_hi:[1,0]
    v_pk_mul_f32 v[162:163], v[162:163], v[58:59] op_sel_hi:[1,0]
    v_pk_mul_f32 v[164:165], v[164:165], v[58:59] op_sel_hi:[1,0]
    v_pk_mul_f32 v[166:167], v[166:167], v[58:59] op_sel_hi:[1,0]
    v_pk_mul_f32 v[168:169], v[168:169], v[58:59] op_sel_hi:[1,0]
    v_pk_mul_f32 v[170:171], v[170:171], v[58:59] op_sel_hi:[1,0]
    v_pk_mul_f32 v[172:173], v[172:173], v[58:59] op_sel_hi:[1,0]
    v_pk_mul_f32 v[174:175], v[174:175], v[58:59] op_sel_hi:[1,0]
    v_cvt_pk_bf16_f32 v160, v160, v161
    v_cvt_pk_bf16_f32 v161, v162, v163
    v_cvt_pk_bf16_f32 v162, v164, v165
    v_cvt_pk_bf16_f32 v163, v166, v167
    v_cvt_pk_bf16_f32 v164, v168, v169
    v_cvt_pk_bf16_f32 v165, v170, v171
    v_cvt_pk_bf16_f32 v166, v172, v173
    v_cvt_pk_bf16_f32 v167, v174, v175
    ds_write_b128 v62, v[160:163] offset:0
    ds_write_b128 v62, v[164:167] offset:512
    v_accvgpr_read_b32 v176, a176
    v_accvgpr_read_b32 v177, a177
    v_accvgpr_read_b32 v178, a178
    v_accvgpr_read_b32 v179, a179
    v_accvgpr_read_b32 v180, a180
    v_accvgpr_read_b32 v181, a181
    v_accvgpr_read_b32 v182, a182
    v_accvgpr_read_b32 v183, a183
    v_accvgpr_read_b32 v184, a184
    v_accvgpr_read_b32 v185, a185
    v_accvgpr_read_b32 v186, a186
    v_accvgpr_read_b32 v187, a187
    v_accvgpr_read_b32 v188, a188
    v_accvgpr_read_b32 v189, a189
    v_accvgpr_read_b32 v190, a190
    v_accvgpr_read_b32 v191, a191
    v_pk_mul_f32 v[176:177], v[176:177], v[60:61] op_sel_hi:[1,0]
    v_pk_mul_f32 v[178:179], v[178:179], v[60:61] op_sel_hi:[1,0]
    v_pk_mul_f32 v[180:181], v[180:181], v[60:61] op_sel_hi:[1,0]
    v_pk_mul_f32 v[182:183], v[182:183], v[60:61] op_sel_hi:[1,0]
    v_pk_mul_f32 v[184:185], v[184:185], v[60:61] op_sel_hi:[1,0]
    v_pk_mul_f32 v[186:187], v[186:187], v[60:61] op_sel_hi:[1,0]
    v_pk_mul_f32 v[188:189], v[188:189], v[60:61] op_sel_hi:[1,0]
    v_pk_mul_f32 v[190:191], v[190:191], v[60:61] op_sel_hi:[1,0]
    v_cvt_pk_bf16_f32 v176, v176, v177
    v_cvt_pk_bf16_f32 v177, v178, v179
    v_cvt_pk_bf16_f32 v178, v180, v181
    v_cvt_pk_bf16_f32 v179, v182, v183
    v_cvt_pk_bf16_f32 v180, v184, v185
    v_cvt_pk_bf16_f32 v181, v186, v187
    v_cvt_pk_bf16_f32 v182, v188, v189
    v_cvt_pk_bf16_f32 v183, v190, v191
    ds_write_b128 v62, v[176:179] offset:2048
    ds_write_b128 v62, v[180:183] offset:2560
    s_lshl_b32 s43, s34, 2
    s_add_u32 s43, s43, 2
    s_sub_u32 s43, s43, s35
    s_and_b32 s43, s43, 15
    s_lshl_b32 s43, s43, 12
    v_add_u32 v61, s43, v56
    v_accvgpr_read_b32 v192, a192
    v_accvgpr_read_b32 v193, a193
    v_accvgpr_read_b32 v194, a194
    v_accvgpr_read_b32 v195, a195
    v_accvgpr_read_b32 v196, a196
    v_accvgpr_read_b32 v197, a197
    v_accvgpr_read_b32 v198, a198
    v_accvgpr_read_b32 v199, a199
    v_accvgpr_read_b32 v200, a200
    v_accvgpr_read_b32 v201, a201
    v_accvgpr_read_b32 v202, a202
    v_accvgpr_read_b32 v203, a203
    v_accvgpr_read_b32 v204, a204
    v_accvgpr_read_b32 v205, a205
    v_accvgpr_read_b32 v206, a206
    v_accvgpr_read_b32 v207, a207
    v_pk_mul_f32 v[192:193], v[192:193], v[58:59] op_sel_hi:[1,0]
    v_pk_mul_f32 v[194:195], v[194:195], v[58:59] op_sel_hi:[1,0]
    v_pk_mul_f32 v[196:197], v[196:197], v[58:59] op_sel_hi:[1,0]
    v_pk_mul_f32 v[198:199], v[198:199], v[58:59] op_sel_hi:[1,0]
    v_pk_mul_f32 v[200:201], v[200:201], v[58:59] op_sel_hi:[1,0]
    v_pk_mul_f32 v[202:203], v[202:203], v[58:59] op_sel_hi:[1,0]
    v_pk_mul_f32 v[204:205], v[204:205], v[58:59] op_sel_hi:[1,0]
    v_pk_mul_f32 v[206:207], v[206:207], v[58:59] op_sel_hi:[1,0]
    v_cvt_pk_bf16_f32 v192, v192, v193
    v_cvt_pk_bf16_f32 v193, v194, v195
    v_cvt_pk_bf16_f32 v194, v196, v197
    v_cvt_pk_bf16_f32 v195, v198, v199
    v_cvt_pk_bf16_f32 v196, v200, v201
    v_cvt_pk_bf16_f32 v197, v202, v203
    v_cvt_pk_bf16_f32 v198, v204, v205
    v_cvt_pk_bf16_f32 v199, v206, v207
    ds_write_b128 v61, v[192:195] offset:0
    ds_write_b128 v61, v[196:199] offset:512
    v_accvgpr_read_b32 v208, a208
    v_accvgpr_read_b32 v209, a209
    v_accvgpr_read_b32 v210, a210
    v_accvgpr_read_b32 v211, a211
    v_accvgpr_read_b32 v212, a212
    v_accvgpr_read_b32 v213, a213
    v_accvgpr_read_b32 v214, a214
    v_accvgpr_read_b32 v215, a215
    v_accvgpr_read_b32 v216, a216
    v_accvgpr_read_b32 v217, a217
    v_accvgpr_read_b32 v218, a218
    v_accvgpr_read_b32 v219, a219
    v_accvgpr_read_b32 v220, a220
    v_accvgpr_read_b32 v221, a221
    v_accvgpr_read_b32 v222, a222
    v_accvgpr_read_b32 v223, a223
    v_pk_mul_f32 v[208:209], v[208:209], v[60:61] op_sel_hi:[1,0]
    v_pk_mul_f32 v[210:211], v[210:211], v[60:61] op_sel_hi:[1,0]
    v_pk_mul_f32 v[212:213], v[212:213], v[60:61] op_sel_hi:[1,0]
    v_pk_mul_f32 v[214:215], v[214:215], v[60:61] op_sel_hi:[1,0]
    v_pk_mul_f32 v[216:217], v[216:217], v[60:61] op_sel_hi:[1,0]
    v_pk_mul_f32 v[218:219], v[218:219], v[60:61] op_sel_hi:[1,0]
    v_pk_mul_f32 v[220:221], v[220:221], v[60:61] op_sel_hi:[1,0]
    v_pk_mul_f32 v[222:223], v[222:223], v[60:61] op_sel_hi:[1,0]
    v_cvt_pk_bf16_f32 v208, v208, v209
    v_cvt_pk_bf16_f32 v209, v210, v211
    v_cvt_pk_bf16_f32 v210, v212, v213
    v_cvt_pk_bf16_f32 v211, v214, v215
    v_cvt_pk_bf16_f32 v212, v216, v217
    v_cvt_pk_bf16_f32 v213, v218, v219
    v_cvt_pk_bf16_f32 v214, v220, v221
    v_cvt_pk_bf16_f32 v215, v222, v223
    ds_write_b128 v61, v[208:211] offset:2048
    ds_write_b128 v61, v[212:215] offset:2560
    s_lshl_b32 s43, s34, 2
    s_add_u32 s43, s43, 3
    s_sub_u32 s43, s43, s35
    s_and_b32 s43, s43, 15
    s_lshl_b32 s43, s43, 12
    v_add_u32 v62, s43, v56
    v_accvgpr_read_b32 v224, a224
    v_accvgpr_read_b32 v225, a225
    v_accvgpr_read_b32 v226, a226
    v_accvgpr_read_b32 v227, a227
    v_accvgpr_read_b32 v228, a228
    v_accvgpr_read_b32 v229, a229
    v_accvgpr_read_b32 v230, a230
    v_accvgpr_read_b32 v231, a231
    v_accvgpr_read_b32 v232, a232
    v_accvgpr_read_b32 v233, a233
    v_accvgpr_read_b32 v234, a234
    v_accvgpr_read_b32 v235, a235
    v_accvgpr_read_b32 v236, a236
    v_accvgpr_read_b32 v237, a237
    v_accvgpr_read_b32 v238, a238
    v_accvgpr_read_b32 v239, a239
    v_pk_mul_f32 v[224:225], v[224:225], v[58:59] op_sel_hi:[1,0]
    v_pk_mul_f32 v[226:227], v[226:227], v[58:59] op_sel_hi:[1,0]
    v_pk_mul_f32 v[228:229], v[228:229], v[58:59] op_sel_hi:[1,0]
    v_pk_mul_f32 v[230:231], v[230:231], v[58:59] op_sel_hi:[1,0]
    v_pk_mul_f32 v[232:233], v[232:233], v[58:59] op_sel_hi:[1,0]
    v_pk_mul_f32 v[234:235], v[234:235], v[58:59] op_sel_hi:[1,0]
    v_pk_mul_f32 v[236:237], v[236:237], v[58:59] op_sel_hi:[1,0]
    v_pk_mul_f32 v[238:239], v[238:239], v[58:59] op_sel_hi:[1,0]
    v_cvt_pk_bf16_f32 v224, v224, v225
    v_cvt_pk_bf16_f32 v225, v226, v227
    v_cvt_pk_bf16_f32 v226, v228, v229
    v_cvt_pk_bf16_f32 v227, v230, v231
    v_cvt_pk_bf16_f32 v228, v232, v233
    v_cvt_pk_bf16_f32 v229, v234, v235
    v_cvt_pk_bf16_f32 v230, v236, v237
    v_cvt_pk_bf16_f32 v231, v238, v239
    ds_write_b128 v62, v[224:227] offset:0
    ds_write_b128 v62, v[228:231] offset:512
    v_accvgpr_read_b32 v240, a240
    v_accvgpr_read_b32 v241, a241
    v_accvgpr_read_b32 v242, a242
    v_accvgpr_read_b32 v243, a243
    v_accvgpr_read_b32 v244, a244
    v_accvgpr_read_b32 v245, a245
    v_accvgpr_read_b32 v246, a246
    v_accvgpr_read_b32 v247, a247
    v_accvgpr_read_b32 v248, a248
    v_accvgpr_read_b32 v249, a249
    v_accvgpr_read_b32 v250, a250
    v_accvgpr_read_b32 v251, a251
    v_accvgpr_read_b32 v252, a252
    v_accvgpr_read_b32 v253, a253
    v_accvgpr_read_b32 v254, a254
    v_accvgpr_read_b32 v255, a255
    v_pk_mul_f32 v[240:241], v[240:241], v[60:61] op_sel_hi:[1,0]
    v_pk_mul_f32 v[242:243], v[242:243], v[60:61] op_sel_hi:[1,0]
    v_pk_mul_f32 v[244:245], v[244:245], v[60:61] op_sel_hi:[1,0]
    v_pk_mul_f32 v[246:247], v[246:247], v[60:61] op_sel_hi:[1,0]
    v_pk_mul_f32 v[248:249], v[248:249], v[60:61] op_sel_hi:[1,0]
    v_pk_mul_f32 v[250:251], v[250:251], v[60:61] op_sel_hi:[1,0]
    v_pk_mul_f32 v[252:253], v[252:253], v[60:61] op_sel_hi:[1,0]
    v_pk_mul_f32 v[254:255], v[254:255], v[60:61] op_sel_hi:[1,0]
    v_cvt_pk_bf16_f32 v240, v240, v241
    v_cvt_pk_bf16_f32 v241, v242, v243
    v_cvt_pk_bf16_f32 v242, v244, v245
    v_cvt_pk_bf16_f32 v243, v246, v247
    v_cvt_pk_bf16_f32 v244, v248, v249
    v_cvt_pk_bf16_f32 v245, v250, v251
    v_cvt_pk_bf16_f32 v246, v252, v253
    v_cvt_pk_bf16_f32 v247, v254, v255
    ds_write_b128 v62, v[240:243] offset:2048
    ds_write_b128 v62, v[244:247] offset:2560
    s_cmp_eq_u64 s[64:65], -1
    s_cselect_b32 s44, 0, 1
    s_cmp_eq_u32 s70, 0
    s_cselect_b32 s44, s44, 0
    s_cmp_eq_u32 s44, 0
    s_cbranch_scc1 L_noflag
    s_lshl_b32 s42, s34, 2
    s_sub_u32 s42, s42, s35
    s_and_b32 s42, s42, 15
    s_lshl_b32 s42, s42, 12
    v_mov_b32 v58, s42
    v_mov_b32 v59, -1
    ds_write_b32 v58, v59
L_noflag:
    s_sub_u32 s42, 0, s35
    s_and_b32 s42, s42, 15
    s_lshl_b32 s42, s42, 12
    v_mov_b32 v58, s42
    s_sub_u32 s42, 4, s35
    s_and_b32 s42, s42, 15
    s_lshl_b32 s42, s42, 12
    v_mov_b32 v59, s42
    s_sub_u32 s42, 8, s35
    s_and_b32 s42, s42, 15
    s_lshl_b32 s42, s42, 12
    v_mov_b32 v60, s42
    s_sub_u32 s42, 12, s35
    s_and_b32 s42, s42, 15
    s_lshl_b32 s42, s42, 12
    v_mov_b32 v61, s42
    s_lshl_b32 s43, s34, 11
    v_lshlrev_b32 v62, 5, v0
    v_add_u32 v62, s43, v62
    v_add_u32 v62, 16777216, v62
    v_lshlrev_b32 v30, 4, v0
    s_mov_b32 s48, 4096
    s_mov_b32 s49, 32768
    s_mov_b32 s50, 36864
    s_waitcnt lgkmcnt(0)
    s_barrier
    ds_read_b32 v58, v58
    ds_read_b32 v59, v59
    ds_read_b32 v60, v60
    ds_read_b32 v61, v61
    s_waitcnt vmcnt(14)
    ds_read_b128 a[48:51], v30 offset:0
    ds_read_b128 a[52:55], v30 offset:1024
    ds_read_b128 a[56:59], v30 offset:2048
    ds_read_b128 a[60:63], v30 offset:3072
    ds_read_b64_tr_b16 a[0:1], v22 offset:0
    ds_read_b64_tr_b16 a[2:3], v22 offset:1024
    ds_read_b64_tr_b16 a[4:5], v23 offset:0
    ds_read_b64_tr_b16 a[6:7], v23 offset:1024
    ds_read_b64_tr_b16 a[8:9], v24 offset:0
    ds_read_b64_tr_b16 a[10:11], v24 offset:1024
    ds_read_b64_tr_b16 a[12:13], v25 offset:0
    ds_read_b64_tr_b16 a[14:15], v25 offset:1024
    s_add_u32 m0, s40, 16384
    s_nop 0
    buffer_load_dwordx4 v5, s[20:23], s37 offen offset:0 lds
    buffer_load_dwordx4 v6, s[20:23], s37 offen offset:1024 lds
    buffer_load_dwordx4 v7, s[20:23], s37 offen offset:2048 lds
    buffer_load_dwordx4 v8, s[20:23], s37 offen offset:3072 lds
    s_add_u32 s37, s37, 32768
    s_and_b32 s37, s37, 524287
    s_waitcnt lgkmcnt(12)
    v_max_u32 v58, v58, v59
    v_max_u32 v60, v60, v61
    v_max_u32 v58, v58, v60
    s_nop 0
    v_readfirstlane_b32 s42, v58
    s_nop 0
    s_cmp_eq_u32 s42, -1
    s_cbranch_scc1 L_fallback
L_p3_start:
    s_waitcnt vmcnt(12)
    v_readfirstlane_b32 s42, v2
    s_nop 0
    s_cmp_ge_u32 s42, 256
    s_cselect_b32 s99, 1, 0
    buffer_load_dwordx4 v[88:91], v62, s[24:27], 0 offen sc1
    buffer_load_dwordx4 v[92:95], v62, s[24:27], 0 offen offset:16 sc1
    s_waitcnt vmcnt(12)
    s_waitcnt lgkmcnt(0)
    v_mfma_f32_16x16x32_bf16 v[128:131], a[0:3], a[48:51], 0
    ds_read_b64_tr_b16 a[16:17], v22 offset:4096
    s_add_u32 m0, s40, 0
    v_mfma_f32_16x16x32_bf16 v[132:135], a[0:3], a[52:55], 0
    ds_read_b64_tr_b16 a[18:19], v22 offset:5120
    v_mfma_f32_16x16x32_bf16 v[136:139], a[0:3], a[56:59], 0
    ds_read_b64_tr_b16 a[20:21], v23 offset:4096
    buffer_load_dwordx4 v5, s[20:23], s37 offen offset:0 lds
    v_mfma_f32_16x16x32_bf16 v[140:143], a[0:3], a[60:63], 0
    ds_read_b64_tr_b16 a[22:23], v23 offset:5120
    v_mfma_f32_16x16x32_bf16 v[144:147], a[4:7], a[48:51], 0
    ds_read_b64_tr_b16 a[24:25], v24 offset:4096
    v_mfma_f32_16x16x32_bf16 v[148:151], a[4:7], a[52:55], 0
    ds_read_b64_tr_b16 a[26:27], v24 offset:5120
    v_mfma_f32_16x16x32_bf16 v[152:155], a[4:7], a[56:59], 0
    ds_read_b64_tr_b16 a[28:29], v25 offset:4096
    buffer_load_dwordx4 v6, s[20:23], s37 offen offset:1024 lds
    v_mfma_f32_16x16x32_bf16 v[156:159], a[4:7], a[60:63], 0
    ds_read_b64_tr_b16 a[30:31], v25 offset:5120
    v_mfma_f32_16x16x32_bf16 v[160:163], a[8:11], a[48:51], 0
    ds_read_b128 a[64:67], v30 offset:4096
    v_mfma_f32_16x16x32_bf16 v[164:167], a[8:11], a[52:55], 0
    ds_read_b128 a[68:71], v30 offset:5120
    v_mfma_f32_16x16x32_bf16 v[168:171], a[8:11], a[56:59], 0
    ds_read_b128 a[72:75], v30 offset:6144
    v_mfma_f32_16x16x32_bf16 v[172:175], a[8:11], a[60:63], 0
    ds_read_b128 a[76:79], v30 offset:7168
    v_mfma_f32_16x16x32_bf16 v[176:179], a[12:15], a[48:51], 0
    buffer_load_dwordx4 v7, s[20:23], s37 offen offset:2048 lds
    v_mfma_f32_16x16x32_bf16 v[180:183], a[12:15], a[52:55], 0
    v_mfma_f32_16x16x32_bf16 v[184:187], a[12:15], a[56:59], 0
    buffer_load_dwordx4 v8, s[20:23], s37 offen offset:3072 lds
    v_mfma_f32_16x16x32_bf16 v[188:191], a[12:15], a[60:63], 0
    s_add_u32 s37, s37, 32768
    s_and_b32 s37, s37, 524287
    s_waitcnt vmcnt(12)
    s_waitcnt lgkmcnt(0)
    v_mfma_f32_16x16x32_bf16 v[128:131], a[16:19], a[64:67], v[128:131]
    ds_read_b64_tr_b16 a[32:33], v22 offset:8192
    s_add_u32 m0, s40, 4096
    v_mfma_f32_16x16x32_bf16 v[132:135], a[16:19], a[68:71], v[132:135]
    ds_read_b64_tr_b16 a[34:35], v22 offset:9216
    v_mfma_f32_16x16x32_bf16 v[136:139], a[16:19], a[72:75], v[136:139]
    ds_read_b64_tr_b16 a[36:37], v23 offset:8192
    buffer_load_dwordx4 v5, s[20:23], s37 offen offset:0 lds
    v_mfma_f32_16x16x32_bf16 v[140:143], a[16:19], a[76:79], v[140:143]
    ds_read_b64_tr_b16 a[38:39], v23 offset:9216
    v_mfma_f32_16x16x32_bf16 v[144:147], a[20:23], a[64:67], v[144:147]
    ds_read_b64_tr_b16 a[40:41], v24 offset:8192
    v_mfma_f32_16x16x32_bf16 v[148:151], a[20:23], a[68:71], v[148:151]
    ds_read_b64_tr_b16 a[42:43], v24 offset:9216
    v_mfma_f32_16x16x32_bf16 v[152:155], a[20:23], a[72:75], v[152:155]
    ds_read_b64_tr_b16 a[44:45], v25 offset:8192
    buffer_load_dwordx4 v6, s[20:23], s37 offen offset:1024 lds
    v_mfma_f32_16x16x32_bf16 v[156:159], a[20:23], a[76:79], v[156:159]
    ds_read_b64_tr_b16 a[46:47], v25 offset:9216
    v_mfma_f32_16x16x32_bf16 v[160:163], a[24:27], a[64:67], v[160:163]
    ds_read_b128 a[80:83], v30 offset:8192
    v_mfma_f32_16x16x32_bf16 v[164:167], a[24:27], a[68:71], v[164:167]
    ds_read_b128 a[84:87], v30 offset:9216
    v_mfma_f32_16x16x32_bf16 v[168:171], a[24:27], a[72:75], v[168:171]
    ds_read_b128 a[88:91], v30 offset:10240
    v_mfma_f32_16x16x32_bf16 v[172:175], a[24:27], a[76:79], v[172:175]
    ds_read_b128 a[92:95], v30 offset:11264
    v_mfma_f32_16x16x32_bf16 v[176:179], a[28:31], a[64:67], v[176:179]
    buffer_load_dwordx4 v7, s[20:23], s37 offen offset:2048 lds
    v_mfma_f32_16x16x32_bf16 v[180:183], a[28:31], a[68:71], v[180:183]
    v_mfma_f32_16x16x32_bf16 v[184:187], a[28:31], a[72:75], v[184:187]
    buffer_load_dwordx4 v8, s[20:23], s37 offen offset:3072 lds
    v_mfma_f32_16x16x32_bf16 v[188:191], a[28:31], a[76:79], v[188:191]
    s_add_u32 s37, s37, 32768
    s_and_b32 s37, s37, 524287
    s_waitcnt vmcnt(12)
    s_waitcnt lgkmcnt(0)
    v_mfma_f32_16x16x32_bf16 v[128:131], a[32:35], a[80:83], v[128:131]
    ds_read_b64_tr_b16 a[0:1], v22 offset:12288
    s_add_u32 m0, s40, 8192
    v_mfma_f32_16x16x32_bf16 v[132:135], a[32:35], a[84:87], v[132:135]
    ds_read_b64_tr_b16 a[2:3], v22 offset:13312
    v_mfma_f32_16x16x32_bf16 v[136:139], a[32:35], a[88:91], v[136:139]
    ds_read_b64_tr_b16 a[4:5], v23 offset:12288
    buffer_load_dwordx4 v5, s[20:23], s37 offen offset:0 lds
    v_mfma_f32_16x16x32_bf16 v[140:143], a[32:35], a[92:95], v[140:143]
    ds_read_b64_tr_b16 a[6:7], v23 offset:13312
    v_mfma_f32_16x16x32_bf16 v[144:147], a[36:39], a[80:83], v[144:147]
    ds_read_b64_tr_b16 a[8:9], v24 offset:12288
    v_mfma_f32_16x16x32_bf16 v[148:151], a[36:39], a[84:87], v[148:151]
    ds_read_b64_tr_b16 a[10:11], v24 offset:13312
    v_mfma_f32_16x16x32_bf16 v[152:155], a[36:39], a[88:91], v[152:155]
    ds_read_b64_tr_b16 a[12:13], v25 offset:12288
    buffer_load_dwordx4 v6, s[20:23], s37 offen offset:1024 lds
    v_mfma_f32_16x16x32_bf16 v[156:159], a[36:39], a[92:95], v[156:159]
    ds_read_b64_tr_b16 a[14:15], v25 offset:13312
    v_mfma_f32_16x16x32_bf16 v[160:163], a[40:43], a[80:83], v[160:163]
    ds_read_b128 a[48:51], v30 offset:12288
    v_mfma_f32_16x16x32_bf16 v[164:167], a[40:43], a[84:87], v[164:167]
    ds_read_b128 a[52:55], v30 offset:13312
    v_mfma_f32_16x16x32_bf16 v[168:171], a[40:43], a[88:91], v[168:171]
    ds_read_b128 a[56:59], v30 offset:14336
    v_mfma_f32_16x16x32_bf16 v[172:175], a[40:43], a[92:95], v[172:175]
    ds_read_b128 a[60:63], v30 offset:15360
    v_mfma_f32_16x16x32_bf16 v[176:179], a[44:47], a[80:83], v[176:179]
    buffer_load_dwordx4 v7, s[20:23], s37 offen offset:2048 lds
    v_mfma_f32_16x16x32_bf16 v[180:183], a[44:47], a[84:87], v[180:183]
    v_mfma_f32_16x16x32_bf16 v[184:187], a[44:47], a[88:91], v[184:187]
    buffer_load_dwordx4 v8, s[20:23], s37 offen offset:3072 lds
    v_mfma_f32_16x16x32_bf16 v[188:191], a[44:47], a[92:95], v[188:191]
    s_add_u32 s37, s37, 32768
    s_and_b32 s37, s37, 524287
    s_waitcnt vmcnt(12)
    s_waitcnt lgkmcnt(0)
    v_mfma_f32_16x16x32_bf16 v[128:131], a[0:3], a[48:51], v[128:131]
    ds_read_b64_tr_b16 a[16:17], v22 offset:16384
    s_add_u32 m0, s40, 12288
    v_mfma_f32_16x16x32_bf16 v[132:135], a[0:3], a[52:55], v[132:135]
    ds_read_b64_tr_b16 a[18:19], v22 offset:17408
    v_mfma_f32_16x16x32_bf16 v[136:139], a[0:3], a[56:59], v[136:139]
    ds_read_b64_tr_b16 a[20:21], v23 offset:16384
    buffer_load_dwordx4 v5, s[20:23], s37 offen offset:0 lds
    v_mfma_f32_16x16x32_bf16 v[140:143], a[0:3], a[60:63], v[140:143]
    ds_read_b64_tr_b16 a[22:23], v23 offset:17408
    v_mfma_f32_16x16x32_bf16 v[144:147], a[4:7], a[48:51], v[144:147]
    ds_read_b64_tr_b16 a[24:25], v24 offset:16384
    v_mfma_f32_16x16x32_bf16 v[148:151], a[4:7], a[52:55], v[148:151]
    ds_read_b64_tr_b16 a[26:27], v24 offset:17408
    v_mfma_f32_16x16x32_bf16 v[152:155], a[4:7], a[56:59], v[152:155]
    ds_read_b64_tr_b16 a[28:29], v25 offset:16384
    buffer_load_dwordx4 v6, s[20:23], s37 offen offset:1024 lds
    v_mfma_f32_16x16x32_bf16 v[156:159], a[4:7], a[60:63], v[156:159]
    ds_read_b64_tr_b16 a[30:31], v25 offset:17408
    v_mfma_f32_16x16x32_bf16 v[160:163], a[8:11], a[48:51], v[160:163]
    ds_read_b128 a[64:67], v30 offset:16384
    v_mfma_f32_16x16x32_bf16 v[164:167], a[8:11], a[52:55], v[164:167]
    ds_read_b128 a[68:71], v30 offset:17408
    v_mfma_f32_16x16x32_bf16 v[168:171], a[8:11], a[56:59], v[168:171]
    ds_read_b128 a[72:75], v30 offset:18432
    v_mfma_f32_16x16x32_bf16 v[172:175], a[8:11], a[60:63], v[172:175]
    ds_read_b128 a[76:79], v30 offset:19456
    v_mfma_f32_16x16x32_bf16 v[176:179], a[12:15], a[48:51], v[176:179]
    buffer_load_dwordx4 v7, s[20:23], s37 offen offset:2048 lds
    v_mfma_f32_16x16x32_bf16 v[180:183], a[12:15], a[52:55], v[180:183]
    v_mfma_f32_16x16x32_bf16 v[184:187], a[12:15], a[56:59], v[184:187]
    buffer_load_dwordx4 v8, s[20:23], s37 offen offset:3072 lds
    v_mfma_f32_16x16x32_bf16 v[188:191], a[12:15], a[60:63], v[188:191]
    s_add_u32 s37, s37, 32768
    s_and_b32 s37, s37, 524287
    s_waitcnt vmcnt(12)
    s_waitcnt lgkmcnt(0)
    v_mfma_f32_16x16x32_bf16 v[128:131], a[16:19], a[64:67], v[128:131]
    ds_read_b64_tr_b16 a[32:33], v22 offset:0
    s_add_u32 m0, s40, 16384
    v_mfma_f32_16x16x32_bf16 v[132:135], a[16:19], a[68:71], v[132:135]
    ds_read_b64_tr_b16 a[34:35], v22 offset:1024
    v_mfma_f32_16x16x32_bf16 v[136:139], a[16:19], a[72:75], v[136:139]
    ds_read_b64_tr_b16 a[36:37], v23 offset:0
    buffer_load_dwordx4 v5, s[20:23], s37 offen offset:0 lds
    v_mfma_f32_16x16x32_bf16 v[140:143], a[16:19], a[76:79], v[140:143]
    ds_read_b64_tr_b16 a[38:39], v23 offset:1024
    v_mfma_f32_16x16x32_bf16 v[144:147], a[20:23], a[64:67], v[144:147]
    ds_read_b64_tr_b16 a[40:41], v24 offset:0
    v_mfma_f32_16x16x32_bf16 v[148:151], a[20:23], a[68:71], v[148:151]
    ds_read_b64_tr_b16 a[42:43], v24 offset:1024
    v_mfma_f32_16x16x32_bf16 v[152:155], a[20:23], a[72:75], v[152:155]
    ds_read_b64_tr_b16 a[44:45], v25 offset:0
    buffer_load_dwordx4 v6, s[20:23], s37 offen offset:1024 lds
    v_mfma_f32_16x16x32_bf16 v[156:159], a[20:23], a[76:79], v[156:159]
    ds_read_b64_tr_b16 a[46:47], v25 offset:1024
    v_mfma_f32_16x16x32_bf16 v[160:163], a[24:27], a[64:67], v[160:163]
    ds_read_b128 a[80:83], v30 offset:20480
    v_mfma_f32_16x16x32_bf16 v[164:167], a[24:27], a[68:71], v[164:167]
    ds_read_b128 a[84:87], v30 offset:21504
    v_mfma_f32_16x16x32_bf16 v[168:171], a[24:27], a[72:75], v[168:171]
    ds_read_b128 a[88:91], v30 offset:22528
    v_mfma_f32_16x16x32_bf16 v[172:175], a[24:27], a[76:79], v[172:175]
    ds_read_b128 a[92:95], v30 offset:23552
    v_mfma_f32_16x16x32_bf16 v[176:179], a[28:31], a[64:67], v[176:179]
    buffer_load_dwordx4 v7, s[20:23], s37 offen offset:2048 lds
    v_mfma_f32_16x16x32_bf16 v[180:183], a[28:31], a[68:71], v[180:183]
    v_mfma_f32_16x16x32_bf16 v[184:187], a[28:31], a[72:75], v[184:187]
    buffer_load_dwordx4 v8, s[20:23], s37 offen offset:3072 lds
    v_mfma_f32_16x16x32_bf16 v[188:191], a[28:31], a[76:79], v[188:191]
    s_add_u32 s37, s37, 32768
    s_and_b32 s37, s37, 524287
    s_waitcnt vmcnt(12)
    s_waitcnt lgkmcnt(0)
    v_mfma_f32_16x16x32_bf16 v[128:131], a[32:35], a[80:83], v[128:131]
    ds_read_b64_tr_b16 a[0:1], v22 offset:4096
    s_add_u32 m0, s40, 0
    v_mfma_f32_16x16x32_bf16 v[132:135], a[32:35], a[84:87], v[132:135]
    ds_read_b64_tr_b16 a[2:3], v22 offset:5120
    v_mfma_f32_16x16x32_bf16 v[136:139], a[32:35], a[88:91], v[136:139]
    ds_read_b64_tr_b16 a[4:5], v23 offset:4096
    buffer_load_dwordx4 v5, s[20:23], s37 offen offset:0 lds
    v_mfma_f32_16x16x32_bf16 v[140:143], a[32:35], a[92:95], v[140:143]
    ds_read_b64_tr_b16 a[6:7], v23 offset:5120
    v_mfma_f32_16x16x32_bf16 v[144:147], a[36:39], a[80:83], v[144:147]
    ds_read_b64_tr_b16 a[8:9], v24 offset:4096
    v_mfma_f32_16x16x32_bf16 v[148:151], a[36:39], a[84:87], v[148:151]
    ds_read_b64_tr_b16 a[10:11], v24 offset:5120
    v_mfma_f32_16x16x32_bf16 v[152:155], a[36:39], a[88:91], v[152:155]
    ds_read_b64_tr_b16 a[12:13], v25 offset:4096
    buffer_load_dwordx4 v6, s[20:23], s37 offen offset:1024 lds
    v_mfma_f32_16x16x32_bf16 v[156:159], a[36:39], a[92:95], v[156:159]
    ds_read_b64_tr_b16 a[14:15], v25 offset:5120
    v_mfma_f32_16x16x32_bf16 v[160:163], a[40:43], a[80:83], v[160:163]
    ds_read_b128 a[48:51], v30 offset:24576
    v_mfma_f32_16x16x32_bf16 v[164:167], a[40:43], a[84:87], v[164:167]
    ds_read_b128 a[52:55], v30 offset:25600
    v_mfma_f32_16x16x32_bf16 v[168:171], a[40:43], a[88:91], v[168:171]
    ds_read_b128 a[56:59], v30 offset:26624
    v_mfma_f32_16x16x32_bf16 v[172:175], a[40:43], a[92:95], v[172:175]
    ds_read_b128 a[60:63], v30 offset:27648
    v_mfma_f32_16x16x32_bf16 v[176:179], a[44:47], a[80:83], v[176:179]
    buffer_load_dwordx4 v7, s[20:23], s37 offen offset:2048 lds
    v_mfma_f32_16x16x32_bf16 v[180:183], a[44:47], a[84:87], v[180:183]
    v_mfma_f32_16x16x32_bf16 v[184:187], a[44:47], a[88:91], v[184:187]
    buffer_load_dwordx4 v8, s[20:23], s37 offen offset:3072 lds
    v_mfma_f32_16x16x32_bf16 v[188:191], a[44:47], a[92:95], v[188:191]
    s_add_u32 s37, s37, 32768
    s_and_b32 s37, s37, 524287
    s_waitcnt vmcnt(12)
    s_waitcnt lgkmcnt(0)
    v_mfma_f32_16x16x32_bf16 v[128:131], a[0:3], a[48:51], v[128:131]
    ds_read_b64_tr_b16 a[16:17], v22 offset:8192
    s_add_u32 m0, s40, 4096
    v_mfma_f32_16x16x32_bf16 v[132:135], a[0:3], a[52:55], v[132:135]
    ds_read_b64_tr_b16 a[18:19], v22 offset:9216
    v_mfma_f32_16x16x32_bf16 v[136:139], a[0:3], a[56:59], v[136:139]
    ds_read_b64_tr_b16 a[20:21], v23 offset:8192
    buffer_load_dwordx4 v5, s[20:23], s37 offen offset:0 lds
    v_mfma_f32_16x16x32_bf16 v[140:143], a[0:3], a[60:63], v[140:143]
    ds_read_b64_tr_b16 a[22:23], v23 offset:9216
    v_mfma_f32_16x16x32_bf16 v[144:147], a[4:7], a[48:51], v[144:147]
    ds_read_b64_tr_b16 a[24:25], v24 offset:8192
    v_mfma_f32_16x16x32_bf16 v[148:151], a[4:7], a[52:55], v[148:151]
    ds_read_b64_tr_b16 a[26:27], v24 offset:9216
    v_mfma_f32_16x16x32_bf16 v[152:155], a[4:7], a[56:59], v[152:155]
    ds_read_b64_tr_b16 a[28:29], v25 offset:8192
    buffer_load_dwordx4 v6, s[20:23], s37 offen offset:1024 lds
    v_mfma_f32_16x16x32_bf16 v[156:159], a[4:7], a[60:63], v[156:159]
    ds_read_b64_tr_b16 a[30:31], v25 offset:9216
    v_mfma_f32_16x16x32_bf16 v[160:163], a[8:11], a[48:51], v[160:163]
    ds_read_b128 a[64:67], v30 offset:28672
    v_mfma_f32_16x16x32_bf16 v[164:167], a[8:11], a[52:55], v[164:167]
    ds_read_b128 a[68:71], v30 offset:29696
    v_mfma_f32_16x16x32_bf16 v[168:171], a[8:11], a[56:59], v[168:171]
    ds_read_b128 a[72:75], v30 offset:30720
    v_mfma_f32_16x16x32_bf16 v[172:175], a[8:11], a[60:63], v[172:175]
    ds_read_b128 a[76:79], v30 offset:31744
    v_mfma_f32_16x16x32_bf16 v[176:179], a[12:15], a[48:51], v[176:179]
    buffer_load_dwordx4 v7, s[20:23], s37 offen offset:2048 lds
    v_mfma_f32_16x16x32_bf16 v[180:183], a[12:15], a[52:55], v[180:183]
    v_mfma_f32_16x16x32_bf16 v[184:187], a[12:15], a[56:59], v[184:187]
    buffer_load_dwordx4 v8, s[20:23], s37 offen offset:3072 lds
    v_mfma_f32_16x16x32_bf16 v[188:191], a[12:15], a[60:63], v[188:191]
    s_add_u32 s37, s37, 32768
    s_and_b32 s37, s37, 524287
    s_waitcnt vmcnt(12)
    s_waitcnt lgkmcnt(0)
    v_mfma_f32_16x16x32_bf16 v[128:131], a[16:19], a[64:67], v[128:131]
    ds_read_b64_tr_b16 a[32:33], v22 offset:12288
    s_add_u32 m0, s40, 8192
    v_mfma_f32_16x16x32_bf16 v[132:135], a[16:19], a[68:71], v[132:135]
    ds_read_b64_tr_b16 a[34:35], v22 offset:13312
    v_mfma_f32_16x16x32_bf16 v[136:139], a[16:19], a[72:75], v[136:139]
    ds_read_b64_tr_b16 a[36:37], v23 offset:12288
    buffer_load_dwordx4 v5, s[20:23], s37 offen offset:0 lds
    v_mfma_f32_16x16x32_bf16 v[140:143], a[16:19], a[76:79], v[140:143]
    ds_read_b64_tr_b16 a[38:39], v23 offset:13312
    v_mfma_f32_16x16x32_bf16 v[144:147], a[20:23], a[64:67], v[144:147]
    ds_read_b64_tr_b16 a[40:41], v24 offset:12288
    v_mfma_f32_16x16x32_bf16 v[148:151], a[20:23], a[68:71], v[148:151]
    ds_read_b64_tr_b16 a[42:43], v24 offset:13312
    v_mfma_f32_16x16x32_bf16 v[152:155], a[20:23], a[72:75], v[152:155]
    ds_read_b64_tr_b16 a[44:45], v25 offset:12288
    buffer_load_dwordx4 v6, s[20:23], s37 offen offset:1024 lds
    v_mfma_f32_16x16x32_bf16 v[156:159], a[20:23], a[76:79], v[156:159]
    ds_read_b64_tr_b16 a[46:47], v25 offset:13312
    v_mfma_f32_16x16x32_bf16 v[160:163], a[24:27], a[64:67], v[160:163]
    ds_read_b128 a[80:83], v30 offset:32768
    v_mfma_f32_16x16x32_bf16 v[164:167], a[24:27], a[68:71], v[164:167]
    ds_read_b128 a[84:87], v30 offset:33792
    v_mfma_f32_16x16x32_bf16 v[168:171], a[24:27], a[72:75], v[168:171]
    ds_read_b128 a[88:91], v30 offset:34816
    v_mfma_f32_16x16x32_bf16 v[172:175], a[24:27], a[76:79], v[172:175]
    ds_read_b128 a[92:95], v30 offset:35840
    v_mfma_f32_16x16x32_bf16 v[176:179], a[28:31], a[64:67], v[176:179]
    buffer_load_dwordx4 v7, s[20:23], s37 offen offset:2048 lds
    v_mfma_f32_16x16x32_bf16 v[180:183], a[28:31], a[68:71], v[180:183]
    v_mfma_f32_16x16x32_bf16 v[184:187], a[28:31], a[72:75], v[184:187]
    buffer_load_dwordx4 v8, s[20:23], s37 offen offset:3072 lds
    v_mfma_f32_16x16x32_bf16 v[188:191], a[28:31], a[76:79], v[188:191]
    s_add_u32 s37, s37, 32768
    s_and_b32 s37, s37, 524287
    s_waitcnt vmcnt(12)
    s_waitcnt lgkmcnt(0)
    v_mfma_f32_16x16x32_bf16 v[128:131], a[32:35], a[80:83], v[128:131]
    ds_read_b64_tr_b16 a[0:1], v22 offset:16384
    s_add_u32 m0, s40, 12288
    v_mfma_f32_16x16x32_bf16 v[132:135], a[32:35], a[84:87], v[132:135]
    ds_read_b64_tr_b16 a[2:3], v22 offset:17408
    v_max_u32 v96, v88, v89
    v_mfma_f32_16x16x32_bf16 v[136:139], a[32:35], a[88:91], v[136:139]
    ds_read_b64_tr_b16 a[4:5], v23 offset:16384
    buffer_load_dwordx4 v5, s[20:23], s37 offen offset:0 lds
    v_mfma_f32_16x16x32_bf16 v[140:143], a[32:35], a[92:95], v[140:143]
    ds_read_b64_tr_b16 a[6:7], v23 offset:17408
    v_min_u32 v89, v88, v89
    v_mfma_f32_16x16x32_bf16 v[144:147], a[36:39], a[80:83], v[144:147]
    ds_read_b64_tr_b16 a[8:9], v24 offset:16384
    v_max_u32 v88, v90, v91
    v_mfma_f32_16x16x32_bf16 v[148:151], a[36:39], a[84:87], v[148:151]
    ds_read_b64_tr_b16 a[10:11], v24 offset:17408
    v_min_u32 v91, v90, v91
    v_mfma_f32_16x16x32_bf16 v[152:155], a[36:39], a[88:91], v[152:155]
    ds_read_b64_tr_b16 a[12:13], v25 offset:16384
    buffer_load_dwordx4 v6, s[20:23], s37 offen offset:1024 lds
    v_mfma_f32_16x16x32_bf16 v[156:159], a[36:39], a[92:95], v[156:159]
    ds_read_b64_tr_b16 a[14:15], v25 offset:17408
    v_max_u32 v90, v92, v93
    v_mfma_f32_16x16x32_bf16 v[160:163], a[40:43], a[80:83], v[160:163]
    ds_read_b128 a[48:51], v30 offset:36864
    v_min_u32 v93, v92, v93
    v_mfma_f32_16x16x32_bf16 v[164:167], a[40:43], a[84:87], v[164:167]
    ds_read_b128 a[52:55], v30 offset:37888
    v_max_u32 v92, v94, v95
    v_mfma_f32_16x16x32_bf16 v[168:171], a[40:43], a[88:91], v[168:171]
    ds_read_b128 a[56:59], v30 offset:38912
    v_min_u32 v95, v94, v95
    v_mfma_f32_16x16x32_bf16 v[172:175], a[40:43], a[92:95], v[172:175]
    ds_read_b128 a[60:63], v30 offset:39936
    v_max_u32 v94, v96, v88
    v_mfma_f32_16x16x32_bf16 v[176:179], a[44:47], a[80:83], v[176:179]
    buffer_load_dwordx4 v7, s[20:23], s37 offen offset:2048 lds
    v_min_u32 v88, v96, v88
    v_mfma_f32_16x16x32_bf16 v[180:183], a[44:47], a[84:87], v[180:183]
    v_max_u32 v96, v89, v91
    v_min_u32 v91, v89, v91
    v_mfma_f32_16x16x32_bf16 v[184:187], a[44:47], a[88:91], v[184:187]
    buffer_load_dwordx4 v8, s[20:23], s37 offen offset:3072 lds
    v_max_u32 v89, v90, v92
    v_mfma_f32_16x16x32_bf16 v[188:191], a[44:47], a[92:95], v[188:191]
    s_add_u32 s37, s37, 32768
    s_and_b32 s37, s37, 524287
    v_min_u32 v92, v90, v92
    s_waitcnt vmcnt(12)
    s_waitcnt lgkmcnt(0)
    v_mfma_f32_16x16x32_bf16 v[128:131], a[0:3], a[48:51], v[128:131]
    ds_read_b64_tr_b16 a[16:17], v22 offset:0
    s_add_u32 m0, s40, 16384
    v_mfma_f32_16x16x32_bf16 v[132:135], a[0:3], a[52:55], v[132:135]
    ds_read_b64_tr_b16 a[18:19], v22 offset:1024
    v_max_u32 v90, v93, v95
    v_mfma_f32_16x16x32_bf16 v[136:139], a[0:3], a[56:59], v[136:139]
    ds_read_b64_tr_b16 a[20:21], v23 offset:0
    buffer_load_dwordx4 v5, s[20:23], s37 offen offset:0 lds
    v_mfma_f32_16x16x32_bf16 v[140:143], a[0:3], a[60:63], v[140:143]
    ds_read_b64_tr_b16 a[22:23], v23 offset:1024
    v_min_u32 v95, v93, v95
    v_mfma_f32_16x16x32_bf16 v[144:147], a[4:7], a[48:51], v[144:147]
    ds_read_b64_tr_b16 a[24:25], v24 offset:0
    v_max_u32 v93, v96, v88
    v_mfma_f32_16x16x32_bf16 v[148:151], a[4:7], a[52:55], v[148:151]
    ds_read_b64_tr_b16 a[26:27], v24 offset:1024
    v_min_u32 v88, v96, v88
    v_mfma_f32_16x16x32_bf16 v[152:155], a[4:7], a[56:59], v[152:155]
    ds_read_b64_tr_b16 a[28:29], v25 offset:0
    buffer_load_dwordx4 v6, s[20:23], s37 offen offset:1024 lds
    v_mfma_f32_16x16x32_bf16 v[156:159], a[4:7], a[60:63], v[156:159]
    ds_read_b64_tr_b16 a[30:31], v25 offset:1024
    v_max_u32 v96, v90, v92
    v_mfma_f32_16x16x32_bf16 v[160:163], a[8:11], a[48:51], v[160:163]
    ds_read_b128 a[64:67], v30 offset:40960
    v_min_u32 v92, v90, v92
    v_mfma_f32_16x16x32_bf16 v[164:167], a[8:11], a[52:55], v[164:167]
    ds_read_b128 a[68:71], v30 offset:41984
    v_max_u32 v90, v94, v89
    v_mfma_f32_16x16x32_bf16 v[168:171], a[8:11], a[56:59], v[168:171]
    ds_read_b128 a[72:75], v30 offset:43008
    v_min_u32 v89, v94, v89
    v_mfma_f32_16x16x32_bf16 v[172:175], a[8:11], a[60:63], v[172:175]
    ds_read_b128 a[76:79], v30 offset:44032
    v_max_u32 v94, v91, v95
    v_mfma_f32_16x16x32_bf16 v[176:179], a[12:15], a[48:51], v[176:179]
    buffer_load_dwordx4 v7, s[20:23], s37 offen offset:2048 lds
    v_min_u32 v95, v91, v95
    v_mfma_f32_16x16x32_bf16 v[180:183], a[12:15], a[52:55], v[180:183]
    v_max_u32 v91, v93, v96
    v_min_u32 v96, v93, v96
    v_mfma_f32_16x16x32_bf16 v[184:187], a[12:15], a[56:59], v[184:187]
    buffer_load_dwordx4 v8, s[20:23], s37 offen offset:3072 lds
    v_max_u32 v93, v88, v92
    v_mfma_f32_16x16x32_bf16 v[188:191], a[12:15], a[60:63], v[188:191]
    s_add_u32 s37, s37, 32768
    s_and_b32 s37, s37, 524287
    v_min_u32 v92, v88, v92
    s_waitcnt vmcnt(12)
    s_waitcnt lgkmcnt(0)
    v_mfma_f32_16x16x32_bf16 v[128:131], a[16:19], a[64:67], v[128:131]
    ds_read_b64_tr_b16 a[32:33], v22 offset:4096
    s_add_u32 m0, s40, 0
    v_mfma_f32_16x16x32_bf16 v[132:135], a[16:19], a[68:71], v[132:135]
    ds_read_b64_tr_b16 a[34:35], v22 offset:5120
    v_max_u32 v88, v91, v89
    v_mfma_f32_16x16x32_bf16 v[136:139], a[16:19], a[72:75], v[136:139]
    ds_read_b64_tr_b16 a[36:37], v23 offset:4096
    buffer_load_dwordx4 v5, s[20:23], s37 offen offset:0 lds
    v_mfma_f32_16x16x32_bf16 v[140:143], a[16:19], a[76:79], v[140:143]
    ds_read_b64_tr_b16 a[38:39], v23 offset:5120
    v_min_u32 v89, v91, v89
    v_mfma_f32_16x16x32_bf16 v[144:147], a[20:23], a[64:67], v[144:147]
    ds_read_b64_tr_b16 a[40:41], v24 offset:4096
    v_max_u32 v91, v94, v92
    v_mfma_f32_16x16x32_bf16 v[148:151], a[20:23], a[68:71], v[148:151]
    ds_read_b64_tr_b16 a[42:43], v24 offset:5120
    v_min_u32 v92, v94, v92
    v_mfma_f32_16x16x32_bf16 v[152:155], a[20:23], a[72:75], v[152:155]
    ds_read_b64_tr_b16 a[44:45], v25 offset:4096
    buffer_load_dwordx4 v6, s[20:23], s37 offen offset:1024 lds
    v_mfma_f32_16x16x32_bf16 v[156:159], a[20:23], a[76:79], v[156:159]
    ds_read_b64_tr_b16 a[46:47], v25 offset:5120
    v_max_u32 v94, v93, v89
    v_mfma_f32_16x16x32_bf16 v[160:163], a[24:27], a[64:67], v[160:163]
    ds_read_b128 a[80:83], v30 offset:45056
    v_min_u32 v89, v93, v89
    v_mfma_f32_16x16x32_bf16 v[164:167], a[24:27], a[68:71], v[164:167]
    ds_read_b128 a[84:87], v30 offset:46080
    v_max_u32 v93, v91, v96
    v_mfma_f32_16x16x32_bf16 v[168:171], a[24:27], a[72:75], v[168:171]
    ds_read_b128 a[88:91], v30 offset:47104
    v_min_u32 v96, v91, v96
    v_mfma_f32_16x16x32_bf16 v[172:175], a[24:27], a[76:79], v[172:175]
    ds_read_b128 a[92:95], v30 offset:48128
    v_max_u32 v91, v93, v89
    v_mfma_f32_16x16x32_bf16 v[176:179], a[28:31], a[64:67], v[176:179]
    buffer_load_dwordx4 v7, s[20:23], s37 offen offset:2048 lds
    v_min_u32 v89, v93, v89
    v_mfma_f32_16x16x32_bf16 v[180:183], a[28:31], a[68:71], v[180:183]
    v_mov_b32 v97, 0
    v_mov_b32 v98, v90
    v_mfma_f32_16x16x32_bf16 v[184:187], a[28:31], a[72:75], v[184:187]
    buffer_load_dwordx4 v8, s[20:23], s37 offen offset:3072 lds
    v_max_u32_dpp v98, v98, v98 row_shr:1 row_mask:0xf bank_mask:0xf
    v_mfma_f32_16x16x32_bf16 v[188:191], a[28:31], a[76:79], v[188:191]
    s_add_u32 s37, s37, 32768
    s_and_b32 s37, s37, 524287
    v_max_u32_dpp v98, v98, v98 row_shr:2 row_mask:0xf bank_mask:0xf
    s_add_u32 s37, s37, 512
    s_waitcnt vmcnt(12)
    s_waitcnt lgkmcnt(0)
    v_mfma_f32_16x16x32_bf16 v[128:131], a[32:35], a[80:83], v[128:131]
    ds_read_b64_tr_b16 a[0:1], v22 offset:8192
    s_add_u32 m0, s40, 4096
    v_mfma_f32_16x16x32_bf16 v[132:135], a[32:35], a[84:87], v[132:135]
    ds_read_b64_tr_b16 a[2:3], v22 offset:9216
    v_max_u32_dpp v98, v98, v98 row_shr:4 row_mask:0xf bank_mask:0xf
    v_mfma_f32_16x16x32_bf16 v[136:139], a[32:35], a[88:91], v[136:139]
    ds_read_b64_tr_b16 a[4:5], v23 offset:8192
    buffer_load_dwordx4 v5, s[20:23], s37 offen offset:0 lds
    v_mfma_f32_16x16x32_bf16 v[140:143], a[32:35], a[92:95], v[140:143]
    ds_read_b64_tr_b16 a[6:7], v23 offset:9216
    v_max_u32_dpp v98, v98, v98 row_shr:8 row_mask:0xf bank_mask:0xf
    v_mfma_f32_16x16x32_bf16 v[144:147], a[36:39], a[80:83], v[144:147]
    ds_read_b64_tr_b16 a[8:9], v24 offset:8192
    v_max_u32_dpp v98, v98, v98 row_bcast:15 row_mask:0xa bank_mask:0xf
    v_mfma_f32_16x16x32_bf16 v[148:151], a[36:39], a[84:87], v[148:151]
    ds_read_b64_tr_b16 a[10:11], v24 offset:9216
    v_max_u32_dpp v98, v98, v98 row_bcast:31 row_mask:0xc bank_mask:0xf
    v_mfma_f32_16x16x32_bf16 v[152:155], a[36:39], a[88:91], v[152:155]
    ds_read_b64_tr_b16 a[12:13], v25 offset:8192
    buffer_load_dwordx4 v6, s[20:23], s37 offen offset:1024 lds
    v_mfma_f32_16x16x32_bf16 v[156:159], a[36:39], a[92:95], v[156:159]
    ds_read_b64_tr_b16 a[14:15], v25 offset:9216
    v_readlane_b32 s46, v98, 63
    v_mfma_f32_16x16x32_bf16 v[160:163], a[40:43], a[80:83], v[160:163]
    ds_read_b128 a[48:51], v30 offset:49152
    v_cmp_eq_u32 s[60:61], s46, v90
    v_mfma_f32_16x16x32_bf16 v[164:167], a[40:43], a[84:87], v[164:167]
    ds_read_b128 a[52:55], v30 offset:50176
    v_writelane_b32 v97, s46, 0
    v_mfma_f32_16x16x32_bf16 v[168:171], a[40:43], a[88:91], v[168:171]
    ds_read_b128 a[56:59], v30 offset:51200
    v_cndmask_b32 v90, v90, v88, s[60:61]
    v_mfma_f32_16x16x32_bf16 v[172:175], a[40:43], a[92:95], v[172:175]
    ds_read_b128 a[60:63], v30 offset:52224
    v_cndmask_b32 v88, v88, v94, s[60:61]
    v_mfma_f32_16x16x32_bf16 v[176:179], a[44:47], a[80:83], v[176:179]
    buffer_load_dwordx4 v7, s[20:23], s37 offen offset:2048 lds
    v_cndmask_b32 v94, v94, v91, s[60:61]
    v_mfma_f32_16x16x32_bf16 v[180:183], a[44:47], a[84:87], v[180:183]
    v_cndmask_b32 v91, v91, v89, s[60:61]
    v_cndmask_b32 v89, v89, v96, s[60:61]
    v_mfma_f32_16x16x32_bf16 v[184:187], a[44:47], a[88:91], v[184:187]
    buffer_load_dwordx4 v8, s[20:23], s37 offen offset:3072 lds
    v_cndmask_b32 v96, v96, v92, s[60:61]
    v_mfma_f32_16x16x32_bf16 v[188:191], a[44:47], a[92:95], v[188:191]
    s_add_u32 s37, s37, 32768
    s_and_b32 s37, s37, 524287
    v_cndmask_b32 v92, v92, v95, s[60:61]
    s_waitcnt vmcnt(12)
    s_waitcnt lgkmcnt(0)
    v_mfma_f32_16x16x32_bf16 v[128:131], a[0:3], a[48:51], v[128:131]
    ds_read_b64_tr_b16 a[16:17], v22 offset:12288
    s_add_u32 m0, s40, 8192
    v_mfma_f32_16x16x32_bf16 v[132:135], a[0:3], a[52:55], v[132:135]
    ds_read_b64_tr_b16 a[18:19], v22 offset:13312
    v_mov_b32 v98, v90
    v_mfma_f32_16x16x32_bf16 v[136:139], a[0:3], a[56:59], v[136:139]
    ds_read_b64_tr_b16 a[20:21], v23 offset:12288
    buffer_load_dwordx4 v5, s[20:23], s37 offen offset:0 lds
    v_mfma_f32_16x16x32_bf16 v[140:143], a[0:3], a[60:63], v[140:143]
    ds_read_b64_tr_b16 a[22:23], v23 offset:13312
    v_max_u32_dpp v98, v98, v98 row_shr:1 row_mask:0xf bank_mask:0xf
    v_mfma_f32_16x16x32_bf16 v[144:147], a[4:7], a[48:51], v[144:147]
    ds_read_b64_tr_b16 a[24:25], v24 offset:12288
    v_max_u32_dpp v98, v98, v98 row_shr:2 row_mask:0xf bank_mask:0xf
    v_mfma_f32_16x16x32_bf16 v[148:151], a[4:7], a[52:55], v[148:151]
    ds_read_b64_tr_b16 a[26:27], v24 offset:13312
    v_max_u32_dpp v98, v98, v98 row_shr:4 row_mask:0xf bank_mask:0xf
    v_mfma_f32_16x16x32_bf16 v[152:155], a[4:7], a[56:59], v[152:155]
    ds_read_b64_tr_b16 a[28:29], v25 offset:12288
    buffer_load_dwordx4 v6, s[20:23], s37 offen offset:1024 lds
    v_mfma_f32_16x16x32_bf16 v[156:159], a[4:7], a[60:63], v[156:159]
    ds_read_b64_tr_b16 a[30:31], v25 offset:13312
    v_max_u32_dpp v98, v98, v98 row_shr:8 row_mask:0xf bank_mask:0xf
    v_mfma_f32_16x16x32_bf16 v[160:163], a[8:11], a[48:51], v[160:163]
    ds_read_b128 a[64:67], v30 offset:53248
    v_max_u32_dpp v98, v98, v98 row_bcast:15 row_mask:0xa bank_mask:0xf
    v_mfma_f32_16x16x32_bf16 v[164:167], a[8:11], a[52:55], v[164:167]
    ds_read_b128 a[68:71], v30 offset:54272
    v_max_u32_dpp v98, v98, v98 row_bcast:31 row_mask:0xc bank_mask:0xf
    v_mfma_f32_16x16x32_bf16 v[168:171], a[8:11], a[56:59], v[168:171]
    ds_read_b128 a[72:75], v30 offset:55296
    v_readlane_b32 s46, v98, 63
    v_mfma_f32_16x16x32_bf16 v[172:175], a[8:11], a[60:63], v[172:175]
    ds_read_b128 a[76:79], v30 offset:56320
    v_cmp_eq_u32 s[60:61], s46, v90
    v_mfma_f32_16x16x32_bf16 v[176:179], a[12:15], a[48:51], v[176:179]
    buffer_load_dwordx4 v7, s[20:23], s37 offen offset:2048 lds
    v_writelane_b32 v97, s46, 1
    v_mfma_f32_16x16x32_bf16 v[180:183], a[12:15], a[52:55], v[180:183]
    v_cndmask_b32 v90, v90, v88, s[60:61]
    v_cndmask_b32 v88, v88, v94, s[60:61]
    v_mfma_f32_16x16x32_bf16 v[184:187], a[12:15], a[56:59], v[184:187]
    buffer_load_dwordx4 v8, s[20:23], s37 offen offset:3072 lds
    v_cndmask_b32 v94, v94, v91, s[60:61]
    v_mfma_f32_16x16x32_bf16 v[188:191], a[12:15], a[60:63], v[188:191]
    s_add_u32 s37, s37, 32768
    s_and_b32 s37, s37, 524287
    v_cndmask_b32 v91, v91, v89, s[60:61]
    s_waitcnt vmcnt(12)
    s_waitcnt lgkmcnt(0)
    v_mfma_f32_16x16x32_bf16 v[128:131], a[16:19], a[64:67], v[128:131]
    ds_read_b64_tr_b16 a[32:33], v22 offset:16384
    s_add_u32 m0, s40, 12288
    v_mfma_f32_16x16x32_bf16 v[132:135], a[16:19], a[68:71], v[132:135]
    ds_read_b64_tr_b16 a[34:35], v22 offset:17408
    v_cndmask_b32 v89, v89, v96, s[60:61]
    v_mfma_f32_16x16x32_bf16 v[136:139], a[16:19], a[72:75], v[136:139]
    ds_read_b64_tr_b16 a[36:37], v23 offset:16384
    buffer_load_dwordx4 v5, s[20:23], s37 offen offset:0 lds
    v_mfma_f32_16x16x32_bf16 v[140:143], a[16:19], a[76:79], v[140:143]
    ds_read_b64_tr_b16 a[38:39], v23 offset:17408
    v_cndmask_b32 v96, v96, v92, s[60:61]
    v_mfma_f32_16x16x32_bf16 v[144:147], a[20:23], a[64:67], v[144:147]
    ds_read_b64_tr_b16 a[40:41], v24 offset:16384
    v_mov_b32 v98, v90
    v_mfma_f32_16x16x32_bf16 v[148:151], a[20:23], a[68:71], v[148:151]
    ds_read_b64_tr_b16 a[42:43], v24 offset:17408
    v_max_u32_dpp v98, v98, v98 row_shr:1 row_mask:0xf bank_mask:0xf
    v_mfma_f32_16x16x32_bf16 v[152:155], a[20:23], a[72:75], v[152:155]
    ds_read_b64_tr_b16 a[44:45], v25 offset:16384
    buffer_load_dwordx4 v6, s[20:23], s37 offen offset:1024 lds
    v_mfma_f32_16x16x32_bf16 v[156:159], a[20:23], a[76:79], v[156:159]
    ds_read_b64_tr_b16 a[46:47], v25 offset:17408
    v_max_u32_dpp v98, v98, v98 row_shr:2 row_mask:0xf bank_mask:0xf
    v_mfma_f32_16x16x32_bf16 v[160:163], a[24:27], a[64:67], v[160:163]
    ds_read_b128 a[80:83], v30 offset:57344
    v_max_u32_dpp v98, v98, v98 row_shr:4 row_mask:0xf bank_mask:0xf
    v_mfma_f32_16x16x32_bf16 v[164:167], a[24:27], a[68:71], v[164:167]
    ds_read_b128 a[84:87], v30 offset:58368
    v_max_u32_dpp v98, v98, v98 row_shr:8 row_mask:0xf bank_mask:0xf
    v_mfma_f32_16x16x32_bf16 v[168:171], a[24:27], a[72:75], v[168:171]
    ds_read_b128 a[88:91], v30 offset:59392
    v_max_u32_dpp v98, v98, v98 row_bcast:15 row_mask:0xa bank_mask:0xf
    v_mfma_f32_16x16x32_bf16 v[172:175], a[24:27], a[76:79], v[172:175]
    ds_read_b128 a[92:95], v30 offset:60416
    v_max_u32_dpp v98, v98, v98 row_bcast:31 row_mask:0xc bank_mask:0xf
    v_mfma_f32_16x16x32_bf16 v[176:179], a[28:31], a[64:67], v[176:179]
    buffer_load_dwordx4 v7, s[20:23], s37 offen offset:2048 lds
    v_readlane_b32 s46, v98, 63
    v_mfma_f32_16x16x32_bf16 v[180:183], a[28:31], a[68:71], v[180:183]
    v_mfma_f32_16x16x32_bf16 v[184:187], a[28:31], a[72:75], v[184:187]
    buffer_load_dwordx4 v8, s[20:23], s37 offen offset:3072 lds
    v_cmp_eq_u32 s[60:61], s46, v90
    v_mfma_f32_16x16x32_bf16 v[188:191], a[28:31], a[76:79], v[188:191]
    s_add_u32 s37, s37, 32768
    s_and_b32 s37, s37, 524287
    v_writelane_b32 v97, s46, 2
    s_waitcnt vmcnt(12)
    s_waitcnt lgkmcnt(0)
    v_mfma_f32_16x16x32_bf16 v[128:131], a[32:35], a[80:83], v[128:131]
    ds_read_b64_tr_b16 a[0:1], v22 offset:0
    s_add_u32 m0, s40, 16384
    v_mfma_f32_16x16x32_bf16 v[132:135], a[32:35], a[84:87], v[132:135]
    ds_read_b64_tr_b16 a[2:3], v22 offset:1024
    v_cndmask_b32 v90, v90, v88, s[60:61]
    v_mfma_f32_16x16x32_bf16 v[136:139], a[32:35], a[88:91], v[136:139]
    ds_read_b64_tr_b16 a[4:5], v23 offset:0
    buffer_load_dwordx4 v5, s[20:23], s37 offen offset:0 lds
    v_mfma_f32_16x16x32_bf16 v[140:143], a[32:35], a[92:95], v[140:143]
    ds_read_b64_tr_b16 a[6:7], v23 offset:1024
    v_cndmask_b32 v88, v88, v94, s[60:61]
    v_mfma_f32_16x16x32_bf16 v[144:147], a[36:39], a[80:83], v[144:147]
    ds_read_b64_tr_b16 a[8:9], v24 offset:0
    v_cndmask_b32 v94, v94, v91, s[60:61]
    v_mfma_f32_16x16x32_bf16 v[148:151], a[36:39], a[84:87], v[148:151]
    ds_read_b64_tr_b16 a[10:11], v24 offset:1024
    v_cndmask_b32 v91, v91, v89, s[60:61]
    v_mfma_f32_16x16x32_bf16 v[152:155], a[36:39], a[88:91], v[152:155]
    ds_read_b64_tr_b16 a[12:13], v25 offset:0
    buffer_load_dwordx4 v6, s[20:23], s37 offen offset:1024 lds
    v_mfma_f32_16x16x32_bf16 v[156:159], a[36:39], a[92:95], v[156:159]
    ds_read_b64_tr_b16 a[14:15], v25 offset:1024
    v_cndmask_b32 v89, v89, v96, s[60:61]
    v_mfma_f32_16x16x32_bf16 v[160:163], a[40:43], a[80:83], v[160:163]
    ds_read_b128 a[48:51], v30 offset:61440
    v_mov_b32 v98, v90
    v_mfma_f32_16x16x32_bf16 v[164:167], a[40:43], a[84:87], v[164:167]
    ds_read_b128 a[52:55], v30 offset:62464
    v_max_u32_dpp v98, v98, v98 row_shr:1 row_mask:0xf bank_mask:0xf
    v_mfma_f32_16x16x32_bf16 v[168:171], a[40:43], a[88:91], v[168:171]
    ds_read_b128 a[56:59], v30 offset:63488
    v_max_u32_dpp v98, v98, v98 row_shr:2 row_mask:0xf bank_mask:0xf
    v_mfma_f32_16x16x32_bf16 v[172:175], a[40:43], a[92:95], v[172:175]
    ds_read_b128 a[60:63], v30 offset:64512
    v_max_u32_dpp v98, v98, v98 row_shr:4 row_mask:0xf bank_mask:0xf
    v_mfma_f32_16x16x32_bf16 v[176:179], a[44:47], a[80:83], v[176:179]
    buffer_load_dwordx4 v7, s[20:23], s37 offen offset:2048 lds
    v_max_u32_dpp v98, v98, v98 row_shr:8 row_mask:0xf bank_mask:0xf
    v_mfma_f32_16x16x32_bf16 v[180:183], a[44:47], a[84:87], v[180:183]
    v_mfma_f32_16x16x32_bf16 v[184:187], a[44:47], a[88:91], v[184:187]
    buffer_load_dwordx4 v8, s[20:23], s37 offen offset:3072 lds
    v_max_u32_dpp v98, v98, v98 row_bcast:15 row_mask:0xa bank_mask:0xf
    v_mfma_f32_16x16x32_bf16 v[188:191], a[44:47], a[92:95], v[188:191]
    s_add_u32 s37, s37, 32768
    s_and_b32 s37, s37, 524287
    v_max_u32_dpp v98, v98, v98 row_bcast:31 row_mask:0xc bank_mask:0xf
    s_waitcnt vmcnt(12)
    s_waitcnt lgkmcnt(0)
    v_mfma_f32_16x16x32_bf16 v[128:131], a[0:3], a[48:51], v[128:131]
    ds_read_b64_tr_b16 a[16:17], v22 offset:4096
    s_add_u32 m0, s40, 0
    v_mfma_f32_16x16x32_bf16 v[132:135], a[0:3], a[52:55], v[132:135]
    ds_read_b64_tr_b16 a[18:19], v22 offset:5120
    v_readlane_b32 s46, v98, 63
    v_mfma_f32_16x16x32_bf16 v[136:139], a[0:3], a[56:59], v[136:139]
    ds_read_b64_tr_b16 a[20:21], v23 offset:4096
    buffer_load_dwordx4 v5, s[20:23], s37 offen offset:0 lds
    v_mfma_f32_16x16x32_bf16 v[140:143], a[0:3], a[60:63], v[140:143]
    ds_read_b64_tr_b16 a[22:23], v23 offset:5120
    v_cmp_eq_u32 s[60:61], s46, v90
    v_mfma_f32_16x16x32_bf16 v[144:147], a[4:7], a[48:51], v[144:147]
    ds_read_b64_tr_b16 a[24:25], v24 offset:4096
    v_writelane_b32 v97, s46, 3
    v_mfma_f32_16x16x32_bf16 v[148:151], a[4:7], a[52:55], v[148:151]
    ds_read_b64_tr_b16 a[26:27], v24 offset:5120
    v_cndmask_b32 v90, v90, v88, s[60:61]
    v_mfma_f32_16x16x32_bf16 v[152:155], a[4:7], a[56:59], v[152:155]
    ds_read_b64_tr_b16 a[28:29], v25 offset:4096
    buffer_load_dwordx4 v6, s[20:23], s37 offen offset:1024 lds
    v_mfma_f32_16x16x32_bf16 v[156:159], a[4:7], a[60:63], v[156:159]
    ds_read_b64_tr_b16 a[30:31], v25 offset:5120
    v_cndmask_b32 v88, v88, v94, s[60:61]
    v_mfma_f32_16x16x32_bf16 v[160:163], a[8:11], a[48:51], v[160:163]
    ds_read_b128 a[64:67], v30 offset:0
    v_cndmask_b32 v94, v94, v91, s[60:61]
    v_mfma_f32_16x16x32_bf16 v[164:167], a[8:11], a[52:55], v[164:167]
    ds_read_b128 a[68:71], v30 offset:1024
    v_cndmask_b32 v91, v91, v89, s[60:61]
    v_mfma_f32_16x16x32_bf16 v[168:171], a[8:11], a[56:59], v[168:171]
    ds_read_b128 a[72:75], v30 offset:2048
    v_mov_b32 v98, v90
    v_mfma_f32_16x16x32_bf16 v[172:175], a[8:11], a[60:63], v[172:175]
    ds_read_b128 a[76:79], v30 offset:3072
    v_max_u32_dpp v98, v98, v98 row_shr:1 row_mask:0xf bank_mask:0xf
    v_mfma_f32_16x16x32_bf16 v[176:179], a[12:15], a[48:51], v[176:179]
    buffer_load_dwordx4 v7, s[20:23], s37 offen offset:2048 lds
    v_max_u32_dpp v98, v98, v98 row_shr:2 row_mask:0xf bank_mask:0xf
    v_mfma_f32_16x16x32_bf16 v[180:183], a[12:15], a[52:55], v[180:183]
    v_mfma_f32_16x16x32_bf16 v[184:187], a[12:15], a[56:59], v[184:187]
    buffer_load_dwordx4 v8, s[20:23], s37 offen offset:3072 lds
    v_max_u32_dpp v98, v98, v98 row_shr:4 row_mask:0xf bank_mask:0xf
    v_mfma_f32_16x16x32_bf16 v[188:191], a[12:15], a[60:63], v[188:191]
    s_add_u32 s37, s37, 32768
    s_and_b32 s37, s37, 524287
    v_max_u32_dpp v98, v98, v98 row_shr:8 row_mask:0xf bank_mask:0xf
    s_waitcnt vmcnt(12)
    s_waitcnt lgkmcnt(0)
    v_mfma_f32_16x16x32_bf16 v[192:195], a[16:19], a[64:67], 0
    ds_read_b64_tr_b16 a[32:33], v22 offset:8192
    s_add_u32 m0, s40, 4096
    v_mfma_f32_16x16x32_bf16 v[196:199], a[16:19], a[68:71], 0
    ds_read_b64_tr_b16 a[34:35], v22 offset:9216
    v_max_u32_dpp v98, v98, v98 row_bcast:15 row_mask:0xa bank_mask:0xf
    v_mfma_f32_16x16x32_bf16 v[200:203], a[16:19], a[72:75], 0
    ds_read_b64_tr_b16 a[36:37], v23 offset:8192
    buffer_load_dwordx4 v5, s[20:23], s37 offen offset:0 lds
    v_mfma_f32_16x16x32_bf16 v[204:207], a[16:19], a[76:79], 0
    ds_read_b64_tr_b16 a[38:39], v23 offset:9216
    v_cvt_pk_bf16_f32 v64, v128, v129
    v_mfma_f32_16x16x32_bf16 v[208:211], a[20:23], a[64:67], 0
    ds_read_b64_tr_b16 a[40:41], v24 offset:8192
    v_cvt_pk_bf16_f32 v65, v130, v131
    v_mfma_f32_16x16x32_bf16 v[212:215], a[20:23], a[68:71], 0
    ds_read_b64_tr_b16 a[42:43], v24 offset:9216
    v_cvt_pk_bf16_f32 v66, v132, v133
    v_mfma_f32_16x16x32_bf16 v[216:219], a[20:23], a[72:75], 0
    ds_read_b64_tr_b16 a[44:45], v25 offset:8192
    buffer_load_dwordx4 v6, s[20:23], s37 offen offset:1024 lds
    v_mfma_f32_16x16x32_bf16 v[220:223], a[20:23], a[76:79], 0
    ds_read_b64_tr_b16 a[46:47], v25 offset:9216
    v_cvt_pk_bf16_f32 v67, v134, v135
    v_mfma_f32_16x16x32_bf16 v[224:227], a[24:27], a[64:67], 0
    ds_read_b128 a[80:83], v30 offset:4096
    v_permlane16_swap_b32 v64, v66
    v_mfma_f32_16x16x32_bf16 v[228:231], a[24:27], a[68:71], 0
    ds_read_b128 a[84:87], v30 offset:5120
    v_permlane16_swap_b32 v65, v67
    v_mfma_f32_16x16x32_bf16 v[232:235], a[24:27], a[72:75], 0
    ds_read_b128 a[88:91], v30 offset:6144
    buffer_store_dwordx4 v[64:67], v57, s[24:27], 0 offen offset:0 sc1
    v_mfma_f32_16x16x32_bf16 v[236:239], a[24:27], a[76:79], 0
    ds_read_b128 a[92:95], v30 offset:7168
    v_max_u32_dpp v98, v98, v98 row_bcast:31 row_mask:0xc bank_mask:0xf
    v_mfma_f32_16x16x32_bf16 v[240:243], a[28:31], a[64:67], 0
    buffer_load_dwordx4 v7, s[20:23], s37 offen offset:2048 lds
    v_readlane_b32 s46, v98, 63
    v_mfma_f32_16x16x32_bf16 v[244:247], a[28:31], a[68:71], 0
    v_mfma_f32_16x16x32_bf16 v[248:251], a[28:31], a[72:75], 0
    buffer_load_dwordx4 v8, s[20:23], s37 offen offset:3072 lds
    v_cmp_eq_u32 s[60:61], s46, v90
    v_mfma_f32_16x16x32_bf16 v[252:255], a[28:31], a[76:79], 0
    s_add_u32 s37, s37, 32768
    s_and_b32 s37, s37, 524287
    v_writelane_b32 v97, s46, 4
    s_waitcnt vmcnt(13)
    s_waitcnt lgkmcnt(0)
    v_mfma_f32_16x16x32_bf16 v[192:195], a[32:35], a[80:83], v[192:195]
    ds_read_b64_tr_b16 a[0:1], v22 offset:12288
    s_add_u32 m0, s40, 8192
    v_mfma_f32_16x16x32_bf16 v[196:199], a[32:35], a[84:87], v[196:199]
    ds_read_b64_tr_b16 a[2:3], v22 offset:13312
    v_cndmask_b32 v90, v90, v88, s[60:61]
    v_mfma_f32_16x16x32_bf16 v[200:203], a[32:35], a[88:91], v[200:203]
    ds_read_b64_tr_b16 a[4:5], v23 offset:12288
    buffer_load_dwordx4 v5, s[20:23], s37 offen offset:0 lds
    v_mfma_f32_16x16x32_bf16 v[204:207], a[32:35], a[92:95], v[204:207]
    ds_read_b64_tr_b16 a[6:7], v23 offset:13312
    v_cndmask_b32 v88, v88, v94, s[60:61]
    v_mfma_f32_16x16x32_bf16 v[208:211], a[36:39], a[80:83], v[208:211]
    ds_read_b64_tr_b16 a[8:9], v24 offset:12288
    v_cndmask_b32 v94, v94, v91, s[60:61]
    v_mfma_f32_16x16x32_bf16 v[212:215], a[36:39], a[84:87], v[212:215]
    ds_read_b64_tr_b16 a[10:11], v24 offset:13312
    v_mov_b32 v98, v90
    v_mfma_f32_16x16x32_bf16 v[216:219], a[36:39], a[88:91], v[216:219]
    ds_read_b64_tr_b16 a[12:13], v25 offset:12288
    buffer_load_dwordx4 v6, s[20:23], s37 offen offset:1024 lds
    v_mfma_f32_16x16x32_bf16 v[220:223], a[36:39], a[92:95], v[220:223]
    ds_read_b64_tr_b16 a[14:15], v25 offset:13312
    v_max_u32_dpp v98, v98, v98 row_shr:1 row_mask:0xf bank_mask:0xf
    v_mfma_f32_16x16x32_bf16 v[224:227], a[40:43], a[80:83], v[224:227]
    ds_read_b128 a[48:51], v30 offset:8192
    v_max_u32_dpp v98, v98, v98 row_shr:2 row_mask:0xf bank_mask:0xf
    v_mfma_f32_16x16x32_bf16 v[228:231], a[40:43], a[84:87], v[228:231]
    ds_read_b128 a[52:55], v30 offset:9216
    v_max_u32_dpp v98, v98, v98 row_shr:4 row_mask:0xf bank_mask:0xf
    v_mfma_f32_16x16x32_bf16 v[232:235], a[40:43], a[88:91], v[232:235]
    ds_read_b128 a[56:59], v30 offset:10240
    v_max_u32_dpp v98, v98, v98 row_shr:8 row_mask:0xf bank_mask:0xf
    v_mfma_f32_16x16x32_bf16 v[236:239], a[40:43], a[92:95], v[236:239]
    ds_read_b128 a[60:63], v30 offset:11264
    v_max_u32_dpp v98, v98, v98 row_bcast:15 row_mask:0xa bank_mask:0xf
    v_mfma_f32_16x16x32_bf16 v[240:243], a[44:47], a[80:83], v[240:243]
    buffer_load_dwordx4 v7, s[20:23], s37 offen offset:2048 lds
    v_max_u32_dpp v98, v98, v98 row_bcast:31 row_mask:0xc bank_mask:0xf
    v_mfma_f32_16x16x32_bf16 v[244:247], a[44:47], a[84:87], v[244:247]
    v_readlane_b32 s46, v98, 63
    v_mfma_f32_16x16x32_bf16 v[248:251], a[44:47], a[88:91], v[248:251]
    buffer_load_dwordx4 v8, s[20:23], s37 offen offset:3072 lds
    v_cmp_eq_u32 s[60:61], s46, v90
    v_mfma_f32_16x16x32_bf16 v[252:255], a[44:47], a[92:95], v[252:255]
    s_add_u32 s37, s37, 32768
    s_and_b32 s37, s37, 524287
    v_writelane_b32 v97, s46, 5
    s_waitcnt vmcnt(13)
    s_waitcnt lgkmcnt(0)
    v_mfma_f32_16x16x32_bf16 v[192:195], a[0:3], a[48:51], v[192:195]
    ds_read_b64_tr_b16 a[16:17], v22 offset:16384
    s_add_u32 m0, s40, 12288
    v_mfma_f32_16x16x32_bf16 v[196:199], a[0:3], a[52:55], v[196:199]
    ds_read_b64_tr_b16 a[18:19], v22 offset:17408
    v_cndmask_b32 v90, v90, v88, s[60:61]
    v_mfma_f32_16x16x32_bf16 v[200:203], a[0:3], a[56:59], v[200:203]
    ds_read_b64_tr_b16 a[20:21], v23 offset:16384
    buffer_load_dwordx4 v5, s[20:23], s37 offen offset:0 lds
    v_mfma_f32_16x16x32_bf16 v[204:207], a[0:3], a[60:63], v[204:207]
    ds_read_b64_tr_b16 a[22:23], v23 offset:17408
    v_cvt_pk_bf16_f32 v68, v136, v137
    v_mfma_f32_16x16x32_bf16 v[208:211], a[4:7], a[48:51], v[208:211]
    ds_read_b64_tr_b16 a[24:25], v24 offset:16384
    v_cvt_pk_bf16_f32 v69, v138, v139
    v_mfma_f32_16x16x32_bf16 v[212:215], a[4:7], a[52:55], v[212:215]
    ds_read_b64_tr_b16 a[26:27], v24 offset:17408
    v_cvt_pk_bf16_f32 v70, v140, v141
    v_mfma_f32_16x16x32_bf16 v[216:219], a[4:7], a[56:59], v[216:219]
    ds_read_b64_tr_b16 a[28:29], v25 offset:16384
    buffer_load_dwordx4 v6, s[20:23], s37 offen offset:1024 lds
    v_mfma_f32_16x16x32_bf16 v[220:223], a[4:7], a[60:63], v[220:223]
    ds_read_b64_tr_b16 a[30:31], v25 offset:17408
    v_cvt_pk_bf16_f32 v71, v142, v143
    v_mfma_f32_16x16x32_bf16 v[224:227], a[8:11], a[48:51], v[224:227]
    ds_read_b128 a[64:67], v30 offset:12288
    v_permlane16_swap_b32 v68, v70
    v_mfma_f32_16x16x32_bf16 v[228:231], a[8:11], a[52:55], v[228:231]
    ds_read_b128 a[68:71], v30 offset:13312
    v_permlane16_swap_b32 v69, v71
    v_mfma_f32_16x16x32_bf16 v[232:235], a[8:11], a[56:59], v[232:235]
    ds_read_b128 a[72:75], v30 offset:14336
    buffer_store_dwordx4 v[68:71], v57, s[24:27], 0 offen offset:1024 sc1
    v_mfma_f32_16x16x32_bf16 v[236:239], a[8:11], a[60:63], v[236:239]
    ds_read_b128 a[76:79], v30 offset:15360
    v_cndmask_b32 v88, v88, v94, s[60:61]
    v_mfma_f32_16x16x32_bf16 v[240:243], a[12:15], a[48:51], v[240:243]
    buffer_load_dwordx4 v7, s[20:23], s37 offen offset:2048 lds
    v_mov_b32 v98, v90
    v_mfma_f32_16x16x32_bf16 v[244:247], a[12:15], a[52:55], v[244:247]
    v_mfma_f32_16x16x32_bf16 v[248:251], a[12:15], a[56:59], v[248:251]
    buffer_load_dwordx4 v8, s[20:23], s37 offen offset:3072 lds
    v_max_u32_dpp v98, v98, v98 row_shr:1 row_mask:0xf bank_mask:0xf
    v_mfma_f32_16x16x32_bf16 v[252:255], a[12:15], a[60:63], v[252:255]
    s_add_u32 s37, s37, 32768
    s_and_b32 s37, s37, 524287
    v_max_u32_dpp v98, v98, v98 row_shr:2 row_mask:0xf bank_mask:0xf
    s_waitcnt vmcnt(14)
    s_waitcnt lgkmcnt(0)
    v_mfma_f32_16x16x32_bf16 v[192:195], a[16:19], a[64:67], v[192:195]
    ds_read_b64_tr_b16 a[32:33], v22 offset:0
    s_add_u32 m0, s40, 16384
    v_mfma_f32_16x16x32_bf16 v[196:199], a[16:19], a[68:71], v[196:199]
    ds_read_b64_tr_b16 a[34:35], v22 offset:1024
    v_max_u32_dpp v98, v98, v98 row_shr:4 row_mask:0xf bank_mask:0xf
    v_mfma_f32_16x16x32_bf16 v[200:203], a[16:19], a[72:75], v[200:203]
    ds_read_b64_tr_b16 a[36:37], v23 offset:0
    buffer_load_dwordx4 v5, s[20:23], s37 offen offset:0 lds
    v_mfma_f32_16x16x32_bf16 v[204:207], a[16:19], a[76:79], v[204:207]
    ds_read_b64_tr_b16 a[38:39], v23 offset:1024
    v_max_u32_dpp v98, v98, v98 row_shr:8 row_mask:0xf bank_mask:0xf
    v_mfma_f32_16x16x32_bf16 v[208:211], a[20:23], a[64:67], v[208:211]
    ds_read_b64_tr_b16 a[40:41], v24 offset:0
    v_max_u32_dpp v98, v98, v98 row_bcast:15 row_mask:0xa bank_mask:0xf
    v_mfma_f32_16x16x32_bf16 v[212:215], a[20:23], a[68:71], v[212:215]
    ds_read_b64_tr_b16 a[42:43], v24 offset:1024
    v_max_u32_dpp v98, v98, v98 row_bcast:31 row_mask:0xc bank_mask:0xf
    v_mfma_f32_16x16x32_bf16 v[216:219], a[20:23], a[72:75], v[216:219]
    ds_read_b64_tr_b16 a[44:45], v25 offset:0
    buffer_load_dwordx4 v6, s[20:23], s37 offen offset:1024 lds
    v_mfma_f32_16x16x32_bf16 v[220:223], a[20:23], a[76:79], v[220:223]
    ds_read_b64_tr_b16 a[46:47], v25 offset:1024
    v_readlane_b32 s46, v98, 63
    v_mfma_f32_16x16x32_bf16 v[224:227], a[24:27], a[64:67], v[224:227]
    ds_read_b128 a[80:83], v30 offset:16384
    v_cmp_eq_u32 s[60:61], s46, v90
    v_mfma_f32_16x16x32_bf16 v[228:231], a[24:27], a[68:71], v[228:231]
    ds_read_b128 a[84:87], v30 offset:17408
    v_writelane_b32 v97, s46, 6
    v_mfma_f32_16x16x32_bf16 v[232:235], a[24:27], a[72:75], v[232:235]
    ds_read_b128 a[88:91], v30 offset:18432
    v_cndmask_b32 v90, v90, v88, s[60:61]
    v_mfma_f32_16x16x32_bf16 v[236:239], a[24:27], a[76:79], v[236:239]
    ds_read_b128 a[92:95], v30 offset:19456
    v_mov_b32 v98, v90
    v_mfma_f32_16x16x32_bf16 v[240:243], a[28:31], a[64:67], v[240:243]
    buffer_load_dwordx4 v7, s[20:23], s37 offen offset:2048 lds
    v_max_u32_dpp v98, v98, v98 row_shr:1 row_mask:0xf bank_mask:0xf
    v_mfma_f32_16x16x32_bf16 v[244:247], a[28:31], a[68:71], v[244:247]
    v_mfma_f32_16x16x32_bf16 v[248:251], a[28:31], a[72:75], v[248:251]
    buffer_load_dwordx4 v8, s[20:23], s37 offen offset:3072 lds
    v_max_u32_dpp v98, v98, v98 row_shr:2 row_mask:0xf bank_mask:0xf
    v_mfma_f32_16x16x32_bf16 v[252:255], a[28:31], a[76:79], v[252:255]
    s_add_u32 s37, s37, 32768
    s_and_b32 s37, s37, 524287
    v_max_u32_dpp v98, v98, v98 row_shr:4 row_mask:0xf bank_mask:0xf
    s_waitcnt vmcnt(13)
    s_waitcnt lgkmcnt(0)
    v_mfma_f32_16x16x32_bf16 v[192:195], a[32:35], a[80:83], v[192:195]
    ds_read_b64_tr_b16 a[0:1], v22 offset:4096
    s_add_u32 m0, s40, 0
    v_mfma_f32_16x16x32_bf16 v[196:199], a[32:35], a[84:87], v[196:199]
    ds_read_b64_tr_b16 a[2:3], v22 offset:5120
    v_max_u32_dpp v98, v98, v98 row_shr:8 row_mask:0xf bank_mask:0xf
    v_mfma_f32_16x16x32_bf16 v[200:203], a[32:35], a[88:91], v[200:203]
    ds_read_b64_tr_b16 a[4:5], v23 offset:4096
    buffer_load_dwordx4 v5, s[20:23], s37 offen offset:0 lds
    v_mfma_f32_16x16x32_bf16 v[204:207], a[32:35], a[92:95], v[204:207]
    ds_read_b64_tr_b16 a[6:7], v23 offset:5120
    v_cvt_pk_bf16_f32 v72, v144, v145
    v_mfma_f32_16x16x32_bf16 v[208:211], a[36:39], a[80:83], v[208:211]
    ds_read_b64_tr_b16 a[8:9], v24 offset:4096
    v_cvt_pk_bf16_f32 v73, v146, v147
    v_mfma_f32_16x16x32_bf16 v[212:215], a[36:39], a[84:87], v[212:215]
    ds_read_b64_tr_b16 a[10:11], v24 offset:5120
    v_cvt_pk_bf16_f32 v74, v148, v149
    v_mfma_f32_16x16x32_bf16 v[216:219], a[36:39], a[88:91], v[216:219]
    ds_read_b64_tr_b16 a[12:13], v25 offset:4096
    buffer_load_dwordx4 v6, s[20:23], s37 offen offset:1024 lds
    v_mfma_f32_16x16x32_bf16 v[220:223], a[36:39], a[92:95], v[220:223]
    ds_read_b64_tr_b16 a[14:15], v25 offset:5120
    v_cvt_pk_bf16_f32 v75, v150, v151
    v_mfma_f32_16x16x32_bf16 v[224:227], a[40:43], a[80:83], v[224:227]
    ds_read_b128 a[48:51], v30 offset:20480
    v_permlane16_swap_b32 v72, v74
    v_mfma_f32_16x16x32_bf16 v[228:231], a[40:43], a[84:87], v[228:231]
    ds_read_b128 a[52:55], v30 offset:21504
    v_permlane16_swap_b32 v73, v75
    v_mfma_f32_16x16x32_bf16 v[232:235], a[40:43], a[88:91], v[232:235]
    ds_read_b128 a[56:59], v30 offset:22528
    buffer_store_dwordx4 v[72:75], v57, s[24:27], 0 offen offset:2048 sc1
    v_mfma_f32_16x16x32_bf16 v[236:239], a[40:43], a[92:95], v[236:239]
    ds_read_b128 a[60:63], v30 offset:23552
    v_max_u32_dpp v98, v98, v98 row_bcast:15 row_mask:0xa bank_mask:0xf
    v_mfma_f32_16x16x32_bf16 v[240:243], a[44:47], a[80:83], v[240:243]
    buffer_load_dwordx4 v7, s[20:23], s37 offen offset:2048 lds
    v_max_u32_dpp v98, v98, v98 row_bcast:31 row_mask:0xc bank_mask:0xf
    v_mfma_f32_16x16x32_bf16 v[244:247], a[44:47], a[84:87], v[244:247]
    v_readlane_b32 s46, v98, 63
    v_mfma_f32_16x16x32_bf16 v[248:251], a[44:47], a[88:91], v[248:251]
    buffer_load_dwordx4 v8, s[20:23], s37 offen offset:3072 lds
    v_writelane_b32 v97, s46, 7
    v_mfma_f32_16x16x32_bf16 v[252:255], a[44:47], a[92:95], v[252:255]
    s_add_u32 s37, s37, 32768
    s_and_b32 s37, s37, 524287
    v_writelane_b32 v97, s99, 8
    s_waitcnt vmcnt(14)
    s_waitcnt lgkmcnt(0)
    v_mfma_f32_16x16x32_bf16 v[192:195], a[0:3], a[48:51], v[192:195]
    ds_read_b64_tr_b16 a[16:17], v22 offset:8192
    s_add_u32 m0, s40, 4096
    v_mfma_f32_16x16x32_bf16 v[196:199], a[0:3], a[52:55], v[196:199]
    ds_read_b64_tr_b16 a[18:19], v22 offset:9216
    v_lshlrev_b32 v100, 2, v0
    v_mfma_f32_16x16x32_bf16 v[200:203], a[0:3], a[56:59], v[200:203]
    ds_read_b64_tr_b16 a[20:21], v23 offset:8192
    buffer_load_dwordx4 v5, s[20:23], s37 offen offset:0 lds
    v_mfma_f32_16x16x32_bf16 v[204:207], a[0:3], a[60:63], v[204:207]
    ds_read_b64_tr_b16 a[22:23], v23 offset:9216
    v_add_u32 v100, s40, v100
    v_mfma_f32_16x16x32_bf16 v[208:211], a[4:7], a[48:51], v[208:211]
    ds_read_b64_tr_b16 a[24:25], v24 offset:8192
    ds_write_b32 v100, v97 offset:20480
    v_mfma_f32_16x16x32_bf16 v[212:215], a[4:7], a[52:55], v[212:215]
    ds_read_b64_tr_b16 a[26:27], v24 offset:9216
    v_lshrrev_b32 v126, 3, v0
    v_mfma_f32_16x16x32_bf16 v[216:219], a[4:7], a[56:59], v[216:219]
    ds_read_b64_tr_b16 a[28:29], v25 offset:8192
    buffer_load_dwordx4 v6, s[20:23], s37 offen offset:1024 lds
    v_mfma_f32_16x16x32_bf16 v[220:223], a[4:7], a[60:63], v[220:223]
    ds_read_b64_tr_b16 a[30:31], v25 offset:9216
    v_and_b32 v126, 3, v126
    v_mfma_f32_16x16x32_bf16 v[224:227], a[8:11], a[48:51], v[224:227]
    ds_read_b128 a[64:67], v30 offset:24576
    v_mul_u32_u24 v126, 24576, v126
    v_mfma_f32_16x16x32_bf16 v[228:231], a[8:11], a[52:55], v[228:231]
    ds_read_b128 a[68:71], v30 offset:25600
    v_and_b32 v127, 7, v0
    v_mfma_f32_16x16x32_bf16 v[232:235], a[8:11], a[56:59], v[232:235]
    ds_read_b128 a[72:75], v30 offset:26624
    v_lshl_add_u32 v126, v127, 2, v126
    v_mfma_f32_16x16x32_bf16 v[236:239], a[8:11], a[60:63], v[236:239]
    ds_read_b128 a[76:79], v30 offset:27648
    v_add_u32 v126, 86016, v126
    v_mfma_f32_16x16x32_bf16 v[240:243], a[12:15], a[48:51], v[240:243]
    buffer_load_dwordx4 v7, s[20:23], s37 offen offset:2048 lds
    s_waitcnt lgkmcnt(7)
    s_barrier
    v_mfma_f32_16x16x32_bf16 v[244:247], a[12:15], a[52:55], v[244:247]
    ds_read_b32 v120, v126
    v_mov_b32 v127, 86016
    v_mfma_f32_16x16x32_bf16 v[248:251], a[12:15], a[56:59], v[248:251]
    buffer_load_dwordx4 v8, s[20:23], s37 offen offset:3072 lds
    ds_read_b128 v[88:91], v127
    v_mfma_f32_16x16x32_bf16 v[252:255], a[12:15], a[60:63], v[252:255]
    s_add_u32 s37, s37, 32768
    s_and_b32 s37, s37, 524287
    ds_read_b128 v[92:95], v127 offset:16
    s_waitcnt vmcnt(13)
    s_waitcnt lgkmcnt(3)
    v_mfma_f32_16x16x32_bf16 v[192:195], a[16:19], a[64:67], v[192:195]
    ds_read_b64_tr_b16 a[32:33], v22 offset:12288
    s_add_u32 m0, s40, 8192
    v_mfma_f32_16x16x32_bf16 v[196:199], a[16:19], a[68:71], v[196:199]
    ds_read_b64_tr_b16 a[34:35], v22 offset:13312
    ds_read_b32 v121, v127 offset:32
    v_mfma_f32_16x16x32_bf16 v[200:203], a[16:19], a[72:75], v[200:203]
    ds_read_b64_tr_b16 a[36:37], v23 offset:12288
    buffer_load_dwordx4 v5, s[20:23], s37 offen offset:0 lds
    v_mfma_f32_16x16x32_bf16 v[204:207], a[16:19], a[76:79], v[204:207]
    ds_read_b64_tr_b16 a[38:39], v23 offset:13312
    v_cvt_pk_bf16_f32 v76, v152, v153
    v_mfma_f32_16x16x32_bf16 v[208:211], a[20:23], a[64:67], v[208:211]
    ds_read_b64_tr_b16 a[40:41], v24 offset:12288
    v_cvt_pk_bf16_f32 v77, v154, v155
    v_mfma_f32_16x16x32_bf16 v[212:215], a[20:23], a[68:71], v[212:215]
    ds_read_b64_tr_b16 a[42:43], v24 offset:13312
    v_cvt_pk_bf16_f32 v78, v156, v157
    v_mfma_f32_16x16x32_bf16 v[216:219], a[20:23], a[72:75], v[216:219]
    ds_read_b64_tr_b16 a[44:45], v25 offset:12288
    buffer_load_dwordx4 v6, s[20:23], s37 offen offset:1024 lds
    v_mfma_f32_16x16x32_bf16 v[220:223], a[20:23], a[76:79], v[220:223]
    ds_read_b64_tr_b16 a[46:47], v25 offset:13312
    v_cvt_pk_bf16_f32 v79, v158, v159
    v_mfma_f32_16x16x32_bf16 v[224:227], a[24:27], a[64:67], v[224:227]
    ds_read_b128 a[80:83], v30 offset:28672
    v_permlane16_swap_b32 v76, v78
    v_mfma_f32_16x16x32_bf16 v[228:231], a[24:27], a[68:71], v[228:231]
    ds_read_b128 a[84:87], v30 offset:29696
    v_permlane16_swap_b32 v77, v79
    v_mfma_f32_16x16x32_bf16 v[232:235], a[24:27], a[72:75], v[232:235]
    ds_read_b128 a[88:91], v30 offset:30720
    buffer_store_dwordx4 v[76:79], v57, s[24:27], 0 offen offset:3072 sc1
    v_mfma_f32_16x16x32_bf16 v[236:239], a[24:27], a[76:79], v[236:239]
    ds_read_b128 a[92:95], v30 offset:31744
    v_mov_b32 v127, 110592
    v_mfma_f32_16x16x32_bf16 v[240:243], a[28:31], a[64:67], v[240:243]
    buffer_load_dwordx4 v7, s[20:23], s37 offen offset:2048 lds
    ds_read_b128 v[96:99], v127
    v_mfma_f32_16x16x32_bf16 v[244:247], a[28:31], a[68:71], v[244:247]
    ds_read_b128 v[100:103], v127 offset:16
    ds_read_b32 v122, v127 offset:32
    v_mfma_f32_16x16x32_bf16 v[248:251], a[28:31], a[72:75], v[248:251]
    buffer_load_dwordx4 v8, s[20:23], s37 offen offset:3072 lds
    v_mov_b32 v127, 135168
    v_mfma_f32_16x16x32_bf16 v[252:255], a[28:31], a[76:79], v[252:255]
    s_add_u32 s37, s37, 32768
    s_and_b32 s37, s37, 524287
    ds_read_b128 v[104:107], v127
    s_waitcnt vmcnt(14)
    s_waitcnt lgkmcnt(4)
    v_mfma_f32_16x16x32_bf16 v[192:195], a[32:35], a[80:83], v[192:195]
    ds_read_b64_tr_b16 a[0:1], v22 offset:16384
    s_add_u32 m0, s40, 12288
    v_mfma_f32_16x16x32_bf16 v[196:199], a[32:35], a[84:87], v[196:199]
    ds_read_b64_tr_b16 a[2:3], v22 offset:17408
    ds_read_b128 v[108:111], v127 offset:16
    v_mfma_f32_16x16x32_bf16 v[200:203], a[32:35], a[88:91], v[200:203]
    ds_read_b64_tr_b16 a[4:5], v23 offset:16384
    buffer_load_dwordx4 v5, s[20:23], s37 offen offset:0 lds
    v_mfma_f32_16x16x32_bf16 v[204:207], a[32:35], a[92:95], v[204:207]
    ds_read_b64_tr_b16 a[6:7], v23 offset:17408
    ds_read_b32 v123, v127 offset:32
    v_mfma_f32_16x16x32_bf16 v[208:211], a[36:39], a[80:83], v[208:211]
    ds_read_b64_tr_b16 a[8:9], v24 offset:16384
    v_mov_b32 v127, 159744
    v_mfma_f32_16x16x32_bf16 v[212:215], a[36:39], a[84:87], v[212:215]
    ds_read_b64_tr_b16 a[10:11], v24 offset:17408
    ds_read_b128 v[112:115], v127
    v_mfma_f32_16x16x32_bf16 v[216:219], a[36:39], a[88:91], v[216:219]
    ds_read_b64_tr_b16 a[12:13], v25 offset:16384
    buffer_load_dwordx4 v6, s[20:23], s37 offen offset:1024 lds
    v_mfma_f32_16x16x32_bf16 v[220:223], a[36:39], a[92:95], v[220:223]
    ds_read_b64_tr_b16 a[14:15], v25 offset:17408
    ds_read_b128 v[116:119], v127 offset:16
    v_mfma_f32_16x16x32_bf16 v[224:227], a[40:43], a[80:83], v[224:227]
    ds_read_b128 a[48:51], v30 offset:32768
    ds_read_b32 v124, v127 offset:32
    v_mfma_f32_16x16x32_bf16 v[228:231], a[40:43], a[84:87], v[228:231]
    ds_read_b128 a[52:55], v30 offset:33792
    v_mov_b32 v125, 0
    v_mfma_f32_16x16x32_bf16 v[232:235], a[40:43], a[88:91], v[232:235]
    ds_read_b128 a[56:59], v30 offset:34816
    s_waitcnt lgkmcnt(2)
    v_mfma_f32_16x16x32_bf16 v[236:239], a[40:43], a[92:95], v[236:239]
    ds_read_b128 a[60:63], v30 offset:35840
    v_and_b32 v121, v121, v122
    v_mfma_f32_16x16x32_bf16 v[240:243], a[44:47], a[80:83], v[240:243]
    buffer_load_dwordx4 v7, s[20:23], s37 offen offset:2048 lds
    v_and_b32 v123, v123, v124
    v_mfma_f32_16x16x32_bf16 v[244:247], a[44:47], a[84:87], v[244:247]
    v_and_b32 v121, v121, v123
    v_cmp_gt_u32 s[60:61], v88, v120
    v_mfma_f32_16x16x32_bf16 v[248:251], a[44:47], a[88:91], v[248:251]
    buffer_load_dwordx4 v8, s[20:23], s37 offen offset:3072 lds
    v_cmp_gt_u32 s[62:63], v89, v120
    v_mfma_f32_16x16x32_bf16 v[252:255], a[44:47], a[92:95], v[252:255]
    s_add_u32 s37, s37, 32768
    s_and_b32 s37, s37, 524287
    v_cmp_gt_u32 s[64:65], v90, v120
    s_waitcnt vmcnt(13)
    s_waitcnt lgkmcnt(0)
    v_mfma_f32_16x16x32_bf16 v[192:195], a[0:3], a[48:51], v[192:195]
    ds_read_b64_tr_b16 a[16:17], v22 offset:0
    s_add_u32 m0, s40, 16384
    v_mfma_f32_16x16x32_bf16 v[196:199], a[0:3], a[52:55], v[196:199]
    ds_read_b64_tr_b16 a[18:19], v22 offset:1024
    v_cmp_gt_u32 s[66:67], v91, v120
    v_mfma_f32_16x16x32_bf16 v[200:203], a[0:3], a[56:59], v[200:203]
    ds_read_b64_tr_b16 a[20:21], v23 offset:0
    buffer_load_dwordx4 v5, s[20:23], s37 offen offset:0 lds
    v_mfma_f32_16x16x32_bf16 v[204:207], a[0:3], a[60:63], v[204:207]
    ds_read_b64_tr_b16 a[22:23], v23 offset:1024
    v_cvt_pk_bf16_f32 v64, v160, v161
    v_mfma_f32_16x16x32_bf16 v[208:211], a[4:7], a[48:51], v[208:211]
    ds_read_b64_tr_b16 a[24:25], v24 offset:0
    v_cvt_pk_bf16_f32 v65, v162, v163
    v_mfma_f32_16x16x32_bf16 v[212:215], a[4:7], a[52:55], v[212:215]
    ds_read_b64_tr_b16 a[26:27], v24 offset:1024
    v_cvt_pk_bf16_f32 v66, v164, v165
    v_mfma_f32_16x16x32_bf16 v[216:219], a[4:7], a[56:59], v[216:219]
    ds_read_b64_tr_b16 a[28:29], v25 offset:0
    buffer_load_dwordx4 v6, s[20:23], s37 offen offset:1024 lds
    v_mfma_f32_16x16x32_bf16 v[220:223], a[4:7], a[60:63], v[220:223]
    ds_read_b64_tr_b16 a[30:31], v25 offset:1024
    v_cvt_pk_bf16_f32 v67, v166, v167
    v_mfma_f32_16x16x32_bf16 v[224:227], a[8:11], a[48:51], v[224:227]
    ds_read_b128 a[64:67], v30 offset:36864
    v_permlane16_swap_b32 v64, v66
    v_mfma_f32_16x16x32_bf16 v[228:231], a[8:11], a[52:55], v[228:231]
    ds_read_b128 a[68:71], v30 offset:37888
    v_permlane16_swap_b32 v65, v67
    v_mfma_f32_16x16x32_bf16 v[232:235], a[8:11], a[56:59], v[232:235]
    ds_read_b128 a[72:75], v30 offset:38912
    buffer_store_dwordx4 v[64:67], v57, s[24:27], s48 offen offset:0 sc1
    v_mfma_f32_16x16x32_bf16 v[236:239], a[8:11], a[60:63], v[236:239]
    ds_read_b128 a[76:79], v30 offset:39936
    v_addc_co_u32 v125, vcc, 0, v125, s[60:61]
    v_mfma_f32_16x16x32_bf16 v[240:243], a[12:15], a[48:51], v[240:243]
    buffer_load_dwordx4 v7, s[20:23], s37 offen offset:2048 lds
    v_addc_co_u32 v125, vcc, 0, v125, s[62:63]
    v_mfma_f32_16x16x32_bf16 v[244:247], a[12:15], a[52:55], v[244:247]
    v_addc_co_u32 v125, vcc, 0, v125, s[64:65]
    v_addc_co_u32 v125, vcc, 0, v125, s[66:67]
    v_mfma_f32_16x16x32_bf16 v[248:251], a[12:15], a[56:59], v[248:251]
    buffer_load_dwordx4 v8, s[20:23], s37 offen offset:3072 lds
    v_cmp_gt_u32 s[60:61], v92, v120
    v_mfma_f32_16x16x32_bf16 v[252:255], a[12:15], a[60:63], v[252:255]
    s_add_u32 s37, s37, 32768
    s_and_b32 s37, s37, 524287
    v_cmp_gt_u32 s[62:63], v93, v120
    s_waitcnt vmcnt(14)
    s_waitcnt lgkmcnt(0)
    v_mfma_f32_16x16x32_bf16 v[192:195], a[16:19], a[64:67], v[192:195]
    ds_read_b64_tr_b16 a[32:33], v22 offset:4096
    s_add_u32 m0, s40, 0
    v_mfma_f32_16x16x32_bf16 v[196:199], a[16:19], a[68:71], v[196:199]
    ds_read_b64_tr_b16 a[34:35], v22 offset:5120
    v_cmp_gt_u32 s[64:65], v94, v120
    v_mfma_f32_16x16x32_bf16 v[200:203], a[16:19], a[72:75], v[200:203]
    ds_read_b64_tr_b16 a[36:37], v23 offset:4096
    buffer_load_dwordx4 v5, s[20:23], s37 offen offset:0 lds
    v_mfma_f32_16x16x32_bf16 v[204:207], a[16:19], a[76:79], v[204:207]
    ds_read_b64_tr_b16 a[38:39], v23 offset:5120
    v_cmp_gt_u32 s[66:67], v95, v120
    v_mfma_f32_16x16x32_bf16 v[208:211], a[20:23], a[64:67], v[208:211]
    ds_read_b64_tr_b16 a[40:41], v24 offset:4096
    v_addc_co_u32 v125, vcc, 0, v125, s[60:61]
    v_mfma_f32_16x16x32_bf16 v[212:215], a[20:23], a[68:71], v[212:215]
    ds_read_b64_tr_b16 a[42:43], v24 offset:5120
    v_addc_co_u32 v125, vcc, 0, v125, s[62:63]
    v_mfma_f32_16x16x32_bf16 v[216:219], a[20:23], a[72:75], v[216:219]
    ds_read_b64_tr_b16 a[44:45], v25 offset:4096
    buffer_load_dwordx4 v6, s[20:23], s37 offen offset:1024 lds
    v_mfma_f32_16x16x32_bf16 v[220:223], a[20:23], a[76:79], v[220:223]
    ds_read_b64_tr_b16 a[46:47], v25 offset:5120
    v_addc_co_u32 v125, vcc, 0, v125, s[64:65]
    v_mfma_f32_16x16x32_bf16 v[224:227], a[24:27], a[64:67], v[224:227]
    ds_read_b128 a[80:83], v30 offset:40960
    v_addc_co_u32 v125, vcc, 0, v125, s[66:67]
    v_mfma_f32_16x16x32_bf16 v[228:231], a[24:27], a[68:71], v[228:231]
    ds_read_b128 a[84:87], v30 offset:41984
    v_cmp_gt_u32 s[60:61], v96, v120
    v_mfma_f32_16x16x32_bf16 v[232:235], a[24:27], a[72:75], v[232:235]
    ds_read_b128 a[88:91], v30 offset:43008
    v_cmp_gt_u32 s[62:63], v97, v120
    v_mfma_f32_16x16x32_bf16 v[236:239], a[24:27], a[76:79], v[236:239]
    ds_read_b128 a[92:95], v30 offset:44032
    v_cmp_gt_u32 s[64:65], v98, v120
    v_mfma_f32_16x16x32_bf16 v[240:243], a[28:31], a[64:67], v[240:243]
    buffer_load_dwordx4 v7, s[20:23], s37 offen offset:2048 lds
    v_cmp_gt_u32 s[66:67], v99, v120
    v_mfma_f32_16x16x32_bf16 v[244:247], a[28:31], a[68:71], v[244:247]
    v_addc_co_u32 v125, vcc, 0, v125, s[60:61]
    v_addc_co_u32 v125, vcc, 0, v125, s[62:63]
    v_mfma_f32_16x16x32_bf16 v[248:251], a[28:31], a[72:75], v[248:251]
    buffer_load_dwordx4 v8, s[20:23], s37 offen offset:3072 lds
    v_addc_co_u32 v125, vcc, 0, v125, s[64:65]
    v_mfma_f32_16x16x32_bf16 v[252:255], a[28:31], a[76:79], v[252:255]
    s_add_u32 s37, s37, 32768
    s_and_b32 s37, s37, 524287
    v_addc_co_u32 v125, vcc, 0, v125, s[66:67]
    s_waitcnt vmcnt(13)
    s_waitcnt lgkmcnt(0)
    v_mfma_f32_16x16x32_bf16 v[192:195], a[32:35], a[80:83], v[192:195]
    ds_read_b64_tr_b16 a[0:1], v22 offset:8192
    s_add_u32 m0, s40, 4096
    v_mfma_f32_16x16x32_bf16 v[196:199], a[32:35], a[84:87], v[196:199]
    ds_read_b64_tr_b16 a[2:3], v22 offset:9216
    v_cmp_gt_u32 s[60:61], v100, v120
    v_mfma_f32_16x16x32_bf16 v[200:203], a[32:35], a[88:91], v[200:203]
    ds_read_b64_tr_b16 a[4:5], v23 offset:8192
    buffer_load_dwordx4 v5, s[20:23], s37 offen offset:0 lds
    v_mfma_f32_16x16x32_bf16 v[204:207], a[32:35], a[92:95], v[204:207]
    ds_read_b64_tr_b16 a[6:7], v23 offset:9216
    v_cvt_pk_bf16_f32 v68, v168, v169
    v_mfma_f32_16x16x32_bf16 v[208:211], a[36:39], a[80:83], v[208:211]
    ds_read_b64_tr_b16 a[8:9], v24 offset:8192
    v_cvt_pk_bf16_f32 v69, v170, v171
    v_mfma_f32_16x16x32_bf16 v[212:215], a[36:39], a[84:87], v[212:215]
    ds_read_b64_tr_b16 a[10:11], v24 offset:9216
    v_cvt_pk_bf16_f32 v70, v172, v173
    v_mfma_f32_16x16x32_bf16 v[216:219], a[36:39], a[88:91], v[216:219]
    ds_read_b64_tr_b16 a[12:13], v25 offset:8192
    buffer_load_dwordx4 v6, s[20:23], s37 offen offset:1024 lds
    v_mfma_f32_16x16x32_bf16 v[220:223], a[36:39], a[92:95], v[220:223]
    ds_read_b64_tr_b16 a[14:15], v25 offset:9216
    v_cvt_pk_bf16_f32 v71, v174, v175
    v_mfma_f32_16x16x32_bf16 v[224:227], a[40:43], a[80:83], v[224:227]
    ds_read_b128 a[48:51], v30 offset:45056
    v_permlane16_swap_b32 v68, v70
    v_mfma_f32_16x16x32_bf16 v[228:231], a[40:43], a[84:87], v[228:231]
    ds_read_b128 a[52:55], v30 offset:46080
    v_permlane16_swap_b32 v69, v71
    v_mfma_f32_16x16x32_bf16 v[232:235], a[40:43], a[88:91], v[232:235]
    ds_read_b128 a[56:59], v30 offset:47104
    buffer_store_dwordx4 v[68:71], v57, s[24:27], s48 offen offset:1024 sc1
    v_mfma_f32_16x16x32_bf16 v[236:239], a[40:43], a[92:95], v[236:239]
    ds_read_b128 a[60:63], v30 offset:48128
    v_cmp_gt_u32 s[62:63], v101, v120
    v_mfma_f32_16x16x32_bf16 v[240:243], a[44:47], a[80:83], v[240:243]
    buffer_load_dwordx4 v7, s[20:23], s37 offen offset:2048 lds
    v_cmp_gt_u32 s[64:65], v102, v120
    v_mfma_f32_16x16x32_bf16 v[244:247], a[44:47], a[84:87], v[244:247]
    v_cmp_gt_u32 s[66:67], v103, v120
    v_addc_co_u32 v125, vcc, 0, v125, s[60:61]
    v_mfma_f32_16x16x32_bf16 v[248:251], a[44:47], a[88:91], v[248:251]
    buffer_load_dwordx4 v8, s[20:23], s37 offen offset:3072 lds
    v_addc_co_u32 v125, vcc, 0, v125, s[62:63]
    v_mfma_f32_16x16x32_bf16 v[252:255], a[44:47], a[92:95], v[252:255]
    s_add_u32 s37, s37, 32768
    s_and_b32 s37, s37, 524287
    v_addc_co_u32 v125, vcc, 0, v125, s[64:65]
    s_waitcnt vmcnt(14)
    s_waitcnt lgkmcnt(0)
    v_mfma_f32_16x16x32_bf16 v[192:195], a[0:3], a[48:51], v[192:195]
    ds_read_b64_tr_b16 a[16:17], v22 offset:12288
    v_addc_co_u32 v125, vcc, 0, v125, s[66:67]
    v_mfma_f32_16x16x32_bf16 v[196:199], a[0:3], a[52:55], v[196:199]
    ds_read_b64_tr_b16 a[18:19], v22 offset:13312
    v_cmp_gt_u32 s[60:61], v104, v120
    v_mfma_f32_16x16x32_bf16 v[200:203], a[0:3], a[56:59], v[200:203]
    ds_read_b64_tr_b16 a[20:21], v23 offset:12288
    v_cmp_gt_u32 s[62:63], v105, v120
    v_mfma_f32_16x16x32_bf16 v[204:207], a[0:3], a[60:63], v[204:207]
    ds_read_b64_tr_b16 a[22:23], v23 offset:13312
    v_cmp_gt_u32 s[64:65], v106, v120
    v_mfma_f32_16x16x32_bf16 v[208:211], a[4:7], a[48:51], v[208:211]
    ds_read_b64_tr_b16 a[24:25], v24 offset:12288
    v_cmp_gt_u32 s[66:67], v107, v120
    v_mfma_f32_16x16x32_bf16 v[212:215], a[4:7], a[52:55], v[212:215]
    ds_read_b64_tr_b16 a[26:27], v24 offset:13312
    v_addc_co_u32 v125, vcc, 0, v125, s[60:61]
    v_mfma_f32_16x16x32_bf16 v[216:219], a[4:7], a[56:59], v[216:219]
    ds_read_b64_tr_b16 a[28:29], v25 offset:12288
    v_addc_co_u32 v125, vcc, 0, v125, s[62:63]
    v_mfma_f32_16x16x32_bf16 v[220:223], a[4:7], a[60:63], v[220:223]
    ds_read_b64_tr_b16 a[30:31], v25 offset:13312
    v_addc_co_u32 v125, vcc, 0, v125, s[64:65]
    v_mfma_f32_16x16x32_bf16 v[224:227], a[8:11], a[48:51], v[224:227]
    ds_read_b128 a[64:67], v30 offset:49152
    v_addc_co_u32 v125, vcc, 0, v125, s[66:67]
    v_mfma_f32_16x16x32_bf16 v[228:231], a[8:11], a[52:55], v[228:231]
    ds_read_b128 a[68:71], v30 offset:50176
    v_cmp_gt_u32 s[60:61], v108, v120
    v_mfma_f32_16x16x32_bf16 v[232:235], a[8:11], a[56:59], v[232:235]
    ds_read_b128 a[72:75], v30 offset:51200
    v_cmp_gt_u32 s[62:63], v109, v120
    v_mfma_f32_16x16x32_bf16 v[236:239], a[8:11], a[60:63], v[236:239]
    ds_read_b128 a[76:79], v30 offset:52224
    v_cmp_gt_u32 s[64:65], v110, v120
    v_mfma_f32_16x16x32_bf16 v[240:243], a[12:15], a[48:51], v[240:243]
    v_cmp_gt_u32 s[66:67], v111, v120
    v_addc_co_u32 v125, vcc, 0, v125, s[60:61]
    v_mfma_f32_16x16x32_bf16 v[244:247], a[12:15], a[52:55], v[244:247]
    v_addc_co_u32 v125, vcc, 0, v125, s[62:63]
    v_addc_co_u32 v125, vcc, 0, v125, s[64:65]
    v_mfma_f32_16x16x32_bf16 v[248:251], a[12:15], a[56:59], v[248:251]
    v_addc_co_u32 v125, vcc, 0, v125, s[66:67]
    v_cmp_gt_u32 s[60:61], v112, v120
    v_mfma_f32_16x16x32_bf16 v[252:255], a[12:15], a[60:63], v[252:255]
    v_cmp_gt_u32 s[62:63], v113, v120
    v_cmp_gt_u32 s[64:65], v114, v120
    s_waitcnt vmcnt(9)
    s_waitcnt lgkmcnt(0)
    v_mfma_f32_16x16x32_bf16 v[192:195], a[16:19], a[64:67], v[192:195]
    ds_read_b64_tr_b16 a[32:33], v22 offset:16384
    v_cmp_gt_u32 s[66:67], v115, v120
    v_mfma_f32_16x16x32_bf16 v[196:199], a[16:19], a[68:71], v[196:199]
    ds_read_b64_tr_b16 a[34:35], v22 offset:17408
    v_addc_co_u32 v125, vcc, 0, v125, s[60:61]
    v_mfma_f32_16x16x32_bf16 v[200:203], a[16:19], a[72:75], v[200:203]
    ds_read_b64_tr_b16 a[36:37], v23 offset:16384
    v_cvt_pk_bf16_f32 v72, v176, v177
    v_mfma_f32_16x16x32_bf16 v[204:207], a[16:19], a[76:79], v[204:207]
    ds_read_b64_tr_b16 a[38:39], v23 offset:17408
    v_cvt_pk_bf16_f32 v73, v178, v179
    v_mfma_f32_16x16x32_bf16 v[208:211], a[20:23], a[64:67], v[208:211]
    ds_read_b64_tr_b16 a[40:41], v24 offset:16384
    v_cvt_pk_bf16_f32 v74, v180, v181
    v_mfma_f32_16x16x32_bf16 v[212:215], a[20:23], a[68:71], v[212:215]
    ds_read_b64_tr_b16 a[42:43], v24 offset:17408
    v_cvt_pk_bf16_f32 v75, v182, v183
    v_mfma_f32_16x16x32_bf16 v[216:219], a[20:23], a[72:75], v[216:219]
    ds_read_b64_tr_b16 a[44:45], v25 offset:16384
    v_permlane16_swap_b32 v72, v74
    v_mfma_f32_16x16x32_bf16 v[220:223], a[20:23], a[76:79], v[220:223]
    ds_read_b64_tr_b16 a[46:47], v25 offset:17408
    v_permlane16_swap_b32 v73, v75
    v_mfma_f32_16x16x32_bf16 v[224:227], a[24:27], a[64:67], v[224:227]
    ds_read_b128 a[80:83], v30 offset:53248
    buffer_store_dwordx4 v[72:75], v57, s[24:27], s48 offen offset:2048 sc1
    v_mfma_f32_16x16x32_bf16 v[228:231], a[24:27], a[68:71], v[228:231]
    ds_read_b128 a[84:87], v30 offset:54272
    v_addc_co_u32 v125, vcc, 0, v125, s[62:63]
    v_mfma_f32_16x16x32_bf16 v[232:235], a[24:27], a[72:75], v[232:235]
    ds_read_b128 a[88:91], v30 offset:55296
    v_addc_co_u32 v125, vcc, 0, v125, s[64:65]
    v_mfma_f32_16x16x32_bf16 v[236:239], a[24:27], a[76:79], v[236:239]
    ds_read_b128 a[92:95], v30 offset:56320
    v_addc_co_u32 v125, vcc, 0, v125, s[66:67]
    v_mfma_f32_16x16x32_bf16 v[240:243], a[28:31], a[64:67], v[240:243]
    v_cmp_gt_u32 s[60:61], v116, v120
    v_cmp_gt_u32 s[62:63], v117, v120
    v_mfma_f32_16x16x32_bf16 v[244:247], a[28:31], a[68:71], v[244:247]
    v_cmp_gt_u32 s[64:65], v118, v120
    v_cmp_gt_u32 s[66:67], v119, v120
    v_mfma_f32_16x16x32_bf16 v[248:251], a[28:31], a[72:75], v[248:251]
    v_addc_co_u32 v125, vcc, 0, v125, s[60:61]
    v_addc_co_u32 v125, vcc, 0, v125, s[62:63]
    v_mfma_f32_16x16x32_bf16 v[252:255], a[28:31], a[76:79], v[252:255]
    v_addc_co_u32 v125, vcc, 0, v125, s[64:65]
    v_addc_co_u32 v125, vcc, 0, v125, s[66:67]
    s_waitcnt vmcnt(6)
    s_waitcnt lgkmcnt(0)
    v_mfma_f32_16x16x32_bf16 v[192:195], a[32:35], a[80:83], v[192:195]
    ds_read_b64_tr_b16 a[0:1], v22 offset:0
    v_readfirstlane_b32 s99, v121
    v_mfma_f32_16x16x32_bf16 v[196:199], a[32:35], a[84:87], v[196:199]
    ds_read_b64_tr_b16 a[2:3], v22 offset:1024
    v_lshlrev_b32 v126, 2, v125
    v_mfma_f32_16x16x32_bf16 v[200:203], a[32:35], a[88:91], v[200:203]
    ds_read_b64_tr_b16 a[4:5], v23 offset:0
    v_add_u32 v126, s40, v126
    v_mfma_f32_16x16x32_bf16 v[204:207], a[32:35], a[92:95], v[204:207]
    ds_read_b64_tr_b16 a[6:7], v23 offset:1024
    ds_write_b32 v126, v120 offset:20544
    v_mfma_f32_16x16x32_bf16 v[208:211], a[36:39], a[80:83], v[208:211]
    ds_read_b64_tr_b16 a[8:9], v24 offset:0
    v_and_b32 v127, 7, v0
    v_mfma_f32_16x16x32_bf16 v[212:215], a[36:39], a[84:87], v[212:215]
    ds_read_b64_tr_b16 a[10:11], v24 offset:1024
    v_lshlrev_b32 v127, 2, v127
    v_mfma_f32_16x16x32_bf16 v[216:219], a[36:39], a[88:91], v[216:219]
    ds_read_b64_tr_b16 a[12:13], v25 offset:0
    v_add_u32 v127, s40, v127
    v_mfma_f32_16x16x32_bf16 v[220:223], a[36:39], a[92:95], v[220:223]
    ds_read_b64_tr_b16 a[14:15], v25 offset:1024
    ds_read_b32 v124, v127 offset:20544
    v_mfma_f32_16x16x32_bf16 v[224:227], a[40:43], a[80:83], v[224:227]
    ds_read_b128 a[48:51], v30 offset:57344
    v_lshrrev_b32 v122, 4, v0
    v_mfma_f32_16x16x32_bf16 v[228:231], a[40:43], a[84:87], v[228:231]
    ds_read_b128 a[52:55], v30 offset:58368
    v_lshlrev_b32 v122, 4, v122
    v_mfma_f32_16x16x32_bf16 v[232:235], a[40:43], a[88:91], v[232:235]
    ds_read_b128 a[56:59], v30 offset:59392
    s_lshl_b32 s47, s34, 8
    v_mfma_f32_16x16x32_bf16 v[236:239], a[40:43], a[92:95], v[236:239]
    ds_read_b128 a[60:63], v30 offset:60416
    s_waitcnt lgkmcnt(4)
    v_mfma_f32_16x16x32_bf16 v[240:243], a[44:47], a[80:83], v[240:243]
    v_and_b32 v123, 0x7ff, v124
    v_sub_u32 v123, 2047, v123
    v_mfma_f32_16x16x32_bf16 v[244:247], a[44:47], a[84:87], v[244:247]
    v_accvgpr_write_b32 a225, v124
    v_lshl_add_u32 v122, v123, 10, v122
    v_mfma_f32_16x16x32_bf16 v[248:251], a[44:47], a[88:91], v[248:251]
    v_lshlrev_b32 v123, 2, v123
    v_add_u32 v123, 16785408, v123
    v_mfma_f32_16x16x32_bf16 v[252:255], a[44:47], a[92:95], v[252:255]
    buffer_load_dword a224, v123, s[24:27], 0 offen sc1
    buffer_load_dwordx4 a[208:211], v122, s[4:7], s47 offen offset:0
    s_waitcnt vmcnt(3)
    s_waitcnt lgkmcnt(0)
    v_mfma_f32_16x16x32_bf16 v[192:195], a[0:3], a[48:51], v[192:195]
    ds_read_b64_tr_b16 a[16:17], v22 offset:4096
    buffer_load_dwordx4 a[212:215], v122, s[4:7], s47 offen offset:64
    v_mfma_f32_16x16x32_bf16 v[196:199], a[0:3], a[52:55], v[196:199]
    ds_read_b64_tr_b16 a[18:19], v22 offset:5120
    buffer_load_dwordx4 a[216:219], v122, s[4:7], s47 offen offset:128
    v_mfma_f32_16x16x32_bf16 v[200:203], a[0:3], a[56:59], v[200:203]
    ds_read_b64_tr_b16 a[20:21], v23 offset:4096
    v_cvt_pk_bf16_f32 v76, v184, v185
    v_mfma_f32_16x16x32_bf16 v[204:207], a[0:3], a[60:63], v[204:207]
    ds_read_b64_tr_b16 a[22:23], v23 offset:5120
    v_cvt_pk_bf16_f32 v77, v186, v187
    v_mfma_f32_16x16x32_bf16 v[208:211], a[4:7], a[48:51], v[208:211]
    ds_read_b64_tr_b16 a[24:25], v24 offset:4096
    v_cvt_pk_bf16_f32 v78, v188, v189
    v_mfma_f32_16x16x32_bf16 v[212:215], a[4:7], a[52:55], v[212:215]
    ds_read_b64_tr_b16 a[26:27], v24 offset:5120
    v_cvt_pk_bf16_f32 v79, v190, v191
    v_mfma_f32_16x16x32_bf16 v[216:219], a[4:7], a[56:59], v[216:219]
    ds_read_b64_tr_b16 a[28:29], v25 offset:4096
    v_permlane16_swap_b32 v76, v78
    v_mfma_f32_16x16x32_bf16 v[220:223], a[4:7], a[60:63], v[220:223]
    ds_read_b64_tr_b16 a[30:31], v25 offset:5120
    v_permlane16_swap_b32 v77, v79
    v_mfma_f32_16x16x32_bf16 v[224:227], a[8:11], a[48:51], v[224:227]
    ds_read_b128 a[64:67], v30 offset:61440
    buffer_store_dwordx4 v[76:79], v57, s[24:27], s48 offen offset:3072 sc1
    v_mfma_f32_16x16x32_bf16 v[228:231], a[8:11], a[52:55], v[228:231]
    ds_read_b128 a[68:71], v30 offset:62464
    buffer_load_dwordx4 a[220:223], v122, s[4:7], s47 offen offset:192
    v_mfma_f32_16x16x32_bf16 v[232:235], a[8:11], a[56:59], v[232:235]
    ds_read_b128 a[72:75], v30 offset:63488
    v_mfma_f32_16x16x32_bf16 v[236:239], a[8:11], a[60:63], v[236:239]
    ds_read_b128 a[76:79], v30 offset:64512
    v_mfma_f32_16x16x32_bf16 v[240:243], a[12:15], a[48:51], v[240:243]
    v_mfma_f32_16x16x32_bf16 v[244:247], a[12:15], a[52:55], v[244:247]
    v_mfma_f32_16x16x32_bf16 v[248:251], a[12:15], a[56:59], v[248:251]
    v_mfma_f32_16x16x32_bf16 v[252:255], a[12:15], a[60:63], v[252:255]
    s_waitcnt lgkmcnt(0)
    v_mfma_f32_16x16x32_bf16 v[192:195], a[16:19], a[64:67], v[192:195]
    v_mfma_f32_16x16x32_bf16 v[196:199], a[16:19], a[68:71], v[196:199]
    v_mfma_f32_16x16x32_bf16 v[200:203], a[16:19], a[72:75], v[200:203]
    v_mfma_f32_16x16x32_bf16 v[204:207], a[16:19], a[76:79], v[204:207]
    v_mfma_f32_16x16x32_bf16 v[208:211], a[20:23], a[64:67], v[208:211]
    v_mfma_f32_16x16x32_bf16 v[212:215], a[20:23], a[68:71], v[212:215]
    v_mfma_f32_16x16x32_bf16 v[216:219], a[20:23], a[72:75], v[216:219]
    v_mfma_f32_16x16x32_bf16 v[220:223], a[20:23], a[76:79], v[220:223]
    v_mfma_f32_16x16x32_bf16 v[224:227], a[24:27], a[64:67], v[224:227]
    v_mfma_f32_16x16x32_bf16 v[228:231], a[24:27], a[68:71], v[228:231]
    v_mfma_f32_16x16x32_bf16 v[232:235], a[24:27], a[72:75], v[232:235]
    v_mfma_f32_16x16x32_bf16 v[236:239], a[24:27], a[76:79], v[236:239]
    v_mfma_f32_16x16x32_bf16 v[240:243], a[28:31], a[64:67], v[240:243]
    v_mfma_f32_16x16x32_bf16 v[244:247], a[28:31], a[68:71], v[244:247]
    v_mfma_f32_16x16x32_bf16 v[248:251], a[28:31], a[72:75], v[248:251]
    v_mfma_f32_16x16x32_bf16 v[252:255], a[28:31], a[76:79], v[252:255]
    s_nop 5
    v_cvt_pk_bf16_f32 v64, v192, v193
    v_cvt_pk_bf16_f32 v65, v194, v195
    v_cvt_pk_bf16_f32 v66, v196, v197
    v_cvt_pk_bf16_f32 v67, v198, v199
    s_nop 1
    v_permlane16_swap_b32 v64, v66
    s_nop 0
    v_permlane16_swap_b32 v65, v67
    buffer_store_dwordx4 v[64:67], v57, s[24:27], s49 offen offset:0 sc1
    s_nop 1
    v_cvt_pk_bf16_f32 v68, v200, v201
    v_cvt_pk_bf16_f32 v69, v202, v203
    v_cvt_pk_bf16_f32 v70, v204, v205
    v_cvt_pk_bf16_f32 v71, v206, v207
    s_nop 1
    v_permlane16_swap_b32 v68, v70
    s_nop 0
    v_permlane16_swap_b32 v69, v71
    buffer_store_dwordx4 v[68:71], v57, s[24:27], s49 offen offset:1024 sc1
    s_nop 1
    v_cvt_pk_bf16_f32 v72, v208, v209
    v_cvt_pk_bf16_f32 v73, v210, v211
    v_cvt_pk_bf16_f32 v74, v212, v213
    v_cvt_pk_bf16_f32 v75, v214, v215
    s_nop 1
    v_permlane16_swap_b32 v72, v74
    s_nop 0
    v_permlane16_swap_b32 v73, v75
    buffer_store_dwordx4 v[72:75], v57, s[24:27], s49 offen offset:2048 sc1
    s_nop 1
    v_cvt_pk_bf16_f32 v76, v216, v217
    v_cvt_pk_bf16_f32 v77, v218, v219
    v_cvt_pk_bf16_f32 v78, v220, v221
    v_cvt_pk_bf16_f32 v79, v222, v223
    s_nop 1
    v_permlane16_swap_b32 v76, v78
    s_nop 0
    v_permlane16_swap_b32 v77, v79
    buffer_store_dwordx4 v[76:79], v57, s[24:27], s49 offen offset:3072 sc1
    s_nop 1
    v_cvt_pk_bf16_f32 v80, v224, v225
    v_cvt_pk_bf16_f32 v81, v226, v227
    v_cvt_pk_bf16_f32 v82, v228, v229
    v_cvt_pk_bf16_f32 v83, v230, v231
    s_nop 1
    v_permlane16_swap_b32 v80, v82
    s_nop 0
    v_permlane16_swap_b32 v81, v83
    buffer_store_dwordx4 v[80:83], v57, s[24:27], s50 offen offset:0 sc1
    s_nop 1
    v_cvt_pk_bf16_f32 v84, v232, v233
    v_cvt_pk_bf16_f32 v85, v234, v235
    v_cvt_pk_bf16_f32 v86, v236, v237
    v_cvt_pk_bf16_f32 v87, v238, v239
    s_nop 1
    v_permlane16_swap_b32 v84, v86
    s_nop 0
    v_permlane16_swap_b32 v85, v87
    buffer_store_dwordx4 v[84:87], v57, s[24:27], s50 offen offset:1024 sc1
    s_nop 1
    v_cvt_pk_bf16_f32 v88, v240, v241
    v_cvt_pk_bf16_f32 v89, v242, v243
    v_cvt_pk_bf16_f32 v90, v244, v245
    v_cvt_pk_bf16_f32 v91, v246, v247
    s_nop 1
    v_permlane16_swap_b32 v88, v90
    s_nop 0
    v_permlane16_swap_b32 v89, v91
    buffer_store_dwordx4 v[88:91], v57, s[24:27], s50 offen offset:2048 sc1
    s_nop 1
    v_cvt_pk_bf16_f32 v92, v248, v249
    v_cvt_pk_bf16_f32 v93, v250, v251
    v_cvt_pk_bf16_f32 v94, v252, v253
    v_cvt_pk_bf16_f32 v95, v254, v255
    s_nop 1
    v_permlane16_swap_b32 v92, v94
    s_nop 0
    v_permlane16_swap_b32 v93, v95
    buffer_store_dwordx4 v[92:95], v57, s[24:27], s50 offen offset:3072 sc1
    s_waitcnt vmcnt(8)
    v_accvgpr_read_b32 v32, a224
    v_accvgpr_read_b32 v23, a225
    v_accvgpr_read_b32 v36, a208
    v_accvgpr_read_b32 v37, a209
    v_accvgpr_read_b32 v38, a210
    v_accvgpr_read_b32 v39, a211
    v_accvgpr_read_b32 v40, a212
    v_accvgpr_read_b32 v41, a213
    v_accvgpr_read_b32 v42, a214
    v_accvgpr_read_b32 v43, a215
    v_accvgpr_read_b32 v44, a216
    v_accvgpr_read_b32 v45, a217
    v_accvgpr_read_b32 v46, a218
    v_accvgpr_read_b32 v47, a219
    v_accvgpr_read_b32 v48, a220
    v_accvgpr_read_b32 v49, a221
    v_accvgpr_read_b32 v50, a222
    v_accvgpr_read_b32 v51, a223
    v_and_b32 v26, 0x7ff, v23
    v_sub_u32 v26, 2047, v26
    s_load_dwordx2 s[20:21], s[0:1], 80
    v_and_b32 v27, s100, v23
    v_ashrrev_i32 v28, 31, v27
    v_not_b32 v28, v28
    v_or_b32 v28, 0x80000000, v28
    v_xor_b32 v27, v27, v28
    v_and_b32 v27, s100, v27
    v_mul_f32 v28, 0xbfb8aa3b, v27
    v_exp_f32 v28, v28
    v_and_b32 v34, s100, v32
    v_add_f32 v28, 1.0, v28
    v_rcp_f32 v28, v28
    v_rcp_f32 v34, v34
    v_lshlrev_b32 v30, 16, v32
    v_cvt_pk_bf16_f32 v28, v28, v28
    v_and_b32 v28, s100, v28
    v_sub_f32 v30, 0, v30
    v_lshlrev_b32 v52, 16, v36
    v_and_b32 v53, s100, v36
    v_lshlrev_b32 v54, 16, v37
    v_and_b32 v55, s100, v37
    v_pk_add_f32 v[52:53], v[52:53], v[30:31] op_sel_hi:[1,0]
    v_pk_add_f32 v[54:55], v[54:55], v[30:31] op_sel_hi:[1,0]
    v_cvt_pk_bf16_f32 v36, v52, v53
    v_cvt_pk_bf16_f32 v37, v54, v55
    v_lshlrev_b32 v52, 16, v36
    v_and_b32 v53, s100, v36
    v_lshlrev_b32 v54, 16, v37
    v_and_b32 v55, s100, v37
    v_pk_mul_f32 v[52:53], v[52:53], v[34:35] op_sel_hi:[1,0]
    v_pk_mul_f32 v[54:55], v[54:55], v[34:35] op_sel_hi:[1,0]
    v_cvt_pk_bf16_f32 v36, v52, v53
    v_cvt_pk_bf16_f32 v37, v54, v55
    v_lshlrev_b32 v52, 16, v38
    v_and_b32 v53, s100, v38
    v_lshlrev_b32 v54, 16, v39
    v_and_b32 v55, s100, v39
    v_pk_add_f32 v[52:53], v[52:53], v[30:31] op_sel_hi:[1,0]
    v_pk_add_f32 v[54:55], v[54:55], v[30:31] op_sel_hi:[1,0]
    v_cvt_pk_bf16_f32 v38, v52, v53
    v_cvt_pk_bf16_f32 v39, v54, v55
    v_lshlrev_b32 v52, 16, v38
    v_and_b32 v53, s100, v38
    v_lshlrev_b32 v54, 16, v39
    v_and_b32 v55, s100, v39
    v_pk_mul_f32 v[52:53], v[52:53], v[34:35] op_sel_hi:[1,0]
    v_pk_mul_f32 v[54:55], v[54:55], v[34:35] op_sel_hi:[1,0]
    v_cvt_pk_bf16_f32 v38, v52, v53
    v_cvt_pk_bf16_f32 v39, v54, v55
    v_lshlrev_b32 v52, 16, v40
    v_and_b32 v53, s100, v40
    v_lshlrev_b32 v54, 16, v41
    v_and_b32 v55, s100, v41
    v_pk_add_f32 v[52:53], v[52:53], v[30:31] op_sel_hi:[1,0]
    v_pk_add_f32 v[54:55], v[54:55], v[30:31] op_sel_hi:[1,0]
    v_cvt_pk_bf16_f32 v40, v52, v53
    v_cvt_pk_bf16_f32 v41, v54, v55
    v_lshlrev_b32 v52, 16, v40
    v_and_b32 v53, s100, v40
    v_lshlrev_b32 v54, 16, v41
    v_and_b32 v55, s100, v41
    v_pk_mul_f32 v[52:53], v[52:53], v[34:35] op_sel_hi:[1,0]
    v_pk_mul_f32 v[54:55], v[54:55], v[34:35] op_sel_hi:[1,0]
    v_cvt_pk_bf16_f32 v40, v52, v53
    v_cvt_pk_bf16_f32 v41, v54, v55
    v_lshlrev_b32 v52, 16, v42
    v_and_b32 v53, s100, v42
    v_lshlrev_b32 v54, 16, v43
    v_and_b32 v55, s100, v43
    v_pk_add_f32 v[52:53], v[52:53], v[30:31] op_sel_hi:[1,0]
    v_pk_add_f32 v[54:55], v[54:55], v[30:31] op_sel_hi:[1,0]
    v_cvt_pk_bf16_f32 v42, v52, v53
    v_cvt_pk_bf16_f32 v43, v54, v55
    v_lshlrev_b32 v52, 16, v42
    v_and_b32 v53, s100, v42
    v_lshlrev_b32 v54, 16, v43
    v_and_b32 v55, s100, v43
    v_pk_mul_f32 v[52:53], v[52:53], v[34:35] op_sel_hi:[1,0]
    v_pk_mul_f32 v[54:55], v[54:55], v[34:35] op_sel_hi:[1,0]
    v_cvt_pk_bf16_f32 v42, v52, v53
    v_cvt_pk_bf16_f32 v43, v54, v55
    v_lshlrev_b32 v52, 16, v44
    v_and_b32 v53, s100, v44
    v_lshlrev_b32 v54, 16, v45
    v_and_b32 v55, s100, v45
    v_pk_add_f32 v[52:53], v[52:53], v[30:31] op_sel_hi:[1,0]
    v_pk_add_f32 v[54:55], v[54:55], v[30:31] op_sel_hi:[1,0]
    v_cvt_pk_bf16_f32 v44, v52, v53
    v_cvt_pk_bf16_f32 v45, v54, v55
    v_lshlrev_b32 v52, 16, v44
    v_and_b32 v53, s100, v44
    v_lshlrev_b32 v54, 16, v45
    v_and_b32 v55, s100, v45
    v_pk_mul_f32 v[52:53], v[52:53], v[34:35] op_sel_hi:[1,0]
    v_pk_mul_f32 v[54:55], v[54:55], v[34:35] op_sel_hi:[1,0]
    v_cvt_pk_bf16_f32 v44, v52, v53
    v_cvt_pk_bf16_f32 v45, v54, v55
    v_lshlrev_b32 v52, 16, v46
    v_and_b32 v53, s100, v46
    v_lshlrev_b32 v54, 16, v47
    v_and_b32 v55, s100, v47
    v_pk_add_f32 v[52:53], v[52:53], v[30:31] op_sel_hi:[1,0]
    v_pk_add_f32 v[54:55], v[54:55], v[30:31] op_sel_hi:[1,0]
    v_cvt_pk_bf16_f32 v46, v52, v53
    v_cvt_pk_bf16_f32 v47, v54, v55
    v_lshlrev_b32 v52, 16, v46
    v_and_b32 v53, s100, v46
    v_lshlrev_b32 v54, 16, v47
    v_and_b32 v55, s100, v47
    v_pk_mul_f32 v[52:53], v[52:53], v[34:35] op_sel_hi:[1,0]
    v_pk_mul_f32 v[54:55], v[54:55], v[34:35] op_sel_hi:[1,0]
    v_cvt_pk_bf16_f32 v46, v52, v53
    v_cvt_pk_bf16_f32 v47, v54, v55
    v_lshlrev_b32 v52, 16, v48
    v_and_b32 v53, s100, v48
    v_lshlrev_b32 v54, 16, v49
    v_and_b32 v55, s100, v49
    v_pk_add_f32 v[52:53], v[52:53], v[30:31] op_sel_hi:[1,0]
    v_pk_add_f32 v[54:55], v[54:55], v[30:31] op_sel_hi:[1,0]
    v_cvt_pk_bf16_f32 v48, v52, v53
    v_cvt_pk_bf16_f32 v49, v54, v55
    v_lshlrev_b32 v52, 16, v48
    v_and_b32 v53, s100, v48
    v_lshlrev_b32 v54, 16, v49
    v_and_b32 v55, s100, v49
    v_pk_mul_f32 v[52:53], v[52:53], v[34:35] op_sel_hi:[1,0]
    v_pk_mul_f32 v[54:55], v[54:55], v[34:35] op_sel_hi:[1,0]
    v_cvt_pk_bf16_f32 v48, v52, v53
    v_cvt_pk_bf16_f32 v49, v54, v55
    v_lshlrev_b32 v52, 16, v50
    v_and_b32 v53, s100, v50
    v_lshlrev_b32 v54, 16, v51
    v_and_b32 v55, s100, v51
    v_pk_add_f32 v[52:53], v[52:53], v[30:31] op_sel_hi:[1,0]
    v_pk_add_f32 v[54:55], v[54:55], v[30:31] op_sel_hi:[1,0]
    v_cvt_pk_bf16_f32 v50, v52, v53
    v_cvt_pk_bf16_f32 v51, v54, v55
    v_lshlrev_b32 v52, 16, v50
    v_and_b32 v53, s100, v50
    v_lshlrev_b32 v54, 16, v51
    v_and_b32 v55, s100, v51
    v_pk_mul_f32 v[52:53], v[52:53], v[34:35] op_sel_hi:[1,0]
    v_pk_mul_f32 v[54:55], v[54:55], v[34:35] op_sel_hi:[1,0]
    v_cvt_pk_bf16_f32 v50, v52, v53
    v_cvt_pk_bf16_f32 v51, v54, v55
    s_mov_b32 s42, 16777216
    s_mov_b32 s43, 16785408
    s_cmp_eq_u32 s99, 0
    s_cbranch_scc1 L_moe_slow
L_moe_lndone:
    s_cmp_ge_u32 s2, 224
    s_cbranch_scc1 L_fin_sync
    s_nop 0
    v_mfma_f32_16x16x32_bf16 v[56:59], a[96:99], v[36:39], 0
    v_mfma_f32_16x16x32_bf16 v[56:59], a[100:103], v[40:43], v[56:59]
    v_mfma_f32_16x16x32_bf16 v[56:59], a[104:107], v[44:47], v[56:59]
    v_mfma_f32_16x16x32_bf16 v[56:59], a[108:111], v[48:51], v[56:59]
    v_accvgpr_write_b32 a128, 0
    v_accvgpr_write_b32 a129, 0
    v_lshlrev_b32 v60, 4, v0
    v_add_u32 v61, s40, v60
    v_add_u32 v60, 67584, v60
    v_add_u32 v62, 49152, v60
    v_add_u32 v63, 73728, v60
    v_mov_b32 v82, 0
    v_mov_b32 v83, 0
    s_lshl_b32 s44, s33, 3
    s_add_u32 s45, s44, s32
    s_lshl_b32 s45, s45, 2
    s_add_u32 s45, s45, 16809984
    s_cmp_eq_u32 s34, 0
    s_cselect_b32 s45, s45, 0x7fff0000
    v_lshlrev_b32 v24, 10, v0
    v_add_u32 v24, s45, v24
    v_mov_b32 v25, 0x7fff0000
    v_cmp_gt_u32 vcc, 1, v0
    s_nop 1
    v_cndmask_b32 v24, v25, v24, vcc
    v_mov_b32 v25, 1
    s_waitcnt vmcnt(8)
    ds_write_b128 v61, v[56:59] offset:2048
    v_add_u32 v61, 24576, v60
    s_waitcnt lgkmcnt(0)
    s_barrier
    ds_read_b128 v[64:67], v60
    ds_read_b128 v[68:71], v61
    ds_read_b128 v[72:75], v62
    ds_read_b128 v[76:79], v63
    buffer_store_dword v25, v24, s[24:27], 0 offen sc1
    v_cmp_gt_u32 vcc, 32, v0
    s_waitcnt lgkmcnt(0)
    v_add_f32 v64, v64, v68
    v_add_f32 v65, v65, v69
    v_add_f32 v66, v66, v70
    v_add_f32 v67, v67, v71
    v_add_f32 v72, v72, v76
    v_add_f32 v73, v73, v77
    v_add_f32 v74, v74, v78
    v_add_f32 v75, v75, v79
    v_add_f32 v64, v64, v72
    v_add_f32 v65, v65, v73
    v_add_f32 v66, v66, v74
    v_add_f32 v67, v67, v75
    v_cvt_pk_bf16_f32 v72, v64, v65
    v_cvt_pk_bf16_f32 v73, v66, v67
    v_mov_b32 v74, v72
    v_mov_b32 v75, v73
    s_nop 0
    v_permlane32_swap_b32 v72, v74
    v_permlane32_swap_b32 v73, v75
    v_lshlrev_b32 v64, 16, v72
    v_and_b32 v65, s100, v72
    v_lshlrev_b32 v68, 16, v74
    v_and_b32 v69, s100, v74
    v_lshlrev_b32 v66, 16, v73
    v_and_b32 v67, s100, v73
    v_lshlrev_b32 v70, 16, v75
    v_and_b32 v71, s100, v75
    v_mul_f32 v76, 0xbfb8aa3b, v64
    v_mul_f32 v77, 0xbfb8aa3b, v65
    v_mul_f32 v78, 0xbfb8aa3b, v66
    v_mul_f32 v79, 0xbfb8aa3b, v67
    v_exp_f32 v76, v76
    v_exp_f32 v77, v77
    v_exp_f32 v78, v78
    v_exp_f32 v79, v79
    v_add_f32 v76, 1.0, v76
    v_add_f32 v77, 1.0, v77
    v_add_f32 v78, 1.0, v78
    v_add_f32 v79, 1.0, v79
    v_rcp_f32 v76, v76
    v_rcp_f32 v77, v77
    v_rcp_f32 v78, v78
    v_rcp_f32 v79, v79
    v_mul_f32 v76, v64, v76
    v_mul_f32 v77, v65, v77
    v_mul_f32 v78, v66, v78
    v_mul_f32 v79, v67, v79
    v_cvt_pk_bf16_f32 v72, v76, v77
    v_cvt_pk_bf16_f32 v73, v78, v79
    v_lshlrev_b32 v76, 16, v72
    v_and_b32 v77, s100, v72
    v_lshlrev_b32 v78, 16, v73
    v_and_b32 v79, s100, v73
    v_mul_f32 v76, v76, v68
    v_mul_f32 v77, v77, v69
    v_mul_f32 v78, v78, v70
    v_mul_f32 v79, v79, v71
    v_cvt_pk_bf16_f32 v80, v76, v77
    v_cvt_pk_bf16_f32 v81, v78, v79
    s_nop 0
    v_cndmask_b32 v80, 0, v80, vcc
    v_cndmask_b32 v81, 0, v81, vcc
    s_nop 1
    v_mfma_f32_16x16x32_bf16 v[120:123], a[112:115], v[80:83], 0
    v_mfma_f32_16x16x32_bf16 v[124:127], a[114:117], v[80:83], 0
    v_mfma_f32_16x16x32_bf16 v[128:131], a[116:119], v[80:83], 0
    v_mfma_f32_16x16x32_bf16 v[132:135], a[118:121], v[80:83], 0
    v_mfma_f32_16x16x32_bf16 v[136:139], a[120:123], v[80:83], 0
    v_mfma_f32_16x16x32_bf16 v[140:143], a[122:125], v[80:83], 0
    v_mfma_f32_16x16x32_bf16 v[144:147], a[124:127], v[80:83], 0
    v_mfma_f32_16x16x32_bf16 v[148:151], a[126:129], v[80:83], 0
    s_nop 3
    v_cvt_pk_bf16_f32 v120, v120, v121
    v_cvt_pk_bf16_f32 v121, v122, v123
    v_cvt_pk_bf16_f32 v122, v124, v125
    v_cvt_pk_bf16_f32 v123, v126, v127
    v_cvt_pk_bf16_f32 v128, v128, v129
    v_cvt_pk_bf16_f32 v129, v130, v131
    v_cvt_pk_bf16_f32 v130, v132, v133
    v_cvt_pk_bf16_f32 v131, v134, v135
    v_cvt_pk_bf16_f32 v136, v136, v137
    v_cvt_pk_bf16_f32 v137, v138, v139
    v_cvt_pk_bf16_f32 v138, v140, v141
    v_cvt_pk_bf16_f32 v139, v142, v143
    v_cvt_pk_bf16_f32 v144, v144, v145
    v_cvt_pk_bf16_f32 v145, v146, v147
    v_cvt_pk_bf16_f32 v146, v148, v149
    v_cvt_pk_bf16_f32 v147, v150, v151
    s_lshl_b32 s44, s98, 13
    s_lshl_b32 s45, s34, 11
    s_add_u32 s44, s44, s45
    s_add_u32 s44, s44, 17825792
    v_and_b32 v60, 15, v0
    v_lshlrev_b32 v61, 6, v60
    v_lshrrev_b32 v62, 4, v0
    v_lshl_add_u32 v61, v62, 4, v61
    v_add_u32 v61, s44, v61
    v_mov_b32 v63, 0x1ffffff0
    v_cmp_gt_u32 vcc, 8, v60
    s_nop 1
    v_cndmask_b32 v61, v63, v61, vcc
    buffer_store_dwordx4 v[120:123], v61, s[24:27], 0 offen offset:0 sc1
    buffer_store_dwordx4 v[128:131], v61, s[24:27], 0 offen offset:512 sc1
    buffer_store_dwordx4 v[136:139], v61, s[24:27], 0 offen offset:1024 sc1
    buffer_store_dwordx4 v[144:147], v61, s[24:27], 0 offen offset:1536 sc1
L_fin_sync:
    v_mov_b32 v60, 86528
    v_mov_b32 v62, 0
    v_mov_b32 v63, 0
    ds_write_b64 v60, v[62:63]
    s_lshl_b32 s44, s33, 3
    s_add_u32 s45, s44, s32
    s_lshl_b32 s45, s45, 2
    s_add_u32 s45, s45, 16809984
    s_cmp_eq_u32 s34, 0
    s_cselect_b32 s45, s45, 0x7fff0000
    v_lshlrev_b32 v24, 10, v0
    v_add_u32 v24, s45, v24
    v_mov_b32 v25, 0x7fff0000
    v_cmp_gt_u32 vcc, 9, v0
    s_nop 1
    v_cndmask_b32 v24, v25, v24, vcc
    v_mov_b32 v25, 1
    s_waitcnt vmcnt(0) lgkmcnt(0)
    s_barrier
    buffer_store_dword v25, v24, s[24:27], 0 offen sc1
    s_mov_b32 s22, 2097152
    s_mov_b32 s23, 0x20000
    v_readlane_b32 s8, v26, 0
    v_readlane_b32 s9, v26, 1
    v_readlane_b32 s10, v26, 2
    v_readlane_b32 s11, v26, 3
    v_readlane_b32 s12, v26, 4
    v_readlane_b32 s13, v26, 5
    v_readlane_b32 s14, v26, 6
    v_readlane_b32 s15, v26, 7
    s_mov_b32 s16, 0x00003f80
    s_mov_b32 s17, 0x3f800000
    s_mov_b32 s18, 0xbfb8aa3b
    s_mov_b32 s19, 0xbfb8aa3b
    s_mov_b32 s48, 1.0
    s_mov_b32 s49, 1.0
    s_mov_b32 s52, 0
    s_mov_b32 s53, 2097152
    s_mov_b32 s54, 4194304
    s_mov_b32 s55, 6291456
    s_mov_b32 s56, 8388608
    s_mov_b32 s57, 10485760
    s_mov_b32 s58, 12582912
    s_mov_b32 s59, 14680064
    s_lshl_b32 s44, s33, 6
    s_lshl_b32 s45, s32, 3
    s_add_u32 s44, s44, s45
    v_and_b32 v2, 7, v0
    v_add_u32 v3, s44, v2
    v_lshrrev_b32 v4, 3, v0
    v_lshlrev_b32 v4, 4, v4
    v_lshl_add_u32 v4, v3, 10, v4
    s_lshl_b32 s45, s34, 8
    v_add_u32 v4, s45, v4
    v_lshlrev_b32 v7, 2, v3
    v_add_u32 v7, 16785408, v7
    s_lshl_b32 s44, s33, 16
    s_lshl_b32 s45, s34, 14
    s_add_u32 s44, s44, s45
    s_lshr_b32 s45, s32, 2
    s_lshl_b32 s45, s45, 10
    s_add_u32 s44, s44, s45
    s_and_b32 s45, s32, 3
    s_lshl_b32 s45, s45, 7
    s_add_u32 s44, s44, s45
    v_lshrrev_b32 v5, 4, v0
    v_lshlrev_b32 v5, 11, v5
    v_bfe_u32 v6, v0, 3, 1
    v_lshl_add_u32 v5, v6, 9, v5
    v_lshl_add_u32 v5, v2, 4, v5
    v_add_u32 v5, s44, v5
    v_add_u32 v6, 8192, v5
    s_lshl_b32 s44, s33, 5
    s_add_u32 s44, s44, 16809984
    s_lshr_b32 s45, s2, 3
    s_and_b32 s45, s45, 7
    s_add_u32 s45, s45, 1
    s_lshl_b32 s51, s45, 10
    s_lshr_b32 s45, s34, 1
    s_mul_i32 s50, s45, s51
    s_add_u32 s44, s44, s50
    v_lshlrev_b32 v8, 2, v2
    v_add_u32 v8, s44, v8
    v_lshlrev_b32 v9, 4, v0
    v_add_u32 v9, s51, v9
    v_add_u32 v9, 16809984, v9
    s_lshl_b32 s45, s45, 2
    s_add_u32 s45, s45, 86528
    v_mov_b32 v11, s45
    buffer_load_dwordx4 v[12:15], v4, s[4:7], 0 offen
    buffer_load_dwordx4 v[16:19], v4, s[4:7], 0 offen offset:128
    s_mov_b32 s45, 200000
    s_bitcmp1_b32 s34, 0
    s_cbranch_scc1 L_fin_watch
    s_cmp_eq_u32 s34, 0
    s_cbranch_scc1 L_fin_poll
    s_cmp_lt_u32 s2, 128
    s_cbranch_scc1 L_fin_pollall
L_fin_poll:
    buffer_load_dword v20, v8, s[24:27], 0 offen sc1
    s_waitcnt vmcnt(0)
    v_cmp_eq_u32 vcc, 1, v20
    s_sub_u32 s45, s45, 1
    s_cmp_eq_u32 s45, 0
    s_cbranch_scc1 L_fin_set
    s_cmp_eq_u64 vcc, -1
    s_cbranch_scc1 L_fin_set
    s_sleep 1
    s_branch L_fin_poll
L_fin_pollall:
    buffer_load_dwordx4 v[20:23], v9, s[24:27], 0 offen sc1
    s_waitcnt vmcnt(0)
    v_and_b32 v20, v20, v21
    v_and_b32 v22, v22, v23
    v_and_b32 v20, v20, v22
    v_cmp_eq_u32 vcc, 1, v20
    s_sub_u32 s45, s45, 1
    s_cmp_eq_u32 s45, 0
    s_cbranch_scc1 L_fin_set
    s_cmp_eq_u64 vcc, -1
    s_cbranch_scc1 L_fin_set
    s_sleep 1
    s_branch L_fin_pollall
L_fin_set:
    v_mov_b32 v20, 1
    ds_write_b32 v11, v20
    s_branch L_fin_go
L_fin_watch:
    s_lshl_b32 s45, s45, 4
L_fin_watch_loop:
    ds_read_b32 v20, v11
    s_waitcnt lgkmcnt(0)
    v_readfirstlane_b32 s44, v20
    s_sub_u32 s45, s45, 1
    s_cmp_eq_u32 s45, 0
    s_cbranch_scc1 L_fin_go
    s_cmp_eq_u32 s44, 1
    s_cbranch_scc0 L_fin_watch_loop
L_fin_go:
    buffer_load_dword v10, v7, s[24:27], 0 offen sc1
    buffer_load_dwordx4 v[64:67], v5, s[24:27], s52 offen sc1
    buffer_load_dwordx4 v[68:71], v5, s[24:27], s53 offen sc1
    buffer_load_dwordx4 v[72:75], v5, s[24:27], s54 offen sc1
    buffer_load_dwordx4 v[76:79], v5, s[24:27], s55 offen sc1
    buffer_load_dwordx4 v[80:83], v5, s[24:27], s56 offen sc1
    buffer_load_dwordx4 v[84:87], v5, s[24:27], s57 offen sc1
    buffer_load_dwordx4 v[88:91], v5, s[24:27], s58 offen sc1
    buffer_load_dwordx4 v[92:95], v5, s[24:27], s59 offen sc1
    buffer_load_dwordx4 v[96:99], v6, s[24:27], s52 offen sc1
    buffer_load_dwordx4 v[100:103], v6, s[24:27], s53 offen sc1
    buffer_load_dwordx4 v[104:107], v6, s[24:27], s54 offen sc1
    buffer_load_dwordx4 v[108:111], v6, s[24:27], s55 offen sc1
    buffer_load_dwordx4 v[112:115], v6, s[24:27], s56 offen sc1
    buffer_load_dwordx4 v[116:119], v6, s[24:27], s57 offen sc1
    buffer_load_dwordx4 v[120:123], v6, s[24:27], s58 offen sc1
    buffer_load_dwordx4 v[124:127], v6, s[24:27], s59 offen sc1
    s_cmp_lt_u32 s34, 2
    s_cbranch_scc1 L_fin_nosel1
    s_cmp_ge_u32 s2, 128
    s_cbranch_scc1 L_fin_nosel1
    s_lshr_b32 s50, s2, 4
    s_and_b32 s51, s2, 15
    s_and_b32 s70, s34, 1
    v_readlane_b32 s46, v26, s50
    v_readlane_b32 s47, v28, s50
    s_lshl_b32 s44, s51, 9
    s_lshl_b32 s45, s50, 6
    s_add_u32 s44, s44, s45
    s_lshl_b32 s45, s70, 3
    s_add_u32 s44, s44, s45
    s_add_u32 s44, s44, 17825792
    v_lshrrev_b32 v24, 2, v0
    v_lshlrev_b32 v24, 13, v24
    v_and_b32 v25, 3, v0
    v_lshl_add_u32 v24, v25, 4, v24
    v_add_u32 v24, s44, v24
    s_lshr_b32 s44, s46, 6
    s_lshl_b32 s44, s44, 16
    s_lshl_b32 s45, s51, 12
    s_add_u32 s44, s44, s45
    s_lshl_b32 s45, s70, 11
    s_add_u32 s44, s44, s45
    s_bfe_u32 s45, s46, 65541
    s_lshl_b32 s45, s45, 10
    s_add_u32 s44, s44, s45
    s_and_b32 s45, s46, 31
    s_lshl_b32 s45, s45, 4
    s_add_u32 s44, s44, s45
    v_lshrrev_b32 v27, 1, v25
    v_lshlrev_b32 v27, 9, v27
    v_and_b32 v29, 1, v25
    v_lshl_add_u32 v27, v29, 3, v27
    v_add_u32 v27, s44, v27
    s_lshl_b32 s44, s46, 10
    s_lshl_b32 s45, s51, 6
    s_add_u32 s44, s44, s45
    s_lshl_b32 s45, s70, 5
    s_add_u32 s44, s44, s45
    v_lshlrev_b32 v29, 3, v25
    v_add_u32 v29, s44, v29
    s_lshl_b32 s44, s46, 2
    s_add_u32 s44, s44, 16785408
    v_mov_b32 v30, s44
    s_mov_b32 s44, 0
    buffer_load_dwordx2 v[180:181], v24, s[24:27], s44 offen sc1
    s_add_u32 s44, s44, 131072
    buffer_load_dwordx2 v[182:183], v24, s[24:27], s44 offen sc1
    s_add_u32 s44, s44, 131072
    buffer_load_dwordx2 v[184:185], v24, s[24:27], s44 offen sc1
    s_add_u32 s44, s44, 131072
    buffer_load_dwordx2 v[186:187], v24, s[24:27], s44 offen sc1
    s_add_u32 s44, s44, 131072
    buffer_load_dwordx2 v[188:189], v24, s[24:27], s44 offen sc1
    s_add_u32 s44, s44, 131072
    buffer_load_dwordx2 v[190:191], v24, s[24:27], s44 offen sc1
    s_add_u32 s44, s44, 131072
    buffer_load_dwordx2 v[192:193], v24, s[24:27], s44 offen sc1
    s_add_u32 s44, s44, 131072
    buffer_load_dwordx2 v[194:195], v24, s[24:27], s44 offen sc1
    s_add_u32 s44, s44, 131072
    buffer_load_dwordx2 v[196:197], v24, s[24:27], s44 offen sc1
    s_add_u32 s44, s44, 131072
    buffer_load_dwordx2 v[198:199], v24, s[24:27], s44 offen sc1
    s_add_u32 s44, s44, 131072
    buffer_load_dwordx2 v[200:201], v24, s[24:27], s44 offen sc1
    s_add_u32 s44, s44, 131072
    buffer_load_dwordx2 v[202:203], v24, s[24:27], s44 offen sc1
    s_add_u32 s44, s44, 131072
    buffer_load_dwordx2 v[204:205], v24, s[24:27], s44 offen sc1
    s_add_u32 s44, s44, 131072
    buffer_load_dwordx2 v[206:207], v24, s[24:27], s44 offen sc1
    s_add_u32 s44, s44, 131072
    buffer_load_dwordx2 v[160:161], v27, s[24:27], s52 offen sc1
    buffer_load_dwordx2 v[162:163], v27, s[24:27], s53 offen sc1
    buffer_load_dwordx2 v[164:165], v27, s[24:27], s54 offen sc1
    buffer_load_dwordx2 v[166:167], v27, s[24:27], s55 offen sc1
    buffer_load_dwordx2 v[168:169], v27, s[24:27], s56 offen sc1
    buffer_load_dwordx2 v[170:171], v27, s[24:27], s57 offen sc1
    buffer_load_dwordx2 v[172:173], v27, s[24:27], s58 offen sc1
    buffer_load_dwordx2 v[174:175], v27, s[24:27], s59 offen sc1
    buffer_load_dwordx2 v[176:177], v29, s[4:7], 0 offen
    buffer_load_dword v178, v30, s[24:27], 0 offen sc1
L_fin_nosel1:
    v_cmp_ne_u32 s[60:61], s8, v3
    v_cmp_ne_u32 s[62:63], s9, v3
    v_cmp_ne_u32 s[64:65], s10, v3
    v_cmp_ne_u32 s[66:67], s11, v3
    s_nop 0
    s_and_b64 s[60:61], s[60:61], s[62:63]
    s_and_b64 s[64:65], s[64:65], s[66:67]
    s_and_b64 s[68:69], s[60:61], s[64:65]
    v_cmp_ne_u32 s[60:61], s12, v3
    v_cmp_ne_u32 s[62:63], s13, v3
    v_cmp_ne_u32 s[64:65], s14, v3
    v_cmp_ne_u32 s[66:67], s15, v3
    s_nop 0
    s_and_b64 s[60:61], s[60:61], s[62:63]
    s_and_b64 s[64:65], s[64:65], s[66:67]
    s_and_b64 s[60:61], s[60:61], s[64:65]
    s_and_b64 s[68:69], s[68:69], s[60:61]
    s_cmp_lt_u32 s34, 2
    s_cbranch_scc1 L_fin_plain
    s_cmp_lt_u32 s2, 128
    s_cbranch_scc1 L_fin_withsel
L_fin_plain:
    s_waitcnt vmcnt(16)
    v_mov_b32 v31, 0x7ffffff0
    v_cndmask_b32 v32, v31, v4, s[68:69]
    v_and_b32 v34, s100, v10
    v_rcp_f32 v34, v34
    v_lshlrev_b32 v33, 16, v10
    v_mul_f32 v30, v33, v34
    v_sub_f32 v36, 0, v30
    s_waitcnt vmcnt(15)
    v_dot2_f32_bf16 v40, v64, s16, 0
    v_dot2_f32_bf16 v41, v64, s17, 0
    v_dot2_f32_bf16 v42, v65, s16, 0
    v_dot2_f32_bf16 v43, v65, s17, 0
    v_dot2_f32_bf16 v44, v66, s16, 0
    v_dot2_f32_bf16 v45, v66, s17, 0
    v_dot2_f32_bf16 v46, v67, s16, 0
    v_dot2_f32_bf16 v47, v67, s17, 0
    s_waitcnt vmcnt(14)
    v_dot2_f32_bf16 v40, v68, s16, v40
    v_dot2_f32_bf16 v41, v68, s17, v41
    v_dot2_f32_bf16 v42, v69, s16, v42
    v_dot2_f32_bf16 v43, v69, s17, v43
    v_dot2_f32_bf16 v44, v70, s16, v44
    v_dot2_f32_bf16 v45, v70, s17, v45
    v_dot2_f32_bf16 v46, v71, s16, v46
    v_dot2_f32_bf16 v47, v71, s17, v47
    s_waitcnt vmcnt(13)
    v_dot2_f32_bf16 v40, v72, s16, v40
    v_dot2_f32_bf16 v41, v72, s17, v41
    v_dot2_f32_bf16 v42, v73, s16, v42
    v_dot2_f32_bf16 v43, v73, s17, v43
    v_dot2_f32_bf16 v44, v74, s16, v44
    v_dot2_f32_bf16 v45, v74, s17, v45
    v_dot2_f32_bf16 v46, v75, s16, v46
    v_dot2_f32_bf16 v47, v75, s17, v47
    s_waitcnt vmcnt(12)
    v_dot2_f32_bf16 v40, v76, s16, v40
    v_dot2_f32_bf16 v41, v76, s17, v41
    v_dot2_f32_bf16 v42, v77, s16, v42
    v_dot2_f32_bf16 v43, v77, s17, v43
    v_dot2_f32_bf16 v44, v78, s16, v44
    v_dot2_f32_bf16 v45, v78, s17, v45
    v_dot2_f32_bf16 v46, v79, s16, v46
    v_dot2_f32_bf16 v47, v79, s17, v47
    s_waitcnt vmcnt(11)
    v_dot2_f32_bf16 v40, v80, s16, v40
    v_dot2_f32_bf16 v41, v80, s17, v41
    v_dot2_f32_bf16 v42, v81, s16, v42
    v_dot2_f32_bf16 v43, v81, s17, v43
    v_dot2_f32_bf16 v44, v82, s16, v44
    v_dot2_f32_bf16 v45, v82, s17, v45
    v_dot2_f32_bf16 v46, v83, s16, v46
    v_dot2_f32_bf16 v47, v83, s17, v47
    s_waitcnt vmcnt(10)
    v_dot2_f32_bf16 v40, v84, s16, v40
    v_dot2_f32_bf16 v41, v84, s17, v41
    v_dot2_f32_bf16 v42, v85, s16, v42
    v_dot2_f32_bf16 v43, v85, s17, v43
    v_dot2_f32_bf16 v44, v86, s16, v44
    v_dot2_f32_bf16 v45, v86, s17, v45
    v_dot2_f32_bf16 v46, v87, s16, v46
    v_dot2_f32_bf16 v47, v87, s17, v47
    s_waitcnt vmcnt(9)
    v_dot2_f32_bf16 v40, v88, s16, v40
    v_dot2_f32_bf16 v41, v88, s17, v41
    v_dot2_f32_bf16 v42, v89, s16, v42
    v_dot2_f32_bf16 v43, v89, s17, v43
    v_dot2_f32_bf16 v44, v90, s16, v44
    v_dot2_f32_bf16 v45, v90, s17, v45
    v_dot2_f32_bf16 v46, v91, s16, v46
    v_dot2_f32_bf16 v47, v91, s17, v47
    s_waitcnt vmcnt(8)
    v_dot2_f32_bf16 v40, v92, s16, v40
    v_dot2_f32_bf16 v41, v92, s17, v41
    v_dot2_f32_bf16 v42, v93, s16, v42
    v_dot2_f32_bf16 v43, v93, s17, v43
    v_dot2_f32_bf16 v44, v94, s16, v44
    v_dot2_f32_bf16 v45, v94, s17, v45
    v_dot2_f32_bf16 v46, v95, s16, v46
    v_dot2_f32_bf16 v47, v95, s17, v47
    v_lshlrev_b32 v48, 16, v12
    v_and_b32 v49, s100, v12
    v_lshlrev_b32 v50, 16, v13
    v_and_b32 v51, s100, v13
    v_lshlrev_b32 v52, 16, v14
    v_and_b32 v53, s100, v14
    v_lshlrev_b32 v54, 16, v15
    v_and_b32 v55, s100, v15
    v_pk_fma_f32 v[56:57], v[48:49], v[34:35], v[36:37] op_sel_hi:[1,0,0]
    v_pk_fma_f32 v[58:59], v[50:51], v[34:35], v[36:37] op_sel_hi:[1,0,0]
    v_pk_fma_f32 v[60:61], v[52:53], v[34:35], v[36:37] op_sel_hi:[1,0,0]
    v_pk_fma_f32 v[62:63], v[54:55], v[34:35], v[36:37] op_sel_hi:[1,0,0]
    v_pk_mul_f32 v[64:65], v[56:57], s[18:19]
    v_pk_mul_f32 v[66:67], v[58:59], s[18:19]
    v_pk_mul_f32 v[68:69], v[60:61], s[18:19]
    v_pk_mul_f32 v[70:71], v[62:63], s[18:19]
    v_exp_f32 v64, v64
    v_exp_f32 v65, v65
    v_exp_f32 v66, v66
    v_exp_f32 v67, v67
    v_exp_f32 v68, v68
    v_exp_f32 v69, v69
    v_exp_f32 v70, v70
    v_exp_f32 v71, v71
    v_pk_add_f32 v[64:65], v[64:65], s[48:49]
    v_pk_add_f32 v[66:67], v[66:67], s[48:49]
    v_pk_add_f32 v[68:69], v[68:69], s[48:49]
    v_pk_add_f32 v[70:71], v[70:71], s[48:49]
    v_rcp_f32 v64, v64
    v_rcp_f32 v65, v65
    v_rcp_f32 v66, v66
    v_rcp_f32 v67, v67
    v_rcp_f32 v68, v68
    v_rcp_f32 v69, v69
    v_rcp_f32 v70, v70
    v_rcp_f32 v71, v71
    v_pk_mul_f32 v[56:57], v[56:57], v[64:65]
    v_pk_mul_f32 v[58:59], v[58:59], v[66:67]
    v_pk_mul_f32 v[60:61], v[60:61], v[68:69]
    v_pk_mul_f32 v[62:63], v[62:63], v[70:71]
    v_pk_fma_f32 v[48:49], v[40:41], v[56:57], v[48:49]
    v_pk_fma_f32 v[50:51], v[42:43], v[58:59], v[50:51]
    v_pk_fma_f32 v[52:53], v[44:45], v[60:61], v[52:53]
    v_pk_fma_f32 v[54:55], v[46:47], v[62:63], v[54:55]
    v_cvt_pk_bf16_f32 v72, v48, v49
    v_cvt_pk_bf16_f32 v73, v50, v51
    v_cvt_pk_bf16_f32 v74, v52, v53
    v_cvt_pk_bf16_f32 v75, v54, v55
    buffer_store_dwordx4 v[72:75], v32, s[20:23], 0 offen offset:0
    s_waitcnt vmcnt(8)
    v_dot2_f32_bf16 v40, v96, s16, 0
    v_dot2_f32_bf16 v41, v96, s17, 0
    v_dot2_f32_bf16 v42, v97, s16, 0
    v_dot2_f32_bf16 v43, v97, s17, 0
    v_dot2_f32_bf16 v44, v98, s16, 0
    v_dot2_f32_bf16 v45, v98, s17, 0
    v_dot2_f32_bf16 v46, v99, s16, 0
    v_dot2_f32_bf16 v47, v99, s17, 0
    s_waitcnt vmcnt(7)
    v_dot2_f32_bf16 v40, v100, s16, v40
    v_dot2_f32_bf16 v41, v100, s17, v41
    v_dot2_f32_bf16 v42, v101, s16, v42
    v_dot2_f32_bf16 v43, v101, s17, v43
    v_dot2_f32_bf16 v44, v102, s16, v44
    v_dot2_f32_bf16 v45, v102, s17, v45
    v_dot2_f32_bf16 v46, v103, s16, v46
    v_dot2_f32_bf16 v47, v103, s17, v47
    s_waitcnt vmcnt(6)
    v_dot2_f32_bf16 v40, v104, s16, v40
    v_dot2_f32_bf16 v41, v104, s17, v41
    v_dot2_f32_bf16 v42, v105, s16, v42
    v_dot2_f32_bf16 v43, v105, s17, v43
    v_dot2_f32_bf16 v44, v106, s16, v44
    v_dot2_f32_bf16 v45, v106, s17, v45
    v_dot2_f32_bf16 v46, v107, s16, v46
    v_dot2_f32_bf16 v47, v107, s17, v47
    s_waitcnt vmcnt(5)
    v_dot2_f32_bf16 v40, v108, s16, v40
    v_dot2_f32_bf16 v41, v108, s17, v41
    v_dot2_f32_bf16 v42, v109, s16, v42
    v_dot2_f32_bf16 v43, v109, s17, v43
    v_dot2_f32_bf16 v44, v110, s16, v44
    v_dot2_f32_bf16 v45, v110, s17, v45
    v_dot2_f32_bf16 v46, v111, s16, v46
    v_dot2_f32_bf16 v47, v111, s17, v47
    s_waitcnt vmcnt(4)
    v_dot2_f32_bf16 v40, v112, s16, v40
    v_dot2_f32_bf16 v41, v112, s17, v41
    v_dot2_f32_bf16 v42, v113, s16, v42
    v_dot2_f32_bf16 v43, v113, s17, v43
    v_dot2_f32_bf16 v44, v114, s16, v44
    v_dot2_f32_bf16 v45, v114, s17, v45
    v_dot2_f32_bf16 v46, v115, s16, v46
    v_dot2_f32_bf16 v47, v115, s17, v47
    s_waitcnt vmcnt(3)
    v_dot2_f32_bf16 v40, v116, s16, v40
    v_dot2_f32_bf16 v41, v116, s17, v41
    v_dot2_f32_bf16 v42, v117, s16, v42
    v_dot2_f32_bf16 v43, v117, s17, v43
    v_dot2_f32_bf16 v44, v118, s16, v44
    v_dot2_f32_bf16 v45, v118, s17, v45
    v_dot2_f32_bf16 v46, v119, s16, v46
    v_dot2_f32_bf16 v47, v119, s17, v47
    s_waitcnt vmcnt(2)
    v_dot2_f32_bf16 v40, v120, s16, v40
    v_dot2_f32_bf16 v41, v120, s17, v41
    v_dot2_f32_bf16 v42, v121, s16, v42
    v_dot2_f32_bf16 v43, v121, s17, v43
    v_dot2_f32_bf16 v44, v122, s16, v44
    v_dot2_f32_bf16 v45, v122, s17, v45
    v_dot2_f32_bf16 v46, v123, s16, v46
    v_dot2_f32_bf16 v47, v123, s17, v47
    s_waitcnt vmcnt(1)
    v_dot2_f32_bf16 v40, v124, s16, v40
    v_dot2_f32_bf16 v41, v124, s17, v41
    v_dot2_f32_bf16 v42, v125, s16, v42
    v_dot2_f32_bf16 v43, v125, s17, v43
    v_dot2_f32_bf16 v44, v126, s16, v44
    v_dot2_f32_bf16 v45, v126, s17, v45
    v_dot2_f32_bf16 v46, v127, s16, v46
    v_dot2_f32_bf16 v47, v127, s17, v47
    v_lshlrev_b32 v48, 16, v16
    v_and_b32 v49, s100, v16
    v_lshlrev_b32 v50, 16, v17
    v_and_b32 v51, s100, v17
    v_lshlrev_b32 v52, 16, v18
    v_and_b32 v53, s100, v18
    v_lshlrev_b32 v54, 16, v19
    v_and_b32 v55, s100, v19
    v_pk_fma_f32 v[56:57], v[48:49], v[34:35], v[36:37] op_sel_hi:[1,0,0]
    v_pk_fma_f32 v[58:59], v[50:51], v[34:35], v[36:37] op_sel_hi:[1,0,0]
    v_pk_fma_f32 v[60:61], v[52:53], v[34:35], v[36:37] op_sel_hi:[1,0,0]
    v_pk_fma_f32 v[62:63], v[54:55], v[34:35], v[36:37] op_sel_hi:[1,0,0]
    v_pk_mul_f32 v[96:97], v[56:57], s[18:19]
    v_pk_mul_f32 v[98:99], v[58:59], s[18:19]
    v_pk_mul_f32 v[100:101], v[60:61], s[18:19]
    v_pk_mul_f32 v[102:103], v[62:63], s[18:19]
    v_exp_f32 v96, v96
    v_exp_f32 v97, v97
    v_exp_f32 v98, v98
    v_exp_f32 v99, v99
    v_exp_f32 v100, v100
    v_exp_f32 v101, v101
    v_exp_f32 v102, v102
    v_exp_f32 v103, v103
    v_pk_add_f32 v[96:97], v[96:97], s[48:49]
    v_pk_add_f32 v[98:99], v[98:99], s[48:49]
    v_pk_add_f32 v[100:101], v[100:101], s[48:49]
    v_pk_add_f32 v[102:103], v[102:103], s[48:49]
    v_rcp_f32 v96, v96
    v_rcp_f32 v97, v97
    v_rcp_f32 v98, v98
    v_rcp_f32 v99, v99
    v_rcp_f32 v100, v100
    v_rcp_f32 v101, v101
    v_rcp_f32 v102, v102
    v_rcp_f32 v103, v103
    v_pk_mul_f32 v[56:57], v[56:57], v[96:97]
    v_pk_mul_f32 v[58:59], v[58:59], v[98:99]
    v_pk_mul_f32 v[60:61], v[60:61], v[100:101]
    v_pk_mul_f32 v[62:63], v[62:63], v[102:103]
    v_pk_fma_f32 v[48:49], v[40:41], v[56:57], v[48:49]
    v_pk_fma_f32 v[50:51], v[42:43], v[58:59], v[50:51]
    v_pk_fma_f32 v[52:53], v[44:45], v[60:61], v[52:53]
    v_pk_fma_f32 v[54:55], v[46:47], v[62:63], v[54:55]
    v_cvt_pk_bf16_f32 v104, v48, v49
    v_cvt_pk_bf16_f32 v105, v50, v51
    v_cvt_pk_bf16_f32 v106, v52, v53
    v_cvt_pk_bf16_f32 v107, v54, v55
    buffer_store_dwordx4 v[104:107], v32, s[20:23], 0 offen offset:128
    s_branch L_recurrent_scan__sliding_block_cached__moe_arch_mod__prompt_kernel_fin
L_fin_withsel:
    s_waitcnt vmcnt(40)
    v_mov_b32 v31, 0x7ffffff0
    v_cndmask_b32 v32, v31, v4, s[68:69]
    v_and_b32 v34, s100, v10
    v_rcp_f32 v34, v34
    v_lshlrev_b32 v33, 16, v10
    v_mul_f32 v30, v33, v34
    v_sub_f32 v36, 0, v30
    s_waitcnt vmcnt(39)
    v_dot2_f32_bf16 v40, v64, s16, 0
    v_dot2_f32_bf16 v41, v64, s17, 0
    v_dot2_f32_bf16 v42, v65, s16, 0
    v_dot2_f32_bf16 v43, v65, s17, 0
    v_dot2_f32_bf16 v44, v66, s16, 0
    v_dot2_f32_bf16 v45, v66, s17, 0
    v_dot2_f32_bf16 v46, v67, s16, 0
    v_dot2_f32_bf16 v47, v67, s17, 0
    s_waitcnt vmcnt(38)
    v_dot2_f32_bf16 v40, v68, s16, v40
    v_dot2_f32_bf16 v41, v68, s17, v41
    v_dot2_f32_bf16 v42, v69, s16, v42
    v_dot2_f32_bf16 v43, v69, s17, v43
    v_dot2_f32_bf16 v44, v70, s16, v44
    v_dot2_f32_bf16 v45, v70, s17, v45
    v_dot2_f32_bf16 v46, v71, s16, v46
    v_dot2_f32_bf16 v47, v71, s17, v47
    s_waitcnt vmcnt(37)
    v_dot2_f32_bf16 v40, v72, s16, v40
    v_dot2_f32_bf16 v41, v72, s17, v41
    v_dot2_f32_bf16 v42, v73, s16, v42
    v_dot2_f32_bf16 v43, v73, s17, v43
    v_dot2_f32_bf16 v44, v74, s16, v44
    v_dot2_f32_bf16 v45, v74, s17, v45
    v_dot2_f32_bf16 v46, v75, s16, v46
    v_dot2_f32_bf16 v47, v75, s17, v47
    s_waitcnt vmcnt(36)
    v_dot2_f32_bf16 v40, v76, s16, v40
    v_dot2_f32_bf16 v41, v76, s17, v41
    v_dot2_f32_bf16 v42, v77, s16, v42
    v_dot2_f32_bf16 v43, v77, s17, v43
    v_dot2_f32_bf16 v44, v78, s16, v44
    v_dot2_f32_bf16 v45, v78, s17, v45
    v_dot2_f32_bf16 v46, v79, s16, v46
    v_dot2_f32_bf16 v47, v79, s17, v47
    s_waitcnt vmcnt(35)
    v_dot2_f32_bf16 v40, v80, s16, v40
    v_dot2_f32_bf16 v41, v80, s17, v41
    v_dot2_f32_bf16 v42, v81, s16, v42
    v_dot2_f32_bf16 v43, v81, s17, v43
    v_dot2_f32_bf16 v44, v82, s16, v44
    v_dot2_f32_bf16 v45, v82, s17, v45
    v_dot2_f32_bf16 v46, v83, s16, v46
    v_dot2_f32_bf16 v47, v83, s17, v47
    s_waitcnt vmcnt(34)
    v_dot2_f32_bf16 v40, v84, s16, v40
    v_dot2_f32_bf16 v41, v84, s17, v41
    v_dot2_f32_bf16 v42, v85, s16, v42
    v_dot2_f32_bf16 v43, v85, s17, v43
    v_dot2_f32_bf16 v44, v86, s16, v44
    v_dot2_f32_bf16 v45, v86, s17, v45
    v_dot2_f32_bf16 v46, v87, s16, v46
    v_dot2_f32_bf16 v47, v87, s17, v47
    s_waitcnt vmcnt(33)
    v_dot2_f32_bf16 v40, v88, s16, v40
    v_dot2_f32_bf16 v41, v88, s17, v41
    v_dot2_f32_bf16 v42, v89, s16, v42
    v_dot2_f32_bf16 v43, v89, s17, v43
    v_dot2_f32_bf16 v44, v90, s16, v44
    v_dot2_f32_bf16 v45, v90, s17, v45
    v_dot2_f32_bf16 v46, v91, s16, v46
    v_dot2_f32_bf16 v47, v91, s17, v47
    s_waitcnt vmcnt(32)
    v_dot2_f32_bf16 v40, v92, s16, v40
    v_dot2_f32_bf16 v41, v92, s17, v41
    v_dot2_f32_bf16 v42, v93, s16, v42
    v_dot2_f32_bf16 v43, v93, s17, v43
    v_dot2_f32_bf16 v44, v94, s16, v44
    v_dot2_f32_bf16 v45, v94, s17, v45
    v_dot2_f32_bf16 v46, v95, s16, v46
    v_dot2_f32_bf16 v47, v95, s17, v47
    v_lshlrev_b32 v48, 16, v12
    v_and_b32 v49, s100, v12
    v_lshlrev_b32 v50, 16, v13
    v_and_b32 v51, s100, v13
    v_lshlrev_b32 v52, 16, v14
    v_and_b32 v53, s100, v14
    v_lshlrev_b32 v54, 16, v15
    v_and_b32 v55, s100, v15
    v_pk_fma_f32 v[56:57], v[48:49], v[34:35], v[36:37] op_sel_hi:[1,0,0]
    v_pk_fma_f32 v[58:59], v[50:51], v[34:35], v[36:37] op_sel_hi:[1,0,0]
    v_pk_fma_f32 v[60:61], v[52:53], v[34:35], v[36:37] op_sel_hi:[1,0,0]
    v_pk_fma_f32 v[62:63], v[54:55], v[34:35], v[36:37] op_sel_hi:[1,0,0]
    v_pk_mul_f32 v[64:65], v[56:57], s[18:19]
    v_pk_mul_f32 v[66:67], v[58:59], s[18:19]
    v_pk_mul_f32 v[68:69], v[60:61], s[18:19]
    v_pk_mul_f32 v[70:71], v[62:63], s[18:19]
    v_exp_f32 v64, v64
    v_exp_f32 v65, v65
    v_exp_f32 v66, v66
    v_exp_f32 v67, v67
    v_exp_f32 v68, v68
    v_exp_f32 v69, v69
    v_exp_f32 v70, v70
    v_exp_f32 v71, v71
    v_pk_add_f32 v[64:65], v[64:65], s[48:49]
    v_pk_add_f32 v[66:67], v[66:67], s[48:49]
    v_pk_add_f32 v[68:69], v[68:69], s[48:49]
    v_pk_add_f32 v[70:71], v[70:71], s[48:49]
    v_rcp_f32 v64, v64
    v_rcp_f32 v65, v65
    v_rcp_f32 v66, v66
    v_rcp_f32 v67, v67
    v_rcp_f32 v68, v68
    v_rcp_f32 v69, v69
    v_rcp_f32 v70, v70
    v_rcp_f32 v71, v71
    v_pk_mul_f32 v[56:57], v[56:57], v[64:65]
    v_pk_mul_f32 v[58:59], v[58:59], v[66:67]
    v_pk_mul_f32 v[60:61], v[60:61], v[68:69]
    v_pk_mul_f32 v[62:63], v[62:63], v[70:71]
    v_pk_fma_f32 v[48:49], v[40:41], v[56:57], v[48:49]
    v_pk_fma_f32 v[50:51], v[42:43], v[58:59], v[50:51]
    v_pk_fma_f32 v[52:53], v[44:45], v[60:61], v[52:53]
    v_pk_fma_f32 v[54:55], v[46:47], v[62:63], v[54:55]
    v_cvt_pk_bf16_f32 v72, v48, v49
    v_cvt_pk_bf16_f32 v73, v50, v51
    v_cvt_pk_bf16_f32 v74, v52, v53
    v_cvt_pk_bf16_f32 v75, v54, v55
    buffer_store_dwordx4 v[72:75], v32, s[20:23], 0 offen offset:0
    s_waitcnt vmcnt(32)
    v_dot2_f32_bf16 v40, v96, s16, 0
    v_dot2_f32_bf16 v41, v96, s17, 0
    v_dot2_f32_bf16 v42, v97, s16, 0
    v_dot2_f32_bf16 v43, v97, s17, 0
    v_dot2_f32_bf16 v44, v98, s16, 0
    v_dot2_f32_bf16 v45, v98, s17, 0
    v_dot2_f32_bf16 v46, v99, s16, 0
    v_dot2_f32_bf16 v47, v99, s17, 0
    s_waitcnt vmcnt(31)
    v_dot2_f32_bf16 v40, v100, s16, v40
    v_dot2_f32_bf16 v41, v100, s17, v41
    v_dot2_f32_bf16 v42, v101, s16, v42
    v_dot2_f32_bf16 v43, v101, s17, v43
    v_dot2_f32_bf16 v44, v102, s16, v44
    v_dot2_f32_bf16 v45, v102, s17, v45
    v_dot2_f32_bf16 v46, v103, s16, v46
    v_dot2_f32_bf16 v47, v103, s17, v47
    s_waitcnt vmcnt(30)
    v_dot2_f32_bf16 v40, v104, s16, v40
    v_dot2_f32_bf16 v41, v104, s17, v41
    v_dot2_f32_bf16 v42, v105, s16, v42
    v_dot2_f32_bf16 v43, v105, s17, v43
    v_dot2_f32_bf16 v44, v106, s16, v44
    v_dot2_f32_bf16 v45, v106, s17, v45
    v_dot2_f32_bf16 v46, v107, s16, v46
    v_dot2_f32_bf16 v47, v107, s17, v47
    s_waitcnt vmcnt(29)
    v_dot2_f32_bf16 v40, v108, s16, v40
    v_dot2_f32_bf16 v41, v108, s17, v41
    v_dot2_f32_bf16 v42, v109, s16, v42
    v_dot2_f32_bf16 v43, v109, s17, v43
    v_dot2_f32_bf16 v44, v110, s16, v44
    v_dot2_f32_bf16 v45, v110, s17, v45
    v_dot2_f32_bf16 v46, v111, s16, v46
    v_dot2_f32_bf16 v47, v111, s17, v47
    s_waitcnt vmcnt(28)
    v_dot2_f32_bf16 v40, v112, s16, v40
    v_dot2_f32_bf16 v41, v112, s17, v41
    v_dot2_f32_bf16 v42, v113, s16, v42
    v_dot2_f32_bf16 v43, v113, s17, v43
    v_dot2_f32_bf16 v44, v114, s16, v44
    v_dot2_f32_bf16 v45, v114, s17, v45
    v_dot2_f32_bf16 v46, v115, s16, v46
    v_dot2_f32_bf16 v47, v115, s17, v47
    s_waitcnt vmcnt(27)
    v_dot2_f32_bf16 v40, v116, s16, v40
    v_dot2_f32_bf16 v41, v116, s17, v41
    v_dot2_f32_bf16 v42, v117, s16, v42
    v_dot2_f32_bf16 v43, v117, s17, v43
    v_dot2_f32_bf16 v44, v118, s16, v44
    v_dot2_f32_bf16 v45, v118, s17, v45
    v_dot2_f32_bf16 v46, v119, s16, v46
    v_dot2_f32_bf16 v47, v119, s17, v47
    s_waitcnt vmcnt(26)
    v_dot2_f32_bf16 v40, v120, s16, v40
    v_dot2_f32_bf16 v41, v120, s17, v41
    v_dot2_f32_bf16 v42, v121, s16, v42
    v_dot2_f32_bf16 v43, v121, s17, v43
    v_dot2_f32_bf16 v44, v122, s16, v44
    v_dot2_f32_bf16 v45, v122, s17, v45
    v_dot2_f32_bf16 v46, v123, s16, v46
    v_dot2_f32_bf16 v47, v123, s17, v47
    s_waitcnt vmcnt(25)
    v_dot2_f32_bf16 v40, v124, s16, v40
    v_dot2_f32_bf16 v41, v124, s17, v41
    v_dot2_f32_bf16 v42, v125, s16, v42
    v_dot2_f32_bf16 v43, v125, s17, v43
    v_dot2_f32_bf16 v44, v126, s16, v44
    v_dot2_f32_bf16 v45, v126, s17, v45
    v_dot2_f32_bf16 v46, v127, s16, v46
    v_dot2_f32_bf16 v47, v127, s17, v47
    v_lshlrev_b32 v48, 16, v16
    v_and_b32 v49, s100, v16
    v_lshlrev_b32 v50, 16, v17
    v_and_b32 v51, s100, v17
    v_lshlrev_b32 v52, 16, v18
    v_and_b32 v53, s100, v18
    v_lshlrev_b32 v54, 16, v19
    v_and_b32 v55, s100, v19
    v_pk_fma_f32 v[56:57], v[48:49], v[34:35], v[36:37] op_sel_hi:[1,0,0]
    v_pk_fma_f32 v[58:59], v[50:51], v[34:35], v[36:37] op_sel_hi:[1,0,0]
    v_pk_fma_f32 v[60:61], v[52:53], v[34:35], v[36:37] op_sel_hi:[1,0,0]
    v_pk_fma_f32 v[62:63], v[54:55], v[34:35], v[36:37] op_sel_hi:[1,0,0]
    v_pk_mul_f32 v[96:97], v[56:57], s[18:19]
    v_pk_mul_f32 v[98:99], v[58:59], s[18:19]
    v_pk_mul_f32 v[100:101], v[60:61], s[18:19]
    v_pk_mul_f32 v[102:103], v[62:63], s[18:19]
    v_exp_f32 v96, v96
    v_exp_f32 v97, v97
    v_exp_f32 v98, v98
    v_exp_f32 v99, v99
    v_exp_f32 v100, v100
    v_exp_f32 v101, v101
    v_exp_f32 v102, v102
    v_exp_f32 v103, v103
    v_pk_add_f32 v[96:97], v[96:97], s[48:49]
    v_pk_add_f32 v[98:99], v[98:99], s[48:49]
    v_pk_add_f32 v[100:101], v[100:101], s[48:49]
    v_pk_add_f32 v[102:103], v[102:103], s[48:49]
    v_rcp_f32 v96, v96
    v_rcp_f32 v97, v97
    v_rcp_f32 v98, v98
    v_rcp_f32 v99, v99
    v_rcp_f32 v100, v100
    v_rcp_f32 v101, v101
    v_rcp_f32 v102, v102
    v_rcp_f32 v103, v103
    v_pk_mul_f32 v[56:57], v[56:57], v[96:97]
    v_pk_mul_f32 v[58:59], v[58:59], v[98:99]
    v_pk_mul_f32 v[60:61], v[60:61], v[100:101]
    v_pk_mul_f32 v[62:63], v[62:63], v[102:103]
    v_pk_fma_f32 v[48:49], v[40:41], v[56:57], v[48:49]
    v_pk_fma_f32 v[50:51], v[42:43], v[58:59], v[50:51]
    v_pk_fma_f32 v[52:53], v[44:45], v[60:61], v[52:53]
    v_pk_fma_f32 v[54:55], v[46:47], v[62:63], v[54:55]
    v_cvt_pk_bf16_f32 v104, v48, v49
    v_cvt_pk_bf16_f32 v105, v50, v51
    v_cvt_pk_bf16_f32 v106, v52, v53
    v_cvt_pk_bf16_f32 v107, v54, v55
    buffer_store_dwordx4 v[104:107], v32, s[20:23], 0 offen offset:128
    s_waitcnt vmcnt(2)
    v_dot2_f32_bf16 v40, v180, s16, 0
    v_dot2_f32_bf16 v41, v180, s17, 0
    v_dot2_f32_bf16 v42, v181, s16, 0
    v_dot2_f32_bf16 v43, v181, s17, 0
    v_dot2_f32_bf16 v40, v182, s16, v40
    v_dot2_f32_bf16 v41, v182, s17, v41
    v_dot2_f32_bf16 v42, v183, s16, v42
    v_dot2_f32_bf16 v43, v183, s17, v43
    v_dot2_f32_bf16 v40, v184, s16, v40
    v_dot2_f32_bf16 v41, v184, s17, v41
    v_dot2_f32_bf16 v42, v185, s16, v42
    v_dot2_f32_bf16 v43, v185, s17, v43
    v_dot2_f32_bf16 v40, v186, s16, v40
    v_dot2_f32_bf16 v41, v186, s17, v41
    v_dot2_f32_bf16 v42, v187, s16, v42
    v_dot2_f32_bf16 v43, v187, s17, v43
    v_dot2_f32_bf16 v40, v188, s16, v40
    v_dot2_f32_bf16 v41, v188, s17, v41
    v_dot2_f32_bf16 v42, v189, s16, v42
    v_dot2_f32_bf16 v43, v189, s17, v43
    v_dot2_f32_bf16 v40, v190, s16, v40
    v_dot2_f32_bf16 v41, v190, s17, v41
    v_dot2_f32_bf16 v42, v191, s16, v42
    v_dot2_f32_bf16 v43, v191, s17, v43
    v_dot2_f32_bf16 v40, v192, s16, v40
    v_dot2_f32_bf16 v41, v192, s17, v41
    v_dot2_f32_bf16 v42, v193, s16, v42
    v_dot2_f32_bf16 v43, v193, s17, v43
    v_dot2_f32_bf16 v40, v194, s16, v40
    v_dot2_f32_bf16 v41, v194, s17, v41
    v_dot2_f32_bf16 v42, v195, s16, v42
    v_dot2_f32_bf16 v43, v195, s17, v43
    v_dot2_f32_bf16 v40, v196, s16, v40
    v_dot2_f32_bf16 v41, v196, s17, v41
    v_dot2_f32_bf16 v42, v197, s16, v42
    v_dot2_f32_bf16 v43, v197, s17, v43
    v_dot2_f32_bf16 v40, v198, s16, v40
    v_dot2_f32_bf16 v41, v198, s17, v41
    v_dot2_f32_bf16 v42, v199, s16, v42
    v_dot2_f32_bf16 v43, v199, s17, v43
    v_dot2_f32_bf16 v40, v200, s16, v40
    v_dot2_f32_bf16 v41, v200, s17, v41
    v_dot2_f32_bf16 v42, v201, s16, v42
    v_dot2_f32_bf16 v43, v201, s17, v43
    v_dot2_f32_bf16 v40, v202, s16, v40
    v_dot2_f32_bf16 v41, v202, s17, v41
    v_dot2_f32_bf16 v42, v203, s16, v42
    v_dot2_f32_bf16 v43, v203, s17, v43
    v_dot2_f32_bf16 v40, v204, s16, v40
    v_dot2_f32_bf16 v41, v204, s17, v41
    v_dot2_f32_bf16 v42, v205, s16, v42
    v_dot2_f32_bf16 v43, v205, s17, v43
    v_dot2_f32_bf16 v40, v206, s16, v40
    v_dot2_f32_bf16 v41, v206, s17, v41
    v_dot2_f32_bf16 v42, v207, s16, v42
    v_dot2_f32_bf16 v43, v207, s17, v43
    v_dot2_f32_bf16 v56, v160, s16, 0
    v_dot2_f32_bf16 v57, v160, s17, 0
    v_dot2_f32_bf16 v58, v161, s16, 0
    v_dot2_f32_bf16 v59, v161, s17, 0
    v_dot2_f32_bf16 v56, v162, s16, v56
    v_dot2_f32_bf16 v57, v162, s17, v57
    v_dot2_f32_bf16 v58, v163, s16, v58
    v_dot2_f32_bf16 v59, v163, s17, v59
    v_dot2_f32_bf16 v56, v164, s16, v56
    v_dot2_f32_bf16 v57, v164, s17, v57
    v_dot2_f32_bf16 v58, v165, s16, v58
    v_dot2_f32_bf16 v59, v165, s17, v59
    v_dot2_f32_bf16 v56, v166, s16, v56
    v_dot2_f32_bf16 v57, v166, s17, v57
    v_dot2_f32_bf16 v58, v167, s16, v58
    v_dot2_f32_bf16 v59, v167, s17, v59
    v_dot2_f32_bf16 v56, v168, s16, v56
    v_dot2_f32_bf16 v57, v168, s17, v57
    v_dot2_f32_bf16 v58, v169, s16, v58
    v_dot2_f32_bf16 v59, v169, s17, v59
    v_dot2_f32_bf16 v56, v170, s16, v56
    v_dot2_f32_bf16 v57, v170, s17, v57
    v_dot2_f32_bf16 v58, v171, s16, v58
    v_dot2_f32_bf16 v59, v171, s17, v59
    v_dot2_f32_bf16 v56, v172, s16, v56
    v_dot2_f32_bf16 v57, v172, s17, v57
    v_dot2_f32_bf16 v58, v173, s16, v58
    v_dot2_f32_bf16 v59, v173, s17, v59
    v_dot2_f32_bf16 v56, v174, s16, v56
    v_dot2_f32_bf16 v57, v174, s17, v57
    v_dot2_f32_bf16 v58, v175, s16, v58
    v_dot2_f32_bf16 v59, v175, s17, v59
    v_and_b32 v10, s100, v178
    v_rcp_f32 v10, v10
    v_lshlrev_b32 v9, 16, v178
    v_mov_b32 v48, s47
    v_mul_f32 v8, v9, v10
    v_sub_f32 v8, 0, v8
    v_add_f32_dpp v40, v40, v40 row_ror:4 row_mask:0xf bank_mask:0xf
    v_add_f32_dpp v41, v41, v41 row_ror:4 row_mask:0xf bank_mask:0xf
    v_add_f32_dpp v42, v42, v42 row_ror:4 row_mask:0xf bank_mask:0xf
    v_add_f32_dpp v43, v43, v43 row_ror:4 row_mask:0xf bank_mask:0xf
    v_lshlrev_b32 v64, 16, v176
    v_and_b32 v65, s100, v176
    v_add_f32_dpp v40, v40, v40 row_ror:8 row_mask:0xf bank_mask:0xf
    v_add_f32_dpp v41, v41, v41 row_ror:8 row_mask:0xf bank_mask:0xf
    v_add_f32_dpp v42, v42, v42 row_ror:8 row_mask:0xf bank_mask:0xf
    v_add_f32_dpp v43, v43, v43 row_ror:8 row_mask:0xf bank_mask:0xf
    v_lshlrev_b32 v66, 16, v177
    v_and_b32 v67, s100, v177
    v_mov_b32 v44, v40
    v_mov_b32 v45, v41
    v_mov_b32 v46, v42
    v_mov_b32 v47, v43
    s_nop 0
    v_permlane16_swap_b32 v40, v44
    v_permlane16_swap_b32 v41, v45
    v_permlane16_swap_b32 v42, v46
    v_permlane16_swap_b32 v43, v47
    v_add_f32 v40, v40, v44
    v_add_f32 v41, v41, v45
    v_add_f32 v42, v42, v46
    v_add_f32 v43, v43, v47
    v_mov_b32 v44, v40
    v_mov_b32 v45, v41
    v_mov_b32 v46, v42
    v_mov_b32 v47, v43
    s_nop 0
    v_permlane32_swap_b32 v40, v44
    v_permlane32_swap_b32 v41, v45
    v_permlane32_swap_b32 v42, v46
    v_permlane32_swap_b32 v43, v47
    v_add_f32 v40, v40, v44
    v_add_f32 v41, v41, v45
    v_add_f32 v42, v42, v46
    v_add_f32 v43, v43, v47
    v_cvt_pk_bf16_f32 v50, v40, v41
    v_cvt_pk_bf16_f32 v51, v42, v43
    v_lshlrev_b32 v40, 16, v50
    v_and_b32 v41, s100, v50
    v_lshlrev_b32 v42, 16, v51
    v_and_b32 v43, s100, v51
    v_pk_mul_f32 v[40:41], v[40:41], v[48:49] op_sel_hi:[1,0]
    v_pk_mul_f32 v[42:43], v[42:43], v[48:49] op_sel_hi:[1,0]
    v_pk_fma_f32 v[72:73], v[64:65], v[10:11], v[8:9] op_sel_hi:[1,0,0]
    v_pk_fma_f32 v[74:75], v[66:67], v[10:11], v[8:9] op_sel_hi:[1,0,0]
    v_cvt_pk_bf16_f32 v50, v40, v41
    v_cvt_pk_bf16_f32 v51, v42, v43
    v_lshlrev_b32 v40, 16, v50
    v_and_b32 v41, s100, v50
    v_lshlrev_b32 v42, 16, v51
    v_and_b32 v43, s100, v51
    v_pk_add_f32 v[72:73], v[72:73], v[40:41]
    v_pk_add_f32 v[74:75], v[74:75], v[42:43]
    v_pk_mul_f32 v[80:81], v[72:73], s[18:19]
    v_pk_mul_f32 v[82:83], v[74:75], s[18:19]
    v_exp_f32 v80, v80
    v_exp_f32 v81, v81
    v_exp_f32 v82, v82
    v_exp_f32 v83, v83
    v_pk_add_f32 v[80:81], v[80:81], s[48:49]
    v_pk_add_f32 v[82:83], v[82:83], s[48:49]
    v_rcp_f32 v80, v80
    v_rcp_f32 v81, v81
    v_rcp_f32 v82, v82
    v_rcp_f32 v83, v83
    s_nop 0
    v_pk_mul_f32 v[72:73], v[72:73], v[80:81]
    v_pk_mul_f32 v[74:75], v[74:75], v[82:83]
    v_pk_fma_f32 v[64:65], v[56:57], v[72:73], v[64:65]
    v_pk_fma_f32 v[66:67], v[58:59], v[74:75], v[66:67]
    v_cvt_pk_bf16_f32 v76, v64, v65
    v_cvt_pk_bf16_f32 v77, v66, v67
    v_mov_b32 v31, 0x7ffffff0
    v_cmp_gt_u32 vcc, 4, v0
    s_nop 1
    v_cndmask_b32 v29, v31, v29, vcc
    s_nop 0
    buffer_store_dwordx2 v[76:77], v29, s[20:23], 0 offen
    s_branch L_recurrent_scan__sliding_block_cached__moe_arch_mod__prompt_kernel_fin
L_moe_slow:
    s_barrier
    s_mov_b32 s45, 4000
    v_mov_b32 v21, 0
L_moe_spin:
    global_load_dword v22, v21, s[72:73] sc1
    s_waitcnt vmcnt(0)
    v_readfirstlane_b32 s44, v22
    s_nop 0
    s_cmp_ge_u32 s44, 256
    s_cbranch_scc1 L_moe_spin_ok
    s_sleep 8
    s_sub_u32 s45, s45, 1
    s_cmp_lg_u32 s45, 0
    s_cbranch_scc1 L_moe_spin
L_moe_spin_ok:
    s_cmp_ge_u32 s44, 256
    s_cselect_b32 s44, 1, 0
    v_mov_b32 v22, s44
    v_mov_b32 v23, s40
    ds_write_b32 v23, v22 offset:128
    s_waitcnt lgkmcnt(0)
    s_barrier
    v_mov_b32 v23, 65536
    ds_read_b32 v32, v23 offset:128
    ds_read_b32 v33, v23 offset:24704
    ds_read_b32 v34, v23 offset:49280
    v_add_u32 v23, 73728, v23
    ds_read_b32 v35, v23 offset:128
    s_waitcnt lgkmcnt(0)
    v_and_b32 v32, v32, v33
    v_and_b32 v34, v34, v35
    v_and_b32 v32, v32, v34
    s_nop 0
    v_readfirstlane_b32 s44, v32
    s_nop 0
    s_cmp_eq_u32 s44, 1
    s_cbranch_scc1 L_moe_reload
    s_lshl_b32 s42, s98, 14
    s_add_u32 s42, s42, 25165824
    s_add_u32 s43, s42, 8192
    v_lshlrev_b32 v21, 4, v0
    buffer_load_dwordx4 v[40:43], v21, s[28:31], 0 offen
    s_lshl_b32 s45, s34, 9
    s_add_u32 s46, s45, 512
    s_waitcnt vmcnt(0)
    v_lshlrev_b32 v44, 16, v40
    v_and_b32 v45, s100, v40
    v_lshlrev_b32 v46, 16, v41
    v_and_b32 v47, s100, v41
    v_lshlrev_b32 v48, 16, v42
    v_and_b32 v49, s100, v42
    v_lshlrev_b32 v50, 16, v43
    v_and_b32 v51, s100, v43
L_moe_fb:
    s_lshl_b32 s44, s45, 10
    buffer_load_dwordx4 v[40:43], v21, s[4:7], s44 offen
    s_waitcnt vmcnt(0)
    v_lshlrev_b32 v56, 16, v40
    v_and_b32 v57, s100, v40
    v_lshlrev_b32 v58, 16, v41
    v_and_b32 v59, s100, v41
    v_lshlrev_b32 v60, 16, v42
    v_and_b32 v61, s100, v42
    v_lshlrev_b32 v62, 16, v43
    v_and_b32 v63, s100, v43
    v_add_f32 v64, v56, v57
    v_add_f32 v64, v64, v58
    v_add_f32 v64, v64, v59
    v_add_f32 v64, v64, v60
    v_add_f32 v64, v64, v61
    v_add_f32 v64, v64, v62
    v_add_f32 v64, v64, v63
    s_nop 1
    v_add_f32_dpp v64, v64, v64 row_ror:1 row_mask:0xf bank_mask:0xf
    s_nop 1
    v_add_f32_dpp v64, v64, v64 row_ror:2 row_mask:0xf bank_mask:0xf
    s_nop 1
    v_add_f32_dpp v64, v64, v64 row_ror:4 row_mask:0xf bank_mask:0xf
    s_nop 1
    v_add_f32_dpp v64, v64, v64 row_ror:8 row_mask:0xf bank_mask:0xf
    v_mov_b32 v65, v64
    s_nop 1
    v_permlane16_swap_b32 v64, v65
    s_nop 0
    v_add_f32 v64, v64, v65
    v_mov_b32 v65, v64
    s_nop 1
    v_permlane32_swap_b32 v64, v65
    s_nop 0
    v_add_f32 v64, v64, v65
    v_mul_f32 v64, 0x3b000000, v64
    v_sub_f32 v66, v56, v64
    v_mul_f32 v67, v66, v66
    v_sub_f32 v66, v57, v64
    v_fmac_f32 v67, v66, v66
    v_sub_f32 v66, v58, v64
    v_fmac_f32 v67, v66, v66
    v_sub_f32 v66, v59, v64
    v_fmac_f32 v67, v66, v66
    v_sub_f32 v66, v60, v64
    v_fmac_f32 v67, v66, v66
    v_sub_f32 v66, v61, v64
    v_fmac_f32 v67, v66, v66
    v_sub_f32 v66, v62, v64
    v_fmac_f32 v67, v66, v66
    v_sub_f32 v66, v63, v64
    v_fmac_f32 v67, v66, v66
    s_nop 1
    v_add_f32_dpp v67, v67, v67 row_ror:1 row_mask:0xf bank_mask:0xf
    s_nop 1
    v_add_f32_dpp v67, v67, v67 row_ror:2 row_mask:0xf bank_mask:0xf
    s_nop 1
    v_add_f32_dpp v67, v67, v67 row_ror:4 row_mask:0xf bank_mask:0xf
    s_nop 1
    v_add_f32_dpp v67, v67, v67 row_ror:8 row_mask:0xf bank_mask:0xf
    v_mov_b32 v65, v67
    s_nop 1
    v_permlane16_swap_b32 v67, v65
    s_nop 0
    v_add_f32 v67, v67, v65
    v_mov_b32 v65, v67
    s_nop 1
    v_permlane32_swap_b32 v67, v65
    s_nop 0
    v_add_f32 v67, v67, v65
    v_mul_f32 v67, 0x3b000000, v67
    v_cvt_pk_bf16_f32 v68, v64, v67
    v_and_b32 v69, s100, v68
    v_add_f32 v69, 0x3727c5ac, v69
    v_cvt_pk_bf16_f32 v69, v69, v69
    v_and_b32 v69, s100, v69
    v_sqrt_f32 v69, v69
    v_lshlrev_b32 v64, 16, v68
    v_cvt_pk_bf16_f32 v69, v69, v69
    v_and_b32 v69, s100, v69
    v_rcp_f32 v70, v69
    v_and_b32 v68, 0xffff, v68
    v_or_b32 v68, v68, v69
    v_mov_b32 v71, 0
    v_sub_f32 v66, v56, v64
    v_mul_f32 v66, v66, v70
    v_cvt_pk_bf16_f32 v66, v66, v66
    v_and_b32 v66, s100, v66
    v_fmac_f32 v71, v66, v44
    v_sub_f32 v66, v57, v64
    v_mul_f32 v66, v66, v70
    v_cvt_pk_bf16_f32 v66, v66, v66
    v_and_b32 v66, s100, v66
    v_fmac_f32 v71, v66, v45
    v_sub_f32 v66, v58, v64
    v_mul_f32 v66, v66, v70
    v_cvt_pk_bf16_f32 v66, v66, v66
    v_and_b32 v66, s100, v66
    v_fmac_f32 v71, v66, v46
    v_sub_f32 v66, v59, v64
    v_mul_f32 v66, v66, v70
    v_cvt_pk_bf16_f32 v66, v66, v66
    v_and_b32 v66, s100, v66
    v_fmac_f32 v71, v66, v47
    v_sub_f32 v66, v60, v64
    v_mul_f32 v66, v66, v70
    v_cvt_pk_bf16_f32 v66, v66, v66
    v_and_b32 v66, s100, v66
    v_fmac_f32 v71, v66, v48
    v_sub_f32 v66, v61, v64
    v_mul_f32 v66, v66, v70
    v_cvt_pk_bf16_f32 v66, v66, v66
    v_and_b32 v66, s100, v66
    v_fmac_f32 v71, v66, v49
    v_sub_f32 v66, v62, v64
    v_mul_f32 v66, v66, v70
    v_cvt_pk_bf16_f32 v66, v66, v66
    v_and_b32 v66, s100, v66
    v_fmac_f32 v71, v66, v50
    v_sub_f32 v66, v63, v64
    v_mul_f32 v66, v66, v70
    v_cvt_pk_bf16_f32 v66, v66, v66
    v_and_b32 v66, s100, v66
    v_fmac_f32 v71, v66, v51
    s_nop 1
    v_add_f32_dpp v71, v71, v71 row_ror:1 row_mask:0xf bank_mask:0xf
    s_nop 1
    v_add_f32_dpp v71, v71, v71 row_ror:2 row_mask:0xf bank_mask:0xf
    s_nop 1
    v_add_f32_dpp v71, v71, v71 row_ror:4 row_mask:0xf bank_mask:0xf
    s_nop 1
    v_add_f32_dpp v71, v71, v71 row_ror:8 row_mask:0xf bank_mask:0xf
    v_mov_b32 v65, v71
    s_nop 1
    v_permlane16_swap_b32 v71, v65
    s_nop 0
    v_add_f32 v71, v71, v65
    v_mov_b32 v65, v71
    s_nop 1
    v_permlane32_swap_b32 v71, v65
    s_nop 0
    v_add_f32 v71, v71, v65
    v_cvt_pk_bf16_f32 v71, v71, v71
    v_and_b32 v71, s100, v71
    v_ashrrev_i32 v72, 31, v71
    v_or_b32 v72, 0x80000000, v72
    v_xor_b32 v71, v71, v72
    s_sub_u32 s44, 2047, s45
    v_mov_b32 v72, s44
    v_and_or_b32 v71, v71, s100, v72
    s_lshl_b32 s44, s45, 2
    v_mov_b32 v72, s44
    v_add_u32 v73, s42, v72
    v_add_u32 v74, s43, v72
    v_cmp_eq_u32 vcc, 0, v0
    s_nop 1
    s_and_saveexec_b64 s[60:61], vcc
    buffer_store_dword v71, v73, s[24:27], 0 offen sc1
    buffer_store_dword v68, v74, s[24:27], 0 offen sc1
    s_mov_b64 exec, s[60:61]
    s_add_u32 s45, s45, 1
    s_cmp_lt_u32 s45, s46
    s_cbranch_scc1 L_moe_fb
    s_waitcnt vmcnt(0)
    s_barrier
L_moe_reload:
    s_lshl_b32 s44, s34, 11
    v_lshlrev_b32 v21, 5, v0
    v_add_u32 v21, s44, v21
    v_add_u32 v21, s42, v21
    buffer_load_dwordx4 v[8:11], v21, s[24:27], 0 offen sc1
    buffer_load_dwordx4 v[12:15], v21, s[24:27], 0 offen offset:16 sc1
    s_mov_b32 s99, 1
    s_waitcnt vmcnt(0)
    s_barrier
L_moe_keys:
    v_max_u32 v16, v8, v9
    v_min_u32 v9, v8, v9
    v_max_u32 v8, v10, v11
    v_min_u32 v11, v10, v11
    v_max_u32 v10, v12, v13
    v_min_u32 v13, v12, v13
    v_max_u32 v12, v14, v15
    v_min_u32 v15, v14, v15
    v_max_u32 v14, v16, v8
    v_min_u32 v8, v16, v8
    v_max_u32 v16, v9, v11
    v_min_u32 v11, v9, v11
    v_max_u32 v9, v10, v12
    v_min_u32 v12, v10, v12
    v_max_u32 v10, v13, v15
    v_min_u32 v15, v13, v15
    v_max_u32 v13, v16, v8
    v_min_u32 v8, v16, v8
    v_max_u32 v16, v10, v12
    v_min_u32 v12, v10, v12
    v_max_u32 v10, v14, v9
    v_min_u32 v9, v14, v9
    v_max_u32 v14, v11, v15
    v_min_u32 v15, v11, v15
    v_max_u32 v11, v13, v16
    v_min_u32 v16, v13, v16
    v_max_u32 v13, v8, v12
    v_min_u32 v12, v8, v12
    v_max_u32 v8, v11, v9
    v_min_u32 v9, v11, v9
    v_max_u32 v11, v14, v12
    v_min_u32 v12, v14, v12
    v_max_u32 v14, v13, v9
    v_min_u32 v9, v13, v9
    v_max_u32 v13, v11, v16
    v_min_u32 v16, v11, v16
    v_max_u32 v11, v13, v9
    v_min_u32 v9, v13, v9
    v_mov_b32 v20, 0
    v_mov_b32 v17, v10
    s_nop 1
    v_max_u32_dpp v17, v17, v17 row_shr:1 row_mask:0xf bank_mask:0xf
    s_nop 1
    v_max_u32_dpp v17, v17, v17 row_shr:2 row_mask:0xf bank_mask:0xf
    s_nop 1
    v_max_u32_dpp v17, v17, v17 row_shr:4 row_mask:0xf bank_mask:0xf
    s_nop 1
    v_max_u32_dpp v17, v17, v17 row_shr:8 row_mask:0xf bank_mask:0xf
    s_nop 1
    v_max_u32_dpp v17, v17, v17 row_bcast:15 row_mask:0xa bank_mask:0xf
    s_nop 1
    v_max_u32_dpp v17, v17, v17 row_bcast:31 row_mask:0xc bank_mask:0xf
    s_nop 0
    v_readlane_b32 s44, v17, 63
    s_nop 1
    v_writelane_b32 v20, s44, 0
    v_cmp_eq_u32 s[60:61], s44, v10
    s_nop 1
    v_cndmask_b32 v10, v10, v8, s[60:61]
    v_cndmask_b32 v8, v8, v14, s[60:61]
    v_cndmask_b32 v14, v14, v11, s[60:61]
    v_cndmask_b32 v11, v11, v9, s[60:61]
    v_cndmask_b32 v9, v9, v16, s[60:61]
    v_cndmask_b32 v16, v16, v12, s[60:61]
    v_cndmask_b32 v12, v12, v15, s[60:61]
    v_mov_b32 v17, v10
    s_nop 1
    v_max_u32_dpp v17, v17, v17 row_shr:1 row_mask:0xf bank_mask:0xf
    s_nop 1
    v_max_u32_dpp v17, v17, v17 row_shr:2 row_mask:0xf bank_mask:0xf
    s_nop 1
    v_max_u32_dpp v17, v17, v17 row_shr:4 row_mask:0xf bank_mask:0xf
    s_nop 1
    v_max_u32_dpp v17, v17, v17 row_shr:8 row_mask:0xf bank_mask:0xf
    s_nop 1
    v_max_u32_dpp v17, v17, v17 row_bcast:15 row_mask:0xa bank_mask:0xf
    s_nop 1
    v_max_u32_dpp v17, v17, v17 row_bcast:31 row_mask:0xc bank_mask:0xf
    s_nop 0
    v_readlane_b32 s44, v17, 63
    s_nop 1
    v_writelane_b32 v20, s44, 1
    v_cmp_eq_u32 s[60:61], s44, v10
    s_nop 1
    v_cndmask_b32 v10, v10, v8, s[60:61]
    v_cndmask_b32 v8, v8, v14, s[60:61]
    v_cndmask_b32 v14, v14, v11, s[60:61]
    v_cndmask_b32 v11, v11, v9, s[60:61]
    v_cndmask_b32 v9, v9, v16, s[60:61]
    v_cndmask_b32 v16, v16, v12, s[60:61]
    v_mov_b32 v17, v10
    s_nop 1
    v_max_u32_dpp v17, v17, v17 row_shr:1 row_mask:0xf bank_mask:0xf
    s_nop 1
    v_max_u32_dpp v17, v17, v17 row_shr:2 row_mask:0xf bank_mask:0xf
    s_nop 1
    v_max_u32_dpp v17, v17, v17 row_shr:4 row_mask:0xf bank_mask:0xf
    s_nop 1
    v_max_u32_dpp v17, v17, v17 row_shr:8 row_mask:0xf bank_mask:0xf
    s_nop 1
    v_max_u32_dpp v17, v17, v17 row_bcast:15 row_mask:0xa bank_mask:0xf
    s_nop 1
    v_max_u32_dpp v17, v17, v17 row_bcast:31 row_mask:0xc bank_mask:0xf
    s_nop 0
    v_readlane_b32 s44, v17, 63
    s_nop 1
    v_writelane_b32 v20, s44, 2
    v_cmp_eq_u32 s[60:61], s44, v10
    s_nop 1
    v_cndmask_b32 v10, v10, v8, s[60:61]
    v_cndmask_b32 v8, v8, v14, s[60:61]
    v_cndmask_b32 v14, v14, v11, s[60:61]
    v_cndmask_b32 v11, v11, v9, s[60:61]
    v_cndmask_b32 v9, v9, v16, s[60:61]
    v_mov_b32 v17, v10
    s_nop 1
    v_max_u32_dpp v17, v17, v17 row_shr:1 row_mask:0xf bank_mask:0xf
    s_nop 1
    v_max_u32_dpp v17, v17, v17 row_shr:2 row_mask:0xf bank_mask:0xf
    s_nop 1
    v_max_u32_dpp v17, v17, v17 row_shr:4 row_mask:0xf bank_mask:0xf
    s_nop 1
    v_max_u32_dpp v17, v17, v17 row_shr:8 row_mask:0xf bank_mask:0xf
    s_nop 1
    v_max_u32_dpp v17, v17, v17 row_bcast:15 row_mask:0xa bank_mask:0xf
    s_nop 1
    v_max_u32_dpp v17, v17, v17 row_bcast:31 row_mask:0xc bank_mask:0xf
    s_nop 0
    v_readlane_b32 s44, v17, 63
    s_nop 1
    v_writelane_b32 v20, s44, 3
    v_cmp_eq_u32 s[60:61], s44, v10
    s_nop 1
    v_cndmask_b32 v10, v10, v8, s[60:61]
    v_cndmask_b32 v8, v8, v14, s[60:61]
    v_cndmask_b32 v14, v14, v11, s[60:61]
    v_cndmask_b32 v11, v11, v9, s[60:61]
    v_mov_b32 v17, v10
    s_nop 1
    v_max_u32_dpp v17, v17, v17 row_shr:1 row_mask:0xf bank_mask:0xf
    s_nop 1
    v_max_u32_dpp v17, v17, v17 row_shr:2 row_mask:0xf bank_mask:0xf
    s_nop 1
    v_max_u32_dpp v17, v17, v17 row_shr:4 row_mask:0xf bank_mask:0xf
    s_nop 1
    v_max_u32_dpp v17, v17, v17 row_shr:8 row_mask:0xf bank_mask:0xf
    s_nop 1
    v_max_u32_dpp v17, v17, v17 row_bcast:15 row_mask:0xa bank_mask:0xf
    s_nop 1
    v_max_u32_dpp v17, v17, v17 row_bcast:31 row_mask:0xc bank_mask:0xf
    s_nop 0
    v_readlane_b32 s44, v17, 63
    s_nop 1
    v_writelane_b32 v20, s44, 4
    v_cmp_eq_u32 s[60:61], s44, v10
    s_nop 1
    v_cndmask_b32 v10, v10, v8, s[60:61]
    v_cndmask_b32 v8, v8, v14, s[60:61]
    v_cndmask_b32 v14, v14, v11, s[60:61]
    v_mov_b32 v17, v10
    s_nop 1
    v_max_u32_dpp v17, v17, v17 row_shr:1 row_mask:0xf bank_mask:0xf
    s_nop 1
    v_max_u32_dpp v17, v17, v17 row_shr:2 row_mask:0xf bank_mask:0xf
    s_nop 1
    v_max_u32_dpp v17, v17, v17 row_shr:4 row_mask:0xf bank_mask:0xf
    s_nop 1
    v_max_u32_dpp v17, v17, v17 row_shr:8 row_mask:0xf bank_mask:0xf
    s_nop 1
    v_max_u32_dpp v17, v17, v17 row_bcast:15 row_mask:0xa bank_mask:0xf
    s_nop 1
    v_max_u32_dpp v17, v17, v17 row_bcast:31 row_mask:0xc bank_mask:0xf
    s_nop 0
    v_readlane_b32 s44, v17, 63
    s_nop 1
    v_writelane_b32 v20, s44, 5
    v_cmp_eq_u32 s[60:61], s44, v10
    s_nop 1
    v_cndmask_b32 v10, v10, v8, s[60:61]
    v_cndmask_b32 v8, v8, v14, s[60:61]
    v_mov_b32 v17, v10
    s_nop 1
    v_max_u32_dpp v17, v17, v17 row_shr:1 row_mask:0xf bank_mask:0xf
    s_nop 1
    v_max_u32_dpp v17, v17, v17 row_shr:2 row_mask:0xf bank_mask:0xf
    s_nop 1
    v_max_u32_dpp v17, v17, v17 row_shr:4 row_mask:0xf bank_mask:0xf
    s_nop 1
    v_max_u32_dpp v17, v17, v17 row_shr:8 row_mask:0xf bank_mask:0xf
    s_nop 1
    v_max_u32_dpp v17, v17, v17 row_bcast:15 row_mask:0xa bank_mask:0xf
    s_nop 1
    v_max_u32_dpp v17, v17, v17 row_bcast:31 row_mask:0xc bank_mask:0xf
    s_nop 0
    v_readlane_b32 s44, v17, 63
    s_nop 1
    v_writelane_b32 v20, s44, 6
    v_cmp_eq_u32 s[60:61], s44, v10
    s_nop 1
    v_cndmask_b32 v10, v10, v8, s[60:61]
    v_mov_b32 v17, v10
    s_nop 1
    v_max_u32_dpp v17, v17, v17 row_shr:1 row_mask:0xf bank_mask:0xf
    s_nop 1
    v_max_u32_dpp v17, v17, v17 row_shr:2 row_mask:0xf bank_mask:0xf
    s_nop 1
    v_max_u32_dpp v17, v17, v17 row_shr:4 row_mask:0xf bank_mask:0xf
    s_nop 1
    v_max_u32_dpp v17, v17, v17 row_shr:8 row_mask:0xf bank_mask:0xf
    s_nop 1
    v_max_u32_dpp v17, v17, v17 row_bcast:15 row_mask:0xa bank_mask:0xf
    s_nop 1
    v_max_u32_dpp v17, v17, v17 row_bcast:31 row_mask:0xc bank_mask:0xf
    s_nop 0
    v_readlane_b32 s44, v17, 63
    s_nop 1
    v_writelane_b32 v20, s44, 7
    v_mov_b32 v21, s99
    v_cmp_eq_u32 vcc, 8, v0
    v_lshlrev_b32 v22, 2, v0
    v_add_u32 v22, s40, v22
    v_cndmask_b32 v20, v20, v21, vcc
    v_cmp_gt_u32 vcc, 9, v0
    s_nop 1
    s_and_saveexec_b64 s[60:61], vcc
    ds_write_b32 v22, v20
    s_mov_b64 exec, s[60:61]
    s_waitcnt lgkmcnt(0)
    s_barrier
    v_lshrrev_b32 v21, 3, v0
    v_and_b32 v21, 3, v21
    v_mul_u32_u24 v21, 24576, v21
    v_and_b32 v22, 7, v0
    v_lshl_add_u32 v21, v22, 2, v21
    v_mov_b32 v23, 65536
    v_add_u32 v21, v23, v21
    ds_read_b32 v24, v21
    v_add_u32 v100, 0, v23
    v_add_u32 v101, 24576, v23
    v_add_u32 v102, 49152, v23
    v_add_u32 v103, 73728, v23
    ds_read_b128 v[32:35], v100
    ds_read_b128 v[36:39], v100 offset:16
    ds_read_b32 v104, v100 offset:32
    ds_read_b128 v[40:43], v101
    ds_read_b128 v[44:47], v101 offset:16
    ds_read_b32 v105, v101 offset:32
    ds_read_b128 v[48:51], v102
    ds_read_b128 v[52:55], v102 offset:16
    ds_read_b32 v106, v102 offset:32
    ds_read_b128 v[56:59], v103
    ds_read_b128 v[60:63], v103 offset:16
    ds_read_b32 v107, v103 offset:32
    s_waitcnt lgkmcnt(0)
    v_and_b32 v104, v104, v105
    v_and_b32 v106, v106, v107
    v_and_b32 v104, v104, v106
    v_mov_b32 v25, 0
    v_readfirstlane_b32 s44, v104
    s_nop 0
    s_cmp_eq_u32 s44, 0
    s_cbranch_scc1 L_moe_slow
    v_cmp_gt_u32 s[60:61], v32, v24
    v_cmp_gt_u32 s[62:63], v33, v24
    v_cmp_gt_u32 s[64:65], v34, v24
    v_cmp_gt_u32 s[66:67], v35, v24
    v_addc_co_u32 v25, vcc, 0, v25, s[60:61]
    v_addc_co_u32 v25, vcc, 0, v25, s[62:63]
    v_addc_co_u32 v25, vcc, 0, v25, s[64:65]
    v_addc_co_u32 v25, vcc, 0, v25, s[66:67]
    v_cmp_gt_u32 s[60:61], v36, v24
    v_cmp_gt_u32 s[62:63], v37, v24
    v_cmp_gt_u32 s[64:65], v38, v24
    v_cmp_gt_u32 s[66:67], v39, v24
    v_addc_co_u32 v25, vcc, 0, v25, s[60:61]
    v_addc_co_u32 v25, vcc, 0, v25, s[62:63]
    v_addc_co_u32 v25, vcc, 0, v25, s[64:65]
    v_addc_co_u32 v25, vcc, 0, v25, s[66:67]
    v_cmp_gt_u32 s[60:61], v40, v24
    v_cmp_gt_u32 s[62:63], v41, v24
    v_cmp_gt_u32 s[64:65], v42, v24
    v_cmp_gt_u32 s[66:67], v43, v24
    v_addc_co_u32 v25, vcc, 0, v25, s[60:61]
    v_addc_co_u32 v25, vcc, 0, v25, s[62:63]
    v_addc_co_u32 v25, vcc, 0, v25, s[64:65]
    v_addc_co_u32 v25, vcc, 0, v25, s[66:67]
    v_cmp_gt_u32 s[60:61], v44, v24
    v_cmp_gt_u32 s[62:63], v45, v24
    v_cmp_gt_u32 s[64:65], v46, v24
    v_cmp_gt_u32 s[66:67], v47, v24
    v_addc_co_u32 v25, vcc, 0, v25, s[60:61]
    v_addc_co_u32 v25, vcc, 0, v25, s[62:63]
    v_addc_co_u32 v25, vcc, 0, v25, s[64:65]
    v_addc_co_u32 v25, vcc, 0, v25, s[66:67]
    v_cmp_gt_u32 s[60:61], v48, v24
    v_cmp_gt_u32 s[62:63], v49, v24
    v_cmp_gt_u32 s[64:65], v50, v24
    v_cmp_gt_u32 s[66:67], v51, v24
    v_addc_co_u32 v25, vcc, 0, v25, s[60:61]
    v_addc_co_u32 v25, vcc, 0, v25, s[62:63]
    v_addc_co_u32 v25, vcc, 0, v25, s[64:65]
    v_addc_co_u32 v25, vcc, 0, v25, s[66:67]
    v_cmp_gt_u32 s[60:61], v52, v24
    v_cmp_gt_u32 s[62:63], v53, v24
    v_cmp_gt_u32 s[64:65], v54, v24
    v_cmp_gt_u32 s[66:67], v55, v24
    v_addc_co_u32 v25, vcc, 0, v25, s[60:61]
    v_addc_co_u32 v25, vcc, 0, v25, s[62:63]
    v_addc_co_u32 v25, vcc, 0, v25, s[64:65]
    v_addc_co_u32 v25, vcc, 0, v25, s[66:67]
    v_cmp_gt_u32 s[60:61], v56, v24
    v_cmp_gt_u32 s[62:63], v57, v24
    v_cmp_gt_u32 s[64:65], v58, v24
    v_cmp_gt_u32 s[66:67], v59, v24
    v_addc_co_u32 v25, vcc, 0, v25, s[60:61]
    v_addc_co_u32 v25, vcc, 0, v25, s[62:63]
    v_addc_co_u32 v25, vcc, 0, v25, s[64:65]
    v_addc_co_u32 v25, vcc, 0, v25, s[66:67]
    v_cmp_gt_u32 s[60:61], v60, v24
    v_cmp_gt_u32 s[62:63], v61, v24
    v_cmp_gt_u32 s[64:65], v62, v24
    v_cmp_gt_u32 s[66:67], v63, v24
    v_addc_co_u32 v25, vcc, 0, v25, s[60:61]
    v_addc_co_u32 v25, vcc, 0, v25, s[62:63]
    v_addc_co_u32 v25, vcc, 0, v25, s[64:65]
    v_addc_co_u32 v25, vcc, 0, v25, s[66:67]
    v_cmp_gt_u32 s[60:61], 8, v25
    v_cmp_gt_u32 vcc, 32, v0
    v_lshlrev_b32 v26, 2, v25
    v_add_u32 v26, s40, v26
    s_and_b64 vcc, vcc, s[60:61]
    s_and_saveexec_b64 s[62:63], vcc
    ds_write_b32 v26, v24 offset:64
    s_mov_b64 exec, s[62:63]
    v_and_b32 v22, 7, v0
    v_lshlrev_b32 v22, 2, v22
    v_add_u32 v22, s40, v22
    ds_read_b32 v23, v22 offset:64
    s_waitcnt lgkmcnt(0)
    v_and_b32 v26, 0x7ff, v23
    v_sub_u32 v26, 2047, v26
    v_lshrrev_b32 v30, 4, v0
    v_lshlrev_b32 v30, 4, v30
    v_lshl_add_u32 v30, v26, 10, v30
    s_lshl_b32 s44, s34, 8
    v_lshlrev_b32 v31, 2, v26
    v_add_u32 v31, s43, v31
    buffer_load_dword v32, v31, s[24:27], 0 offen sc1
    buffer_load_dwordx4 v[36:39], v30, s[4:7], s44 offen offset:0
    buffer_load_dwordx4 v[40:43], v30, s[4:7], s44 offen offset:64
    buffer_load_dwordx4 v[44:47], v30, s[4:7], s44 offen offset:128
    buffer_load_dwordx4 v[48:51], v30, s[4:7], s44 offen offset:192
    s_waitcnt vmcnt(0)
    v_and_b32 v27, s100, v23
    v_ashrrev_i32 v28, 31, v27
    v_not_b32 v28, v28
    v_or_b32 v28, 0x80000000, v28
    v_xor_b32 v27, v27, v28
    v_and_b32 v27, s100, v27
    v_mul_f32 v28, 0xbfb8aa3b, v27
    v_exp_f32 v28, v28
    v_and_b32 v34, s100, v32
    v_add_f32 v28, 1.0, v28
    v_rcp_f32 v28, v28
    v_rcp_f32 v34, v34
    v_lshlrev_b32 v30, 16, v32
    v_cvt_pk_bf16_f32 v28, v28, v28
    v_and_b32 v28, s100, v28
    v_sub_f32 v30, 0, v30
    v_lshlrev_b32 v52, 16, v36
    v_and_b32 v53, s100, v36
    v_lshlrev_b32 v54, 16, v37
    v_and_b32 v55, s100, v37
    v_pk_add_f32 v[52:53], v[52:53], v[30:31] op_sel_hi:[1,0]
    v_pk_add_f32 v[54:55], v[54:55], v[30:31] op_sel_hi:[1,0]
    v_cvt_pk_bf16_f32 v36, v52, v53
    v_cvt_pk_bf16_f32 v37, v54, v55
    v_lshlrev_b32 v52, 16, v36
    v_and_b32 v53, s100, v36
    v_lshlrev_b32 v54, 16, v37
    v_and_b32 v55, s100, v37
    v_pk_mul_f32 v[52:53], v[52:53], v[34:35] op_sel_hi:[1,0]
    v_pk_mul_f32 v[54:55], v[54:55], v[34:35] op_sel_hi:[1,0]
    v_cvt_pk_bf16_f32 v36, v52, v53
    v_cvt_pk_bf16_f32 v37, v54, v55
    v_lshlrev_b32 v52, 16, v38
    v_and_b32 v53, s100, v38
    v_lshlrev_b32 v54, 16, v39
    v_and_b32 v55, s100, v39
    v_pk_add_f32 v[52:53], v[52:53], v[30:31] op_sel_hi:[1,0]
    v_pk_add_f32 v[54:55], v[54:55], v[30:31] op_sel_hi:[1,0]
    v_cvt_pk_bf16_f32 v38, v52, v53
    v_cvt_pk_bf16_f32 v39, v54, v55
    v_lshlrev_b32 v52, 16, v38
    v_and_b32 v53, s100, v38
    v_lshlrev_b32 v54, 16, v39
    v_and_b32 v55, s100, v39
    v_pk_mul_f32 v[52:53], v[52:53], v[34:35] op_sel_hi:[1,0]
    v_pk_mul_f32 v[54:55], v[54:55], v[34:35] op_sel_hi:[1,0]
    v_cvt_pk_bf16_f32 v38, v52, v53
    v_cvt_pk_bf16_f32 v39, v54, v55
    v_lshlrev_b32 v52, 16, v40
    v_and_b32 v53, s100, v40
    v_lshlrev_b32 v54, 16, v41
    v_and_b32 v55, s100, v41
    v_pk_add_f32 v[52:53], v[52:53], v[30:31] op_sel_hi:[1,0]
    v_pk_add_f32 v[54:55], v[54:55], v[30:31] op_sel_hi:[1,0]
    v_cvt_pk_bf16_f32 v40, v52, v53
    v_cvt_pk_bf16_f32 v41, v54, v55
    v_lshlrev_b32 v52, 16, v40
    v_and_b32 v53, s100, v40
    v_lshlrev_b32 v54, 16, v41
    v_and_b32 v55, s100, v41
    v_pk_mul_f32 v[52:53], v[52:53], v[34:35] op_sel_hi:[1,0]
    v_pk_mul_f32 v[54:55], v[54:55], v[34:35] op_sel_hi:[1,0]
    v_cvt_pk_bf16_f32 v40, v52, v53
    v_cvt_pk_bf16_f32 v41, v54, v55
    v_lshlrev_b32 v52, 16, v42
    v_and_b32 v53, s100, v42
    v_lshlrev_b32 v54, 16, v43
    v_and_b32 v55, s100, v43
    v_pk_add_f32 v[52:53], v[52:53], v[30:31] op_sel_hi:[1,0]
    v_pk_add_f32 v[54:55], v[54:55], v[30:31] op_sel_hi:[1,0]
    v_cvt_pk_bf16_f32 v42, v52, v53
    v_cvt_pk_bf16_f32 v43, v54, v55
    v_lshlrev_b32 v52, 16, v42
    v_and_b32 v53, s100, v42
    v_lshlrev_b32 v54, 16, v43
    v_and_b32 v55, s100, v43
    v_pk_mul_f32 v[52:53], v[52:53], v[34:35] op_sel_hi:[1,0]
    v_pk_mul_f32 v[54:55], v[54:55], v[34:35] op_sel_hi:[1,0]
    v_cvt_pk_bf16_f32 v42, v52, v53
    v_cvt_pk_bf16_f32 v43, v54, v55
    v_lshlrev_b32 v52, 16, v44
    v_and_b32 v53, s100, v44
    v_lshlrev_b32 v54, 16, v45
    v_and_b32 v55, s100, v45
    v_pk_add_f32 v[52:53], v[52:53], v[30:31] op_sel_hi:[1,0]
    v_pk_add_f32 v[54:55], v[54:55], v[30:31] op_sel_hi:[1,0]
    v_cvt_pk_bf16_f32 v44, v52, v53
    v_cvt_pk_bf16_f32 v45, v54, v55
    v_lshlrev_b32 v52, 16, v44
    v_and_b32 v53, s100, v44
    v_lshlrev_b32 v54, 16, v45
    v_and_b32 v55, s100, v45
    v_pk_mul_f32 v[52:53], v[52:53], v[34:35] op_sel_hi:[1,0]
    v_pk_mul_f32 v[54:55], v[54:55], v[34:35] op_sel_hi:[1,0]
    v_cvt_pk_bf16_f32 v44, v52, v53
    v_cvt_pk_bf16_f32 v45, v54, v55
    v_lshlrev_b32 v52, 16, v46
    v_and_b32 v53, s100, v46
    v_lshlrev_b32 v54, 16, v47
    v_and_b32 v55, s100, v47
    v_pk_add_f32 v[52:53], v[52:53], v[30:31] op_sel_hi:[1,0]
    v_pk_add_f32 v[54:55], v[54:55], v[30:31] op_sel_hi:[1,0]
    v_cvt_pk_bf16_f32 v46, v52, v53
    v_cvt_pk_bf16_f32 v47, v54, v55
    v_lshlrev_b32 v52, 16, v46
    v_and_b32 v53, s100, v46
    v_lshlrev_b32 v54, 16, v47
    v_and_b32 v55, s100, v47
    v_pk_mul_f32 v[52:53], v[52:53], v[34:35] op_sel_hi:[1,0]
    v_pk_mul_f32 v[54:55], v[54:55], v[34:35] op_sel_hi:[1,0]
    v_cvt_pk_bf16_f32 v46, v52, v53
    v_cvt_pk_bf16_f32 v47, v54, v55
    v_lshlrev_b32 v52, 16, v48
    v_and_b32 v53, s100, v48
    v_lshlrev_b32 v54, 16, v49
    v_and_b32 v55, s100, v49
    v_pk_add_f32 v[52:53], v[52:53], v[30:31] op_sel_hi:[1,0]
    v_pk_add_f32 v[54:55], v[54:55], v[30:31] op_sel_hi:[1,0]
    v_cvt_pk_bf16_f32 v48, v52, v53
    v_cvt_pk_bf16_f32 v49, v54, v55
    v_lshlrev_b32 v52, 16, v48
    v_and_b32 v53, s100, v48
    v_lshlrev_b32 v54, 16, v49
    v_and_b32 v55, s100, v49
    v_pk_mul_f32 v[52:53], v[52:53], v[34:35] op_sel_hi:[1,0]
    v_pk_mul_f32 v[54:55], v[54:55], v[34:35] op_sel_hi:[1,0]
    v_cvt_pk_bf16_f32 v48, v52, v53
    v_cvt_pk_bf16_f32 v49, v54, v55
    v_lshlrev_b32 v52, 16, v50
    v_and_b32 v53, s100, v50
    v_lshlrev_b32 v54, 16, v51
    v_and_b32 v55, s100, v51
    v_pk_add_f32 v[52:53], v[52:53], v[30:31] op_sel_hi:[1,0]
    v_pk_add_f32 v[54:55], v[54:55], v[30:31] op_sel_hi:[1,0]
    v_cvt_pk_bf16_f32 v50, v52, v53
    v_cvt_pk_bf16_f32 v51, v54, v55
    v_lshlrev_b32 v52, 16, v50
    v_and_b32 v53, s100, v50
    v_lshlrev_b32 v54, 16, v51
    v_and_b32 v55, s100, v51
    v_pk_mul_f32 v[52:53], v[52:53], v[34:35] op_sel_hi:[1,0]
    v_pk_mul_f32 v[54:55], v[54:55], v[34:35] op_sel_hi:[1,0]
    v_cvt_pk_bf16_f32 v50, v52, v53
    v_cvt_pk_bf16_f32 v51, v54, v55
    s_branch L_moe_lndone
L_recurrent_scan__sliding_block_cached__moe_arch_mod__prompt_kernel_fin:
    s_branch L_recurrent_scan__sliding_block_cached__moe_arch_mod__prompt_kernel_done
L_fallback:
    s_barrier
    s_lshl_b32 s38, s51, 14
    v_mov_b32 v32, v31
    v_mov_b32 v52, 0xff800000
    v_mov_b32 v54, 0xff800000
    v_subrev_u32 v32, 8192, v32
    s_mov_b32 s50, 0
    v_xor_b32 v33, 32, v32
    v_xor_b32 v34, 64, v32
    v_xor_b32 v35, 96, v32
    v_xor_b32 v36, 128, v32
    v_xor_b32 v37, 160, v32
    v_xor_b32 v38, 192, v32
    v_xor_b32 v39, 224, v32
L_fb_loop:
    s_waitcnt vmcnt(0) lgkmcnt(0)
    s_barrier
    s_add_u32 m0, s40, 0
    s_nop 0
    buffer_load_dwordx4 v9, s[12:15], s38 offen offset:0 lds
    buffer_load_dwordx4 v10, s[12:15], s38 offen offset:1024 lds
    buffer_load_dwordx4 v11, s[12:15], s38 offen offset:2048 lds
    buffer_load_dwordx4 v12, s[12:15], s38 offen offset:3072 lds
    s_add_u32 s38, s38, 16384
    s_and_b32 s38, s38, 131071
    s_waitcnt vmcnt(0) lgkmcnt(0)
    s_barrier
    ds_read_b128 a[0:3], v32 offset:0
    ds_read_b128 a[4:7], v33 offset:0
    ds_read_b128 a[8:11], v34 offset:0
    ds_read_b128 a[12:15], v35 offset:0
    ds_read_b128 a[16:19], v36 offset:0
    ds_read_b128 a[20:23], v37 offset:0
    ds_read_b128 a[24:27], v38 offset:0
    ds_read_b128 a[28:31], v39 offset:0
    s_waitcnt lgkmcnt(0)
    v_mfma_f32_32x32x16_bf16 v[128:143], a[0:3], v[64:67], 0
    v_mfma_f32_32x32x16_bf16 v[144:159], a[0:3], v[68:71], 0
    v_mfma_f32_32x32x16_bf16 v[128:143], a[4:7], v[72:75], v[128:143]
    v_mfma_f32_32x32x16_bf16 v[144:159], a[4:7], v[76:79], v[144:159]
    v_mfma_f32_32x32x16_bf16 v[128:143], a[8:11], v[80:83], v[128:143]
    v_mfma_f32_32x32x16_bf16 v[144:159], a[8:11], v[84:87], v[144:159]
    v_mfma_f32_32x32x16_bf16 v[128:143], a[12:15], v[88:91], v[128:143]
    v_mfma_f32_32x32x16_bf16 v[144:159], a[12:15], v[92:95], v[144:159]
    v_mfma_f32_32x32x16_bf16 v[128:143], a[16:19], v[96:99], v[128:143]
    v_mfma_f32_32x32x16_bf16 v[144:159], a[16:19], v[100:103], v[144:159]
    v_mfma_f32_32x32x16_bf16 v[128:143], a[20:23], v[104:107], v[128:143]
    v_mfma_f32_32x32x16_bf16 v[144:159], a[20:23], v[108:111], v[144:159]
    v_mfma_f32_32x32x16_bf16 v[128:143], a[24:27], v[112:115], v[128:143]
    v_mfma_f32_32x32x16_bf16 v[144:159], a[24:27], v[116:119], v[144:159]
    v_mfma_f32_32x32x16_bf16 v[128:143], a[28:31], v[120:123], v[128:143]
    v_mfma_f32_32x32x16_bf16 v[144:159], a[28:31], v[124:127], v[144:159]
    s_nop 15
    v_max3_f32 v52, v52, v128, v129
    v_max3_f32 v52, v52, v130, v131
    v_max3_f32 v52, v52, v132, v133
    v_max3_f32 v52, v52, v134, v135
    v_max3_f32 v52, v52, v136, v137
    v_max3_f32 v52, v52, v138, v139
    v_max3_f32 v52, v52, v140, v141
    v_max3_f32 v52, v52, v142, v143
    v_max3_f32 v54, v54, v144, v145
    v_max3_f32 v54, v54, v146, v147
    v_max3_f32 v54, v54, v148, v149
    v_max3_f32 v54, v54, v150, v151
    v_max3_f32 v54, v54, v152, v153
    v_max3_f32 v54, v54, v154, v155
    v_max3_f32 v54, v54, v156, v157
    v_max3_f32 v54, v54, v158, v159
    ds_read_b128 a[0:3], v32 offset:49152
    ds_read_b128 a[4:7], v33 offset:49152
    ds_read_b128 a[8:11], v34 offset:49152
    ds_read_b128 a[12:15], v35 offset:49152
    ds_read_b128 a[16:19], v36 offset:49152
    ds_read_b128 a[20:23], v37 offset:49152
    ds_read_b128 a[24:27], v38 offset:49152
    ds_read_b128 a[28:31], v39 offset:49152
    s_waitcnt lgkmcnt(0)
    v_mfma_f32_32x32x16_bf16 v[128:143], a[0:3], v[64:67], 0
    v_mfma_f32_32x32x16_bf16 v[144:159], a[0:3], v[68:71], 0
    v_mfma_f32_32x32x16_bf16 v[128:143], a[4:7], v[72:75], v[128:143]
    v_mfma_f32_32x32x16_bf16 v[144:159], a[4:7], v[76:79], v[144:159]
    v_mfma_f32_32x32x16_bf16 v[128:143], a[8:11], v[80:83], v[128:143]
    v_mfma_f32_32x32x16_bf16 v[144:159], a[8:11], v[84:87], v[144:159]
    v_mfma_f32_32x32x16_bf16 v[128:143], a[12:15], v[88:91], v[128:143]
    v_mfma_f32_32x32x16_bf16 v[144:159], a[12:15], v[92:95], v[144:159]
    v_mfma_f32_32x32x16_bf16 v[128:143], a[16:19], v[96:99], v[128:143]
    v_mfma_f32_32x32x16_bf16 v[144:159], a[16:19], v[100:103], v[144:159]
    v_mfma_f32_32x32x16_bf16 v[128:143], a[20:23], v[104:107], v[128:143]
    v_mfma_f32_32x32x16_bf16 v[144:159], a[20:23], v[108:111], v[144:159]
    v_mfma_f32_32x32x16_bf16 v[128:143], a[24:27], v[112:115], v[128:143]
    v_mfma_f32_32x32x16_bf16 v[144:159], a[24:27], v[116:119], v[144:159]
    v_mfma_f32_32x32x16_bf16 v[128:143], a[28:31], v[120:123], v[128:143]
    v_mfma_f32_32x32x16_bf16 v[144:159], a[28:31], v[124:127], v[144:159]
    s_nop 15
    v_max3_f32 v52, v52, v128, v129
    v_max3_f32 v52, v52, v130, v131
    v_max3_f32 v52, v52, v132, v133
    v_max3_f32 v52, v52, v134, v135
    v_max3_f32 v52, v52, v136, v137
    v_max3_f32 v52, v52, v138, v139
    v_max3_f32 v52, v52, v140, v141
    v_max3_f32 v52, v52, v142, v143
    v_max3_f32 v54, v54, v144, v145
    v_max3_f32 v54, v54, v146, v147
    v_max3_f32 v54, v54, v148, v149
    v_max3_f32 v54, v54, v150, v151
    v_max3_f32 v54, v54, v152, v153
    v_max3_f32 v54, v54, v154, v155
    v_max3_f32 v54, v54, v156, v157
    v_max3_f32 v54, v54, v158, v159
    s_add_u32 s50, s50, 1
    s_cmp_lt_u32 s50, 8
    s_cbranch_scc1 L_fb_loop
    v_mov_b32 v53, v52
    v_mov_b32 v55, v54
    s_nop 1
    v_permlane32_swap_b32 v52, v53
    v_permlane32_swap_b32 v54, v55
    s_nop 0
    v_max_f32 v52, v52, v53
    v_max_f32 v54, v54, v55
    v_sub_f32 v224, 0, v52
    v_sub_f32 v225, 0, v52
    v_sub_f32 v226, 0, v52
    v_sub_f32 v227, 0, v52
    v_sub_f32 v228, 0, v52
    v_sub_f32 v229, 0, v52
    v_sub_f32 v230, 0, v52
    v_sub_f32 v231, 0, v52
    v_sub_f32 v232, 0, v52
    v_sub_f32 v233, 0, v52
    v_sub_f32 v234, 0, v52
    v_sub_f32 v235, 0, v52
    v_sub_f32 v236, 0, v52
    v_sub_f32 v237, 0, v52
    v_sub_f32 v238, 0, v52
    v_sub_f32 v239, 0, v52
    v_sub_f32 v240, 0, v54
    v_sub_f32 v241, 0, v54
    v_sub_f32 v242, 0, v54
    v_sub_f32 v243, 0, v54
    v_sub_f32 v244, 0, v54
    v_sub_f32 v245, 0, v54
    v_sub_f32 v246, 0, v54
    v_sub_f32 v247, 0, v54
    v_sub_f32 v248, 0, v54
    v_sub_f32 v249, 0, v54
    v_sub_f32 v250, 0, v54
    v_sub_f32 v251, 0, v54
    v_sub_f32 v252, 0, v54
    v_sub_f32 v253, 0, v54
    v_sub_f32 v254, 0, v54
    v_sub_f32 v255, 0, v54
    s_barrier
    s_lshl_b32 s38, s51, 14
    s_mov_b32 s39, s38
    s_lshl_b32 s37, s35, 15
    v_mov_b32 v32, v31
    v_mov_b32 v40, v63
    s_mov_b32 s70, 1
    v_xor_b32 v33, 32, v32
    v_xor_b32 v34, 64, v32
    v_xor_b32 v35, 96, v32
    v_xor_b32 v36, 128, v32
    v_xor_b32 v37, 160, v32
    v_xor_b32 v38, 192, v32
    v_xor_b32 v39, 224, v32
    v_xor_b32 v41, 64, v40
    v_xor_b32 v42, 128, v40
    v_xor_b32 v43, 192, v40
    s_add_u32 m0, s40, 8192
    s_nop 0
    buffer_load_dwordx4 v9, s[12:15], s38 offen offset:0 lds
    buffer_load_dwordx4 v10, s[12:15], s38 offen offset:1024 lds
    buffer_load_dwordx4 v11, s[12:15], s38 offen offset:2048 lds
    buffer_load_dwordx4 v12, s[12:15], s38 offen offset:3072 lds
    s_add_u32 s38, s38, 16384
    s_and_b32 s38, s38, 131071
    s_add_u32 m0, s40, 12288
    s_nop 0
    buffer_load_dwordx4 v13, s[16:19], s39 offen offset:0 lds
    buffer_load_dwordx4 v13, s[16:19], s39 offen offset:1024 lds
    buffer_load_dwordx4 v13, s[16:19], s39 offen offset:2048 lds
    buffer_load_dwordx4 v13, s[16:19], s39 offen offset:3072 lds
    s_add_u32 s39, s39, 16384
    s_and_b32 s39, s39, 131071
    s_add_u32 m0, s40, 16384
    s_nop 0
    buffer_load_dwordx4 v9, s[12:15], s38 offen offset:0 lds
    buffer_load_dwordx4 v10, s[12:15], s38 offen offset:1024 lds
    buffer_load_dwordx4 v11, s[12:15], s38 offen offset:2048 lds
    buffer_load_dwordx4 v12, s[12:15], s38 offen offset:3072 lds
    s_add_u32 s38, s38, 16384
    s_and_b32 s38, s38, 131071
    s_add_u32 m0, s40, 20480
    s_nop 0
    buffer_load_dwordx4 v13, s[16:19], s39 offen offset:0 lds
    buffer_load_dwordx4 v13, s[16:19], s39 offen offset:1024 lds
    buffer_load_dwordx4 v13, s[16:19], s39 offen offset:2048 lds
    buffer_load_dwordx4 v13, s[16:19], s39 offen offset:3072 lds
    s_add_u32 s39, s39, 16384
    s_and_b32 s39, s39, 131071
    s_add_u32 m0, s40, 0
    s_nop 0
    buffer_load_dwordx4 v9, s[12:15], s38 offen offset:0 lds
    buffer_load_dwordx4 v10, s[12:15], s38 offen offset:1024 lds
    buffer_load_dwordx4 v11, s[12:15], s38 offen offset:2048 lds
    buffer_load_dwordx4 v12, s[12:15], s38 offen offset:3072 lds
    s_add_u32 s38, s38, 16384
    s_and_b32 s38, s38, 131071
    v_mov_b32 v52, 0
    v_mov_b32 v44, v9
    v_mov_b32 v48, v13
    v_mov_b32 v53, 0
    v_mov_b32 v45, v10
    v_mov_b32 v49, v13
    v_mov_b32 v54, 0
    v_mov_b32 v46, v11
    v_mov_b32 v50, v13
    v_mov_b32 v55, 0
    v_mov_b32 v47, v12
    v_mov_b32 v51, v13
    v_accvgpr_write_b32 a128, 0
    v_accvgpr_write_b32 a129, 0
    v_accvgpr_write_b32 a130, 0
    v_accvgpr_write_b32 a131, 0
    v_accvgpr_write_b32 a132, 0
    v_accvgpr_write_b32 a133, 0
    v_accvgpr_write_b32 a134, 0
    v_accvgpr_write_b32 a135, 0
    v_accvgpr_write_b32 a136, 0
    v_accvgpr_write_b32 a137, 0
    v_accvgpr_write_b32 a138, 0
    v_accvgpr_write_b32 a139, 0
    v_accvgpr_write_b32 a140, 0
    v_accvgpr_write_b32 a141, 0
    v_accvgpr_write_b32 a142, 0
    v_accvgpr_write_b32 a143, 0
    v_accvgpr_write_b32 a144, 0
    v_accvgpr_write_b32 a145, 0
    v_accvgpr_write_b32 a146, 0
    v_accvgpr_write_b32 a147, 0
    v_accvgpr_write_b32 a148, 0
    v_accvgpr_write_b32 a149, 0
    v_accvgpr_write_b32 a150, 0
    v_accvgpr_write_b32 a151, 0
    v_accvgpr_write_b32 a152, 0
    v_accvgpr_write_b32 a153, 0
    v_accvgpr_write_b32 a154, 0
    v_accvgpr_write_b32 a155, 0
    v_accvgpr_write_b32 a156, 0
    v_accvgpr_write_b32 a157, 0
    v_accvgpr_write_b32 a158, 0
    v_accvgpr_write_b32 a159, 0
    v_accvgpr_write_b32 a160, 0
    v_accvgpr_write_b32 a161, 0
    v_accvgpr_write_b32 a162, 0
    v_accvgpr_write_b32 a163, 0
    v_accvgpr_write_b32 a164, 0
    v_accvgpr_write_b32 a165, 0
    v_accvgpr_write_b32 a166, 0
    v_accvgpr_write_b32 a167, 0
    v_accvgpr_write_b32 a168, 0
    v_accvgpr_write_b32 a169, 0
    v_accvgpr_write_b32 a170, 0
    v_accvgpr_write_b32 a171, 0
    v_accvgpr_write_b32 a172, 0
    v_accvgpr_write_b32 a173, 0
    v_accvgpr_write_b32 a174, 0
    v_accvgpr_write_b32 a175, 0
    v_accvgpr_write_b32 a176, 0
    v_accvgpr_write_b32 a177, 0
    v_accvgpr_write_b32 a178, 0
    v_accvgpr_write_b32 a179, 0
    v_accvgpr_write_b32 a180, 0
    v_accvgpr_write_b32 a181, 0
    v_accvgpr_write_b32 a182, 0
    v_accvgpr_write_b32 a183, 0
    v_accvgpr_write_b32 a184, 0
    v_accvgpr_write_b32 a185, 0
    v_accvgpr_write_b32 a186, 0
    v_accvgpr_write_b32 a187, 0
    v_accvgpr_write_b32 a188, 0
    v_accvgpr_write_b32 a189, 0
    v_accvgpr_write_b32 a190, 0
    v_accvgpr_write_b32 a191, 0
    v_accvgpr_write_b32 a192, 0
    v_accvgpr_write_b32 a193, 0
    v_accvgpr_write_b32 a194, 0
    v_accvgpr_write_b32 a195, 0
    v_accvgpr_write_b32 a196, 0
    v_accvgpr_write_b32 a197, 0
    v_accvgpr_write_b32 a198, 0
    v_accvgpr_write_b32 a199, 0
    v_accvgpr_write_b32 a200, 0
    v_accvgpr_write_b32 a201, 0
    v_accvgpr_write_b32 a202, 0
    v_accvgpr_write_b32 a203, 0
    v_accvgpr_write_b32 a204, 0
    v_accvgpr_write_b32 a205, 0
    v_accvgpr_write_b32 a206, 0
    v_accvgpr_write_b32 a207, 0
    v_accvgpr_write_b32 a208, 0
    v_accvgpr_write_b32 a209, 0
    v_accvgpr_write_b32 a210, 0
    v_accvgpr_write_b32 a211, 0
    v_accvgpr_write_b32 a212, 0
    v_accvgpr_write_b32 a213, 0
    v_accvgpr_write_b32 a214, 0
    v_accvgpr_write_b32 a215, 0
    v_accvgpr_write_b32 a216, 0
    v_accvgpr_write_b32 a217, 0
    v_accvgpr_write_b32 a218, 0
    v_accvgpr_write_b32 a219, 0
    v_accvgpr_write_b32 a220, 0
    v_accvgpr_write_b32 a221, 0
    v_accvgpr_write_b32 a222, 0
    v_accvgpr_write_b32 a223, 0
    v_accvgpr_write_b32 a224, 0
    v_accvgpr_write_b32 a225, 0
    v_accvgpr_write_b32 a226, 0
    v_accvgpr_write_b32 a227, 0
    v_accvgpr_write_b32 a228, 0
    v_accvgpr_write_b32 a229, 0
    v_accvgpr_write_b32 a230, 0
    v_accvgpr_write_b32 a231, 0
    v_accvgpr_write_b32 a232, 0
    v_accvgpr_write_b32 a233, 0
    v_accvgpr_write_b32 a234, 0
    v_accvgpr_write_b32 a235, 0
    v_accvgpr_write_b32 a236, 0
    v_accvgpr_write_b32 a237, 0
    v_accvgpr_write_b32 a238, 0
    v_accvgpr_write_b32 a239, 0
    v_accvgpr_write_b32 a240, 0
    v_accvgpr_write_b32 a241, 0
    v_accvgpr_write_b32 a242, 0
    v_accvgpr_write_b32 a243, 0
    v_accvgpr_write_b32 a244, 0
    v_accvgpr_write_b32 a245, 0
    v_accvgpr_write_b32 a246, 0
    v_accvgpr_write_b32 a247, 0
    v_accvgpr_write_b32 a248, 0
    v_accvgpr_write_b32 a249, 0
    v_accvgpr_write_b32 a250, 0
    v_accvgpr_write_b32 a251, 0
    v_accvgpr_write_b32 a252, 0
    v_accvgpr_write_b32 a253, 0
    v_accvgpr_write_b32 a254, 0
    v_accvgpr_write_b32 a255, 0
    s_waitcnt vmcnt(0)
    s_branch L_p2_start
L_recurrent_scan__sliding_block_cached__moe_arch_mod__prompt_kernel_done:
    s_endpgm
L_kend:
.section .rodata,"a"
.p2align 6
.amdhsa_kernel recurrent_scan__sliding_block_cached__moe_arch_mod__prompt_kernel
  .amdhsa_next_free_vgpr 512
  .amdhsa_next_free_sgpr 102
  .amdhsa_accum_offset 256
  .amdhsa_group_segment_fixed_size 0
  .amdhsa_kernarg_size 104
  .amdhsa_user_sgpr_count 2
  .amdhsa_user_sgpr_kernarg_segment_ptr 1
  .amdhsa_system_sgpr_workgroup_id_x 1
  .amdhsa_float_denorm_mode_32 3
.end_amdhsa_kernel
.text
```
